```python
import torch

def _softmax(x, axis=-1):
    return torch.softmax(x, dim=axis)
def _gelu(x):
    return torch.nn.functional.gelu(x, approximate="tanh")
def _silu(x):
    return torch.nn.functional.silu(x)
def _sigmoid(x):
    return torch.sigmoid(x)
def _layernorm(x, axis=-1, eps=1e-5):
    m = x.mean(dim=axis, keepdim=True)
    v = x.var(dim=axis, keepdim=True, unbiased=False)
    return (x - m) / torch.sqrt(v + eps)
def _scatter_add(tgt, idx, src, axis=0):
    return tgt.clone().index_add_(axis, idx, src)
def _segment_sum(src, seg, n):
    out = torch.zeros((n,) + src.shape[1:], dtype=src.dtype)
    return out.index_add_(0, seg, src)
def _pad(x, pw):
    flat = tuple(v for pair in reversed(pw) for v in pair)
    return torch.nn.functional.pad(x, flat)

kernel_name = 'standalone__gqa_softmax__near_ridge'

def setup_inputs():

    _w = (lambda a: (lambda t: t.to(torch.bfloat16) if t.is_floating_point() else t)(torch.as_tensor(a)))
    B, Hq, Hkv, Sq, Sk, D = 32, 32, 8, 256, 256, 128
    return {
        "q": _w((lambda *s: torch.randn(*s, dtype=torch.bfloat16) * 0.8)(B, Hq, Sq, D)),
        "k": _w((lambda *s: torch.randn(*s, dtype=torch.bfloat16) * 0.8)(B, Hkv, Sk, D)),
        "v": _w((lambda *s: torch.randn(*s, dtype=torch.bfloat16) * 0.05)(B, Hkv, Sk, D)),
    }

def reference(q, k, v):
    B, Hq, Sq, D = q.shape
    Hkv = k.shape[1]
    rep = Hq // Hkv
    k = (lambda x, n, axis: torch.repeat_interleave(x, n, dim=axis))(k, rep, axis=1)
    v = (lambda x, n, axis: torch.repeat_interleave(x, n, dim=axis))(v, rep, axis=1)
    scale = D ** -0.5
    scores = torch.einsum("bhqd,bhkd->bhqk", q, k) * scale
    p = _softmax(scores, axis=-1)
    return torch.einsum("bhqk,bhkd->bhqd", p, v)
```

```asm
; @launch grid=(256,1,1) block=(256,1,1) lds=131328
.amdgcn_target "amdgcn-amd-amdhsa--gfx950"
.text
.globl standalone__gqa_softmax__near_ridge_kernel
.p2align 8
.type standalone__gqa_softmax__near_ridge_kernel,@function
standalone__gqa_softmax__near_ridge_kernel:
    s_cmp_ge_u32 s2, 256
    s_cbranch_scc1 L_end
    s_load_dwordx4 s[4:7], s[0:1], 0
    s_load_dwordx4 s[8:11], s[0:1], 16
    v_lshrrev_b32 v1, 6, v0
    v_and_b32 v2, 63, v0
    v_readfirstlane_b32 s40, v1
    v_and_b32 v3, 15, v2
    v_lshrrev_b32 v4, 4, v2
    v_lshlrev_b32 v5, 4, v4
    v_lshl_add_u32 v243, v3, 8, v5
    v_lshrrev_b32 v6, 2, v3
    v_and_b32 v7, 3, v3
    v_lshl_add_u32 v249, v6, 11, v5
    v_lshl_add_u32 v249, v7, 8, v249
    v_lshlrev_b32 v250, 4, v3
    v_lshl_add_u32 v250, v4, 11, v250
    s_lshl_b32 s45, s40, 4
    s_mov_b32 s46, 0x7531db90
    s_mov_b32 s47, 0xf642eca8
    s_lshr_b64 s[46:47], s[46:47], s45
    s_and_b32 s44, s46, 0xffff
    s_lshr_b32 s68, s2, 0
    s_lshr_b32 s69, s2, 3
    s_xor_b32 s68, s68, s69
    s_lshl_b32 s3, s2, 16
    s_mov_b32 s26, 0x10000
    s_mov_b32 s27, 0x20000
    s_lshl_b32 s46, s2, 18
    s_lshl_b32 s47, s40, 16
    s_add_u32 s47, s47, s46
    s_getpc_b64 s[36:37]
L_pf:
    s_lshr_b32 s38, s2, 3
    s_and_b32 s38, s38, 31
    s_lshl_b32 s38, s38, 11
    s_lshl_b32 s39, s40, 9
    s_add_u32 s38, s38, s39
    v_lshlrev_b32 v10, 7, v2
    v_add_u32 v10, s38, v10
    s_mov_b32 s38, L_done-L_pf-4
    v_min_u32 v10, s38, v10
    v_mov_b32 v11, s37
    v_add_co_u32 v10, vcc, s36, v10
    v_addc_co_u32 v11, vcc, 0, v11, vcc
    s_mov_b64 exec, 15
    global_load_dword v12, v[10:11], off
    s_mov_b64 exec, -1
    s_waitcnt lgkmcnt(0)
    s_add_u32 s20, s6, s3
    s_addc_u32 s21, s7, 0
    s_and_b32 s21, s21, 0xffff
    s_add_u32 s22, s8, s3
    s_addc_u32 s23, s9, 0
    s_and_b32 s23, s23, 0xffff
    s_bfe_u32 s45, s44, 0x30000
    s_add_u32 s45, s45, s68
    s_and_b32 s45, s45, 7
    s_lshl_b32 s28, s45, 13
    s_bitcmp1_b32 s44, 3
    s_cselect_b64 s[24:25], s[22:23], s[20:21]
    s_cselect_b32 s45, 256, 64
    s_cselect_b64 vcc, -1, 0
    s_add_u32 s29, s28, s45
    v_cndmask_b32 v251, v249, v250, vcc
    s_add_u32 s30, s29, s45
    s_add_u32 s31, s30, s45
    buffer_load_dwordx4 v[32:35], v251, s[24:27], s28 offen offset:0 nt
    buffer_load_dwordx4 v[36:39], v251, s[24:27], s29 offen offset:0 nt
    buffer_load_dwordx4 v[40:43], v251, s[24:27], s30 offen offset:0 nt
    buffer_load_dwordx4 v[44:47], v251, s[24:27], s31 offen offset:0 nt
    buffer_load_dwordx4 v[48:51], v251, s[24:27], s28 offen offset:1024 nt
    buffer_load_dwordx4 v[52:55], v251, s[24:27], s29 offen offset:1024 nt
    buffer_load_dwordx4 v[56:59], v251, s[24:27], s30 offen offset:1024 nt
    buffer_load_dwordx4 v[60:63], v251, s[24:27], s31 offen offset:1024 nt
    s_add_u32 s12, s4, s47
    s_addc_u32 s13, s5, 0
    s_and_b32 s13, s13, 0xffff
    s_mov_b32 s14, 0x10000
    s_mov_b32 s15, 0x20000
    s_add_u32 s16, s10, s47
    s_addc_u32 s17, s11, 0
    s_and_b32 s17, s17, 0xffff
    s_mov_b32 s18, 0x10000
    s_mov_b32 s19, 0x20000
    s_lshr_b32 s52, s2, 0
    s_lshr_b32 s53, s2, 4
    s_xor_b32 s52, s52, s53
    s_and_b32 s52, s52, 15
    s_lshl_b32 s52, s52, 12
    s_add_u32 s53, s52, 4096
    s_and_b32 s53, s53, 0xffff
    s_add_u32 s54, s53, 4096
    s_and_b32 s54, s54, 0xffff
    s_add_u32 s55, s54, 4096
    s_and_b32 s55, s55, 0xffff
    s_add_u32 s56, s55, 4096
    s_and_b32 s56, s56, 0xffff
    s_add_u32 s57, s56, 4096
    s_and_b32 s57, s57, 0xffff
    s_add_u32 s58, s57, 4096
    s_and_b32 s58, s58, 0xffff
    s_add_u32 s59, s58, 4096
    s_and_b32 s59, s59, 0xffff
    s_add_u32 s60, s59, 4096
    s_and_b32 s60, s60, 0xffff
    s_add_u32 s61, s60, 4096
    s_and_b32 s61, s61, 0xffff
    s_add_u32 s62, s61, 4096
    s_and_b32 s62, s62, 0xffff
    s_add_u32 s63, s62, 4096
    s_and_b32 s63, s63, 0xffff
    s_add_u32 s64, s63, 4096
    s_and_b32 s64, s64, 0xffff
    s_add_u32 s65, s64, 4096
    s_and_b32 s65, s65, 0xffff
    s_add_u32 s66, s65, 4096
    s_and_b32 s66, s66, 0xffff
    s_add_u32 s67, s66, 4096
    s_and_b32 s67, s67, 0xffff
    buffer_load_dwordx4 a[0:3], v243, s[12:15], s52 offen offset:0
    buffer_load_dwordx4 a[4:7], v243, s[12:15], s52 offen offset:64
    buffer_load_dwordx4 a[8:11], v243, s[12:15], s52 offen offset:128
    buffer_load_dwordx4 a[12:15], v243, s[12:15], s52 offen offset:192
    buffer_load_dwordx4 a[16:19], v243, s[12:15], s53 offen offset:0 nt
    buffer_load_dwordx4 a[20:23], v243, s[12:15], s53 offen offset:64 nt
    buffer_load_dwordx4 a[24:27], v243, s[12:15], s53 offen offset:128 nt
    buffer_load_dwordx4 a[28:31], v243, s[12:15], s53 offen offset:192 nt
    v_lshlrev_b32 v240, 4, v2
    v_add_u32 v241, 0x10000, v240
    v_lshlrev_b32 v248, 4, v3
    v_lshl_add_u32 v248, v4, 10, v248
    v_lshl_add_u32 v8, v4, 2, v3
    v_and_b32 v8, 15, v8
    v_lshl_add_u32 v8, v4, 4, v8
    v_lshlrev_b32 v242, 2, v8
    v_mov_b32 v253, 0
    v_mov_b32 v9, 0x3f803f80
    s_mov_b32 s41, 0x3e0293ee
    s_mov_b32 s42, 0x05040100
    s_mov_b32 s43, 0x07060302
    s_mov_b32 s48, 0x30800000
    s_mov_b32 s49, 0x23000000
    v_lshrrev_b32 v8, 1, v3
    v_lshrrev_b32 v10, 1, v4
    v_xor_b32 v8, v8, v10
    v_and_b32 v8, 1, v8
    v_cmp_eq_u32 vcc, 0, v8
    s_nop 1
    v_cndmask_b32 v9, 0, v9, vcc
    v_and_b32 v8, 1, v3
    v_cmp_eq_u32 vcc, 0, v8
    v_mov_b32 v8, 0x44444444
    v_mov_b32 v10, 0xeeeeeeee
    v_cndmask_b32 v247, v10, v8, vcc
    v_accvgpr_write_b32 a192, 0
    v_accvgpr_write_b32 a193, 0
    v_accvgpr_write_b32 a194, 0
    v_accvgpr_write_b32 a195, 0
    v_accvgpr_write_b32 a196, 0
    v_accvgpr_write_b32 a197, 0
    v_accvgpr_write_b32 a198, 0
    v_accvgpr_write_b32 a199, 0
    v_mov_b32 v224, 0
    v_mov_b32 v225, 0
    v_mov_b32 v226, 0
    v_mov_b32 v227, 0
    v_mov_b32 v228, 0
    v_mov_b32 v229, 0
    v_mov_b32 v230, 0
    v_mov_b32 v231, 0
    v_mov_b32 v232, 0
    v_mov_b32 v233, 0
    v_mov_b32 v234, 0
    v_mov_b32 v235, 0
    v_mov_b32 v236, 0
    v_mov_b32 v237, 0
    v_mov_b32 v238, 0
    v_mov_b32 v239, 0
    v_accvgpr_write_b32 a212, v9
    v_accvgpr_write_b32 a213, v9
    v_accvgpr_write_b32 a214, v9
    v_accvgpr_write_b32 a215, v9
    s_bfe_u32 s46, s44, 0x30000
    s_lshl_b32 s46, s46, 13
    s_bitcmp1_b32 s44, 3
    s_cbranch_scc1 L_c0_v
    v_add_u32 v252, s46, v240
    s_waitcnt vmcnt(15)
    v_lshlrev_b32 v216, 16, v32
    v_and_b32 v217, 0xffff0000, v32
    v_mul_f32 v216, s41, v216
    v_mul_f32 v217, s41, v217
    v_cvt_pk_bf16_f32 v32, v216, v217
    v_lshlrev_b32 v218, 16, v33
    v_and_b32 v219, 0xffff0000, v33
    v_mul_f32 v218, s41, v218
    v_mul_f32 v219, s41, v219
    v_cvt_pk_bf16_f32 v33, v218, v219
    v_lshlrev_b32 v216, 16, v34
    v_and_b32 v217, 0xffff0000, v34
    v_mul_f32 v216, s41, v216
    v_mul_f32 v217, s41, v217
    v_cvt_pk_bf16_f32 v34, v216, v217
    v_lshlrev_b32 v218, 16, v35
    v_and_b32 v219, 0xffff0000, v35
    v_mul_f32 v218, s41, v218
    v_mul_f32 v219, s41, v219
    v_cvt_pk_bf16_f32 v35, v218, v219
    ds_write_b128 v252, v[32:35] offset:0
    s_bfe_u32 s45, s44, 0x30004
    s_add_u32 s45, s45, s68
    s_and_b32 s45, s45, 7
    s_lshl_b32 s28, s45, 13
    s_bitcmp1_b32 s44, 7
    s_cselect_b64 s[24:25], s[22:23], s[20:21]
    s_cselect_b32 s45, 256, 64
    s_cselect_b64 vcc, -1, 0
    s_add_u32 s29, s28, s45
    v_cndmask_b32 v251, v249, v250, vcc
    s_add_u32 s30, s29, s45
    s_add_u32 s31, s30, s45
    buffer_load_dwordx4 v[64:67], v251, s[24:27], s28 offen offset:0 nt
    s_waitcnt vmcnt(15)
    v_lshlrev_b32 v216, 16, v36
    v_and_b32 v217, 0xffff0000, v36
    v_mul_f32 v216, s41, v216
    v_mul_f32 v217, s41, v217
    v_cvt_pk_bf16_f32 v36, v216, v217
    v_lshlrev_b32 v218, 16, v37
    v_and_b32 v219, 0xffff0000, v37
    v_mul_f32 v218, s41, v218
    v_mul_f32 v219, s41, v219
    v_cvt_pk_bf16_f32 v37, v218, v219
    v_lshlrev_b32 v216, 16, v38
    v_and_b32 v217, 0xffff0000, v38
    v_mul_f32 v216, s41, v216
    v_mul_f32 v217, s41, v217
    v_cvt_pk_bf16_f32 v38, v216, v217
    v_lshlrev_b32 v218, 16, v39
    v_and_b32 v219, 0xffff0000, v39
    v_mul_f32 v218, s41, v218
    v_mul_f32 v219, s41, v219
    v_cvt_pk_bf16_f32 v39, v218, v219
    ds_write_b128 v252, v[36:39] offset:1024
    buffer_load_dwordx4 v[68:71], v251, s[24:27], s29 offen offset:0 nt
    s_waitcnt vmcnt(15)
    v_lshlrev_b32 v216, 16, v40
    v_and_b32 v217, 0xffff0000, v40
    v_mul_f32 v216, s41, v216
    v_mul_f32 v217, s41, v217
    v_cvt_pk_bf16_f32 v40, v216, v217
    v_lshlrev_b32 v218, 16, v41
    v_and_b32 v219, 0xffff0000, v41
    v_mul_f32 v218, s41, v218
    v_mul_f32 v219, s41, v219
    v_cvt_pk_bf16_f32 v41, v218, v219
    v_lshlrev_b32 v216, 16, v42
    v_and_b32 v217, 0xffff0000, v42
    v_mul_f32 v216, s41, v216
    v_mul_f32 v217, s41, v217
    v_cvt_pk_bf16_f32 v42, v216, v217
    v_lshlrev_b32 v218, 16, v43
    v_and_b32 v219, 0xffff0000, v43
    v_mul_f32 v218, s41, v218
    v_mul_f32 v219, s41, v219
    v_cvt_pk_bf16_f32 v43, v218, v219
    ds_write_b128 v252, v[40:43] offset:2048
    buffer_load_dwordx4 v[72:75], v251, s[24:27], s30 offen offset:0 nt
    s_waitcnt vmcnt(15)
    v_lshlrev_b32 v216, 16, v44
    v_and_b32 v217, 0xffff0000, v44
    v_mul_f32 v216, s41, v216
    v_mul_f32 v217, s41, v217
    v_cvt_pk_bf16_f32 v44, v216, v217
    v_lshlrev_b32 v218, 16, v45
    v_and_b32 v219, 0xffff0000, v45
    v_mul_f32 v218, s41, v218
    v_mul_f32 v219, s41, v219
    v_cvt_pk_bf16_f32 v45, v218, v219
    v_lshlrev_b32 v216, 16, v46
    v_and_b32 v217, 0xffff0000, v46
    v_mul_f32 v216, s41, v216
    v_mul_f32 v217, s41, v217
    v_cvt_pk_bf16_f32 v46, v216, v217
    v_lshlrev_b32 v218, 16, v47
    v_and_b32 v219, 0xffff0000, v47
    v_mul_f32 v218, s41, v218
    v_mul_f32 v219, s41, v219
    v_cvt_pk_bf16_f32 v47, v218, v219
    ds_write_b128 v252, v[44:47] offset:3072
    buffer_load_dwordx4 v[76:79], v251, s[24:27], s31 offen offset:0 nt
    s_waitcnt vmcnt(15)
    v_lshlrev_b32 v216, 16, v48
    v_and_b32 v217, 0xffff0000, v48
    v_mul_f32 v216, s41, v216
    v_mul_f32 v217, s41, v217
    v_cvt_pk_bf16_f32 v48, v216, v217
    v_lshlrev_b32 v218, 16, v49
    v_and_b32 v219, 0xffff0000, v49
    v_mul_f32 v218, s41, v218
    v_mul_f32 v219, s41, v219
    v_cvt_pk_bf16_f32 v49, v218, v219
    v_lshlrev_b32 v216, 16, v50
    v_and_b32 v217, 0xffff0000, v50
    v_mul_f32 v216, s41, v216
    v_mul_f32 v217, s41, v217
    v_cvt_pk_bf16_f32 v50, v216, v217
    v_lshlrev_b32 v218, 16, v51
    v_and_b32 v219, 0xffff0000, v51
    v_mul_f32 v218, s41, v218
    v_mul_f32 v219, s41, v219
    v_cvt_pk_bf16_f32 v51, v218, v219
    ds_write_b128 v252, v[48:51] offset:4096
    buffer_load_dwordx4 v[80:83], v251, s[24:27], s28 offen offset:1024 nt
    s_waitcnt vmcnt(15)
    v_lshlrev_b32 v216, 16, v52
    v_and_b32 v217, 0xffff0000, v52
    v_mul_f32 v216, s41, v216
    v_mul_f32 v217, s41, v217
    v_cvt_pk_bf16_f32 v52, v216, v217
    v_lshlrev_b32 v218, 16, v53
    v_and_b32 v219, 0xffff0000, v53
    v_mul_f32 v218, s41, v218
    v_mul_f32 v219, s41, v219
    v_cvt_pk_bf16_f32 v53, v218, v219
    v_lshlrev_b32 v216, 16, v54
    v_and_b32 v217, 0xffff0000, v54
    v_mul_f32 v216, s41, v216
    v_mul_f32 v217, s41, v217
    v_cvt_pk_bf16_f32 v54, v216, v217
    v_lshlrev_b32 v218, 16, v55
    v_and_b32 v219, 0xffff0000, v55
    v_mul_f32 v218, s41, v218
    v_mul_f32 v219, s41, v219
    v_cvt_pk_bf16_f32 v55, v218, v219
    ds_write_b128 v252, v[52:55] offset:5120
    buffer_load_dwordx4 v[84:87], v251, s[24:27], s29 offen offset:1024 nt
    s_waitcnt vmcnt(15)
    v_lshlrev_b32 v216, 16, v56
    v_and_b32 v217, 0xffff0000, v56
    v_mul_f32 v216, s41, v216
    v_mul_f32 v217, s41, v217
    v_cvt_pk_bf16_f32 v56, v216, v217
    v_lshlrev_b32 v218, 16, v57
    v_and_b32 v219, 0xffff0000, v57
    v_mul_f32 v218, s41, v218
    v_mul_f32 v219, s41, v219
    v_cvt_pk_bf16_f32 v57, v218, v219
    v_lshlrev_b32 v216, 16, v58
    v_and_b32 v217, 0xffff0000, v58
    v_mul_f32 v216, s41, v216
    v_mul_f32 v217, s41, v217
    v_cvt_pk_bf16_f32 v58, v216, v217
    v_lshlrev_b32 v218, 16, v59
    v_and_b32 v219, 0xffff0000, v59
    v_mul_f32 v218, s41, v218
    v_mul_f32 v219, s41, v219
    v_cvt_pk_bf16_f32 v59, v218, v219
    ds_write_b128 v252, v[56:59] offset:6144
    buffer_load_dwordx4 v[88:91], v251, s[24:27], s30 offen offset:1024 nt
    s_waitcnt vmcnt(15)
    v_lshlrev_b32 v216, 16, v60
    v_and_b32 v217, 0xffff0000, v60
    v_mul_f32 v216, s41, v216
    v_mul_f32 v217, s41, v217
    v_cvt_pk_bf16_f32 v60, v216, v217
    v_lshlrev_b32 v218, 16, v61
    v_and_b32 v219, 0xffff0000, v61
    v_mul_f32 v218, s41, v218
    v_mul_f32 v219, s41, v219
    v_cvt_pk_bf16_f32 v61, v218, v219
    v_lshlrev_b32 v216, 16, v62
    v_and_b32 v217, 0xffff0000, v62
    v_mul_f32 v216, s41, v216
    v_mul_f32 v217, s41, v217
    v_cvt_pk_bf16_f32 v62, v216, v217
    v_lshlrev_b32 v218, 16, v63
    v_and_b32 v219, 0xffff0000, v63
    v_mul_f32 v218, s41, v218
    v_mul_f32 v219, s41, v219
    v_cvt_pk_bf16_f32 v63, v218, v219
    ds_write_b128 v252, v[60:63] offset:7168
    buffer_load_dwordx4 v[92:95], v251, s[24:27], s31 offen offset:1024 nt
    s_waitcnt lgkmcnt(0)
    s_nop 0
    s_branch L_c0_e
L_c0_v:
    v_add_u32 v252, s46, v241
    s_waitcnt vmcnt(8)
    v_perm_b32 v216, v36, v32, s42
    v_perm_b32 v217, v44, v40, s42
    v_perm_b32 v218, v52, v48, s42
    v_perm_b32 v219, v60, v56, s42
    ds_write_b128 v252, v[216:219] offset:0
    v_pk_maximum3_f16 v254, v32, v33, v34
    v_pk_minimum3_f16 v255, v32, v33, v34
    v_pk_maximum3_f16 v254, v254, v35, v35
    v_pk_minimum3_f16 v255, v255, v35, v35
    s_bfe_u32 s45, s44, 0x30004
    s_add_u32 s45, s45, s68
    s_and_b32 s45, s45, 7
    s_lshl_b32 s28, s45, 13
    s_bitcmp1_b32 s44, 7
    s_cselect_b64 s[24:25], s[22:23], s[20:21]
    s_cselect_b32 s45, 256, 64
    s_cselect_b64 vcc, -1, 0
    s_add_u32 s29, s28, s45
    v_cndmask_b32 v251, v249, v250, vcc
    s_add_u32 s30, s29, s45
    s_add_u32 s31, s30, s45
    buffer_load_dwordx4 v[64:67], v251, s[24:27], s28 offen offset:0 nt
    v_perm_b32 v216, v36, v32, s43
    v_perm_b32 v217, v44, v40, s43
    v_perm_b32 v218, v52, v48, s43
    v_perm_b32 v219, v60, v56, s43
    ds_write_b128 v252, v[216:219] offset:1024
    v_pk_maximum3_f16 v254, v254, v36, v37
    v_pk_minimum3_f16 v255, v255, v36, v37
    v_pk_maximum3_f16 v254, v254, v38, v39
    v_pk_minimum3_f16 v255, v255, v38, v39
    buffer_load_dwordx4 v[68:71], v251, s[24:27], s29 offen offset:0 nt
    v_perm_b32 v216, v37, v33, s42
    v_perm_b32 v217, v45, v41, s42
    v_perm_b32 v218, v53, v49, s42
    v_perm_b32 v219, v61, v57, s42
    ds_write_b128 v252, v[216:219] offset:2048
    v_pk_maximum3_f16 v254, v254, v40, v41
    v_pk_minimum3_f16 v255, v255, v40, v41
    v_pk_maximum3_f16 v254, v254, v42, v43
    v_pk_minimum3_f16 v255, v255, v42, v43
    buffer_load_dwordx4 v[72:75], v251, s[24:27], s30 offen offset:0 nt
    v_perm_b32 v216, v37, v33, s43
    v_perm_b32 v217, v45, v41, s43
    v_perm_b32 v218, v53, v49, s43
    v_perm_b32 v219, v61, v57, s43
    ds_write_b128 v252, v[216:219] offset:3072
    v_pk_maximum3_f16 v254, v254, v44, v45
    v_pk_minimum3_f16 v255, v255, v44, v45
    v_pk_maximum3_f16 v254, v254, v46, v47
    v_pk_minimum3_f16 v255, v255, v46, v47
    buffer_load_dwordx4 v[76:79], v251, s[24:27], s31 offen offset:0 nt
    v_perm_b32 v216, v38, v34, s42
    v_perm_b32 v217, v46, v42, s42
    v_perm_b32 v218, v54, v50, s42
    v_perm_b32 v219, v62, v58, s42
    ds_write_b128 v252, v[216:219] offset:4096
    v_pk_maximum3_f16 v254, v254, v48, v49
    v_pk_minimum3_f16 v255, v255, v48, v49
    v_pk_maximum3_f16 v254, v254, v50, v51
    v_pk_minimum3_f16 v255, v255, v50, v51
    buffer_load_dwordx4 v[80:83], v251, s[24:27], s28 offen offset:1024 nt
    v_perm_b32 v216, v38, v34, s43
    v_perm_b32 v217, v46, v42, s43
    v_perm_b32 v218, v54, v50, s43
    v_perm_b32 v219, v62, v58, s43
    ds_write_b128 v252, v[216:219] offset:5120
    v_pk_maximum3_f16 v254, v254, v52, v53
    v_pk_minimum3_f16 v255, v255, v52, v53
    v_pk_maximum3_f16 v254, v254, v54, v55
    v_pk_minimum3_f16 v255, v255, v54, v55
    buffer_load_dwordx4 v[84:87], v251, s[24:27], s29 offen offset:1024 nt
    v_perm_b32 v216, v39, v35, s42
    v_perm_b32 v217, v47, v43, s42
    v_perm_b32 v218, v55, v51, s42
    v_perm_b32 v219, v63, v59, s42
    ds_write_b128 v252, v[216:219] offset:6144
    v_pk_maximum3_f16 v254, v254, v56, v57
    v_pk_minimum3_f16 v255, v255, v56, v57
    v_pk_maximum3_f16 v254, v254, v58, v59
    v_pk_minimum3_f16 v255, v255, v58, v59
    buffer_load_dwordx4 v[88:91], v251, s[24:27], s30 offen offset:1024 nt
    v_perm_b32 v216, v39, v35, s43
    v_perm_b32 v217, v47, v43, s43
    v_perm_b32 v218, v55, v51, s43
    v_perm_b32 v219, v63, v59, s43
    ds_write_b128 v252, v[216:219] offset:7168
    v_pk_maximum3_f16 v254, v254, v60, v61
    v_pk_minimum3_f16 v255, v255, v60, v61
    v_pk_maximum3_f16 v254, v254, v62, v63
    v_pk_minimum3_f16 v255, v255, v62, v63
    v_and_b32 v254, 0x7fff7fff, v254
    v_and_b32 v255, 0x7fff7fff, v255
    v_pk_max_u16 v254, v254, v255
    v_pk_max_u16 v253, v253, v254
    buffer_load_dwordx4 v[92:95], v251, s[24:27], s31 offen offset:1024 nt
    s_waitcnt lgkmcnt(0)
    s_nop 0
L_c0_e:
    s_barrier
    ds_read_b128 a[128:131], v240 offset:0
    ds_read_b128 a[132:135], v240 offset:1024
    ds_read_b128 a[136:139], v240 offset:2048
    ds_read_b128 a[140:143], v240 offset:3072
    ds_read_b128 a[144:147], v240 offset:4096
    ds_read_b128 a[148:151], v240 offset:5120
    ds_read_b128 a[152:155], v240 offset:6144
    s_waitcnt vmcnt(12) lgkmcnt(3)
    v_mfma_f32_16x16x32_bf16 v[160:163], a[128:131], a[0:3], 0
    ds_read_b128 a[156:159], v240 offset:7168
    v_mfma_f32_16x16x32_bf16 v[160:163], a[132:135], a[4:7], v[160:163]
    ds_read_b128 a[128:131], v240 offset:8192
    v_mfma_f32_16x16x32_bf16 v[160:163], a[136:139], a[8:11], v[160:163]
    ds_read_b128 a[132:135], v240 offset:9216
    v_mfma_f32_16x16x32_bf16 v[160:163], a[140:143], a[12:15], v[160:163]
    ds_read_b128 a[136:139], v240 offset:10240
    buffer_load_dwordx4 a[32:35], v243, s[12:15], s54 offen offset:0 nt
    s_waitcnt lgkmcnt(3)
    v_mfma_f32_16x16x32_bf16 v[164:167], a[144:147], a[0:3], 0
    ds_read_b128 a[140:143], v240 offset:11264
    v_mfma_f32_16x16x32_bf16 v[164:167], a[148:151], a[4:7], v[164:167]
    ds_read_b128 a[144:147], v240 offset:12288
    v_mfma_f32_16x16x32_bf16 v[164:167], a[152:155], a[8:11], v[164:167]
    ds_read_b128 a[148:151], v240 offset:13312
    v_mfma_f32_16x16x32_bf16 v[164:167], a[156:159], a[12:15], v[164:167]
    ds_read_b128 a[152:155], v240 offset:14336
    s_waitcnt lgkmcnt(3)
    v_mfma_f32_16x16x32_bf16 v[192:195], a[128:131], a[0:3], 0
    v_exp_f32 v160, v160
    ds_read_b128 a[156:159], v240 offset:15360
    v_mfma_f32_16x16x32_bf16 v[192:195], a[132:135], a[4:7], v[192:195]
    ds_read_b128 a[128:131], v241 offset:0
    buffer_load_dwordx4 a[36:39], v243, s[12:15], s54 offen offset:64 nt
    v_mfma_f32_16x16x32_bf16 v[192:195], a[136:139], a[8:11], v[192:195]
    v_exp_f32 v161, v161
    ds_read_b128 a[132:135], v241 offset:1024
    v_mfma_f32_16x16x32_bf16 v[192:195], a[140:143], a[12:15], v[192:195]
    ds_read_b128 a[136:139], v241 offset:2048
    s_waitcnt lgkmcnt(3)
    v_mfma_f32_16x16x32_bf16 v[196:199], a[144:147], a[0:3], 0
    v_exp_f32 v162, v162
    ds_read_b128 a[140:143], v241 offset:3072
    v_mfma_f32_16x16x32_bf16 v[196:199], a[148:151], a[4:7], v[196:199]
    v_exp_f32 v163, v163
    v_exp_f32 v164, v164
    v_exp_f32 v165, v165
    v_exp_f32 v166, v166
    v_exp_f32 v167, v167
    ds_read_b128 a[144:147], v241 offset:4096
    v_mfma_f32_16x16x32_bf16 v[196:199], a[152:155], a[8:11], v[196:199]
    ds_read_b128 a[148:151], v241 offset:5120
    v_cvt_pk_bf16_f32 v224, v160, v161
    v_cvt_pk_bf16_f32 v225, v162, v163
    v_cvt_pk_bf16_f32 v226, v164, v165
    v_cvt_pk_bf16_f32 v227, v166, v167
    v_mfma_f32_16x16x32_bf16 v[196:199], a[156:159], a[12:15], v[196:199]
    v_exp_f32 v192, v192
    ds_read_b128 a[152:155], v241 offset:6144
    v_smfmac_f32_16x16x64_bf16 a[192:195], a[212:215], v[224:231], v247
    buffer_load_dwordx4 a[40:43], v243, s[12:15], s54 offen offset:128 nt
    s_waitcnt lgkmcnt(3)
    v_mfma_f32_16x16x32_bf16 v[0:3], v[224:227], a[128:131], 0
    v_exp_f32 v193, v193
    ds_read_b128 a[156:159], v241 offset:7168
    v_mfma_f32_16x16x32_bf16 v[4:7], v[224:227], a[132:135], 0
    ds_read_b128 a[128:131], v240 offset:16384
    v_mfma_f32_16x16x32_bf16 v[8:11], v[224:227], a[136:139], 0
    v_exp_f32 v194, v194
    ds_read_b128 a[132:135], v240 offset:17408
    v_mfma_f32_16x16x32_bf16 v[12:15], v[224:227], a[140:143], 0
    ds_read_b128 a[136:139], v240 offset:18432
    s_waitcnt lgkmcnt(3)
    v_mfma_f32_16x16x32_bf16 v[16:19], v[224:227], a[144:147], 0
    v_exp_f32 v195, v195
    ds_read_b128 a[140:143], v240 offset:19456
    v_mfma_f32_16x16x32_bf16 v[20:23], v[224:227], a[148:151], 0
    ds_read_b128 a[144:147], v240 offset:20480
    buffer_load_dwordx4 a[44:47], v243, s[12:15], s54 offen offset:192 nt
    v_mfma_f32_16x16x32_bf16 v[24:27], v[224:227], a[152:155], 0
    v_exp_f32 v196, v196
    ds_read_b128 a[148:151], v240 offset:21504
    v_mfma_f32_16x16x32_bf16 v[28:31], v[224:227], a[156:159], 0
    ds_read_b128 a[152:155], v240 offset:22528
    s_waitcnt vmcnt(12) lgkmcnt(3)
    v_mfma_f32_16x16x32_bf16 v[160:163], a[128:131], a[0:3], 0
    v_exp_f32 v197, v197
    v_mfma_f32_16x16x32_bf16 v[168:171], a[128:131], a[16:19], 0
    ds_read_b128 a[156:159], v240 offset:23552
    v_cvt_pk_bf16_f32 v224, v192, v193
    v_mfma_f32_16x16x32_bf16 v[160:163], a[132:135], a[4:7], v[160:163]
    v_exp_f32 v198, v198
    v_mfma_f32_16x16x32_bf16 v[168:171], a[132:135], a[20:23], v[168:171]
    v_cvt_pk_bf16_f32 v225, v194, v195
    v_cvt_pk_bf16_f32 v226, v196, v197
    v_mfma_f32_16x16x32_bf16 v[160:163], a[136:139], a[8:11], v[160:163]
    v_exp_f32 v199, v199
    s_bfe_u32 s45, s44, 0x30008
    s_add_u32 s45, s45, s68
    s_and_b32 s45, s45, 7
    s_lshl_b32 s28, s45, 13
    s_bitcmp1_b32 s44, 11
    s_cselect_b64 s[24:25], s[22:23], s[20:21]
    s_cselect_b32 s45, 256, 64
    s_cselect_b64 vcc, -1, 0
    s_add_u32 s29, s28, s45
    v_cndmask_b32 v251, v249, v250, vcc
    s_add_u32 s30, s29, s45
    s_add_u32 s31, s30, s45
    buffer_load_dwordx4 v[96:99], v251, s[24:27], s28 offen offset:0 nt
    v_mfma_f32_16x16x32_bf16 v[168:171], a[136:139], a[24:27], v[168:171]
    v_cvt_pk_bf16_f32 v227, v198, v199
    v_mfma_f32_16x16x32_bf16 v[160:163], a[140:143], a[12:15], v[160:163]
    v_mfma_f32_16x16x32_bf16 v[168:171], a[140:143], a[28:31], v[168:171]
    s_waitcnt lgkmcnt(0)
    v_mfma_f32_16x16x32_bf16 v[164:167], a[144:147], a[0:3], 0
    v_mfma_f32_16x16x32_bf16 v[172:175], a[144:147], a[16:19], 0
    v_mfma_f32_16x16x32_bf16 v[164:167], a[148:151], a[4:7], v[164:167]
    s_nop 2
    v_exp_f32 v160, v160
    buffer_load_dwordx4 v[100:103], v251, s[24:27], s29 offen offset:0 nt
    v_mfma_f32_16x16x32_bf16 v[172:175], a[148:151], a[20:23], v[172:175]
    v_exp_f32 v161, v161
    v_mfma_f32_16x16x32_bf16 v[164:167], a[152:155], a[8:11], v[164:167]
    v_exp_f32 v162, v162
    v_mfma_f32_16x16x32_bf16 v[172:175], a[152:155], a[24:27], v[172:175]
    v_exp_f32 v163, v163
    v_mfma_f32_16x16x32_bf16 v[164:167], a[156:159], a[12:15], v[164:167]
    v_exp_f32 v168, v168
    v_mfma_f32_16x16x32_bf16 v[172:175], a[156:159], a[28:31], v[172:175]
    v_exp_f32 v169, v169
    v_exp_f32 v170, v170
    v_exp_f32 v171, v171
    s_bfe_u32 s46, s44, 0x30004
    s_lshl_b32 s46, s46, 13
    s_bitcmp1_b32 s44, 7
    s_cbranch_scc1 L_c1_v
    v_add_u32 v252, s46, v240
    s_waitcnt vmcnt(13)
    v_lshlrev_b32 v216, 16, v64
    v_and_b32 v217, 0xffff0000, v64
    v_mul_f32 v216, s41, v216
    v_mul_f32 v217, s41, v217
    v_cvt_pk_bf16_f32 v64, v216, v217
    v_lshlrev_b32 v218, 16, v65
    v_and_b32 v219, 0xffff0000, v65
    v_mul_f32 v218, s41, v218
    v_mul_f32 v219, s41, v219
    v_cvt_pk_bf16_f32 v65, v218, v219
    v_lshlrev_b32 v216, 16, v66
    v_and_b32 v217, 0xffff0000, v66
    v_mul_f32 v216, s41, v216
    v_mul_f32 v217, s41, v217
    v_cvt_pk_bf16_f32 v66, v216, v217
    v_lshlrev_b32 v218, 16, v67
    v_and_b32 v219, 0xffff0000, v67
    v_mul_f32 v218, s41, v218
    v_mul_f32 v219, s41, v219
    v_cvt_pk_bf16_f32 v67, v218, v219
    ds_write_b128 v252, v[64:67] offset:0
    buffer_load_dwordx4 v[104:107], v251, s[24:27], s30 offen offset:0 nt
    s_waitcnt vmcnt(13)
    v_lshlrev_b32 v216, 16, v68
    v_and_b32 v217, 0xffff0000, v68
    v_mul_f32 v216, s41, v216
    v_mul_f32 v217, s41, v217
    v_cvt_pk_bf16_f32 v68, v216, v217
    v_lshlrev_b32 v218, 16, v69
    v_and_b32 v219, 0xffff0000, v69
    v_mul_f32 v218, s41, v218
    v_mul_f32 v219, s41, v219
    v_cvt_pk_bf16_f32 v69, v218, v219
    v_lshlrev_b32 v216, 16, v70
    v_and_b32 v217, 0xffff0000, v70
    v_mul_f32 v216, s41, v216
    v_mul_f32 v217, s41, v217
    v_cvt_pk_bf16_f32 v70, v216, v217
    v_lshlrev_b32 v218, 16, v71
    v_and_b32 v219, 0xffff0000, v71
    v_mul_f32 v218, s41, v218
    v_mul_f32 v219, s41, v219
    v_cvt_pk_bf16_f32 v71, v218, v219
    ds_write_b128 v252, v[68:71] offset:1024
    buffer_load_dwordx4 v[108:111], v251, s[24:27], s31 offen offset:0 nt
    s_waitcnt vmcnt(13)
    v_lshlrev_b32 v216, 16, v72
    v_and_b32 v217, 0xffff0000, v72
    v_mul_f32 v216, s41, v216
    v_mul_f32 v217, s41, v217
    v_cvt_pk_bf16_f32 v72, v216, v217
    v_lshlrev_b32 v218, 16, v73
    v_and_b32 v219, 0xffff0000, v73
    v_mul_f32 v218, s41, v218
    v_mul_f32 v219, s41, v219
    v_cvt_pk_bf16_f32 v73, v218, v219
    v_lshlrev_b32 v216, 16, v74
    v_and_b32 v217, 0xffff0000, v74
    v_mul_f32 v216, s41, v216
    v_mul_f32 v217, s41, v217
    v_cvt_pk_bf16_f32 v74, v216, v217
    v_lshlrev_b32 v218, 16, v75
    v_and_b32 v219, 0xffff0000, v75
    v_mul_f32 v218, s41, v218
    v_mul_f32 v219, s41, v219
    v_cvt_pk_bf16_f32 v75, v218, v219
    ds_write_b128 v252, v[72:75] offset:2048
    buffer_load_dwordx4 v[112:115], v251, s[24:27], s28 offen offset:1024 nt
    s_waitcnt vmcnt(13)
    v_lshlrev_b32 v216, 16, v76
    v_and_b32 v217, 0xffff0000, v76
    v_mul_f32 v216, s41, v216
    v_mul_f32 v217, s41, v217
    v_cvt_pk_bf16_f32 v76, v216, v217
    v_lshlrev_b32 v218, 16, v77
    v_and_b32 v219, 0xffff0000, v77
    v_mul_f32 v218, s41, v218
    v_mul_f32 v219, s41, v219
    v_cvt_pk_bf16_f32 v77, v218, v219
    v_lshlrev_b32 v216, 16, v78
    v_and_b32 v217, 0xffff0000, v78
    v_mul_f32 v216, s41, v216
    v_mul_f32 v217, s41, v217
    v_cvt_pk_bf16_f32 v78, v216, v217
    v_lshlrev_b32 v218, 16, v79
    v_and_b32 v219, 0xffff0000, v79
    v_mul_f32 v218, s41, v218
    v_mul_f32 v219, s41, v219
    v_cvt_pk_bf16_f32 v79, v218, v219
    ds_write_b128 v252, v[76:79] offset:3072
    s_waitcnt vmcnt(12)
    v_lshlrev_b32 v216, 16, v80
    v_and_b32 v217, 0xffff0000, v80
    v_mul_f32 v216, s41, v216
    v_mul_f32 v217, s41, v217
    v_cvt_pk_bf16_f32 v80, v216, v217
    v_lshlrev_b32 v218, 16, v81
    v_and_b32 v219, 0xffff0000, v81
    v_mul_f32 v218, s41, v218
    v_mul_f32 v219, s41, v219
    v_cvt_pk_bf16_f32 v81, v218, v219
    v_lshlrev_b32 v216, 16, v82
    v_and_b32 v217, 0xffff0000, v82
    v_mul_f32 v216, s41, v216
    v_mul_f32 v217, s41, v217
    v_cvt_pk_bf16_f32 v82, v216, v217
    v_lshlrev_b32 v218, 16, v83
    v_and_b32 v219, 0xffff0000, v83
    v_mul_f32 v218, s41, v218
    v_mul_f32 v219, s41, v219
    v_cvt_pk_bf16_f32 v83, v218, v219
    ds_write_b128 v252, v[80:83] offset:4096
    buffer_load_dwordx4 v[116:119], v251, s[24:27], s29 offen offset:1024 nt
    s_waitcnt vmcnt(12)
    v_lshlrev_b32 v216, 16, v84
    v_and_b32 v217, 0xffff0000, v84
    v_mul_f32 v216, s41, v216
    v_mul_f32 v217, s41, v217
    v_cvt_pk_bf16_f32 v84, v216, v217
    v_lshlrev_b32 v218, 16, v85
    v_and_b32 v219, 0xffff0000, v85
    v_mul_f32 v218, s41, v218
    v_mul_f32 v219, s41, v219
    v_cvt_pk_bf16_f32 v85, v218, v219
    v_lshlrev_b32 v216, 16, v86
    v_and_b32 v217, 0xffff0000, v86
    v_mul_f32 v216, s41, v216
    v_mul_f32 v217, s41, v217
    v_cvt_pk_bf16_f32 v86, v216, v217
    v_lshlrev_b32 v218, 16, v87
    v_and_b32 v219, 0xffff0000, v87
    v_mul_f32 v218, s41, v218
    v_mul_f32 v219, s41, v219
    v_cvt_pk_bf16_f32 v87, v218, v219
    ds_write_b128 v252, v[84:87] offset:5120
    buffer_load_dwordx4 v[120:123], v251, s[24:27], s30 offen offset:1024 nt
    s_waitcnt vmcnt(12)
    v_lshlrev_b32 v216, 16, v88
    v_and_b32 v217, 0xffff0000, v88
    v_mul_f32 v216, s41, v216
    v_mul_f32 v217, s41, v217
    v_cvt_pk_bf16_f32 v88, v216, v217
    v_lshlrev_b32 v218, 16, v89
    v_and_b32 v219, 0xffff0000, v89
    v_mul_f32 v218, s41, v218
    v_mul_f32 v219, s41, v219
    v_cvt_pk_bf16_f32 v89, v218, v219
    v_lshlrev_b32 v216, 16, v90
    v_and_b32 v217, 0xffff0000, v90
    v_mul_f32 v216, s41, v216
    v_mul_f32 v217, s41, v217
    v_cvt_pk_bf16_f32 v90, v216, v217
    v_lshlrev_b32 v218, 16, v91
    v_and_b32 v219, 0xffff0000, v91
    v_mul_f32 v218, s41, v218
    v_mul_f32 v219, s41, v219
    v_cvt_pk_bf16_f32 v91, v218, v219
    ds_write_b128 v252, v[88:91] offset:6144
    buffer_load_dwordx4 v[124:127], v251, s[24:27], s31 offen offset:1024 nt
    s_waitcnt vmcnt(12)
    v_lshlrev_b32 v216, 16, v92
    v_and_b32 v217, 0xffff0000, v92
    v_mul_f32 v216, s41, v216
    v_mul_f32 v217, s41, v217
    v_cvt_pk_bf16_f32 v92, v216, v217
    v_lshlrev_b32 v218, 16, v93
    v_and_b32 v219, 0xffff0000, v93
    v_mul_f32 v218, s41, v218
    v_mul_f32 v219, s41, v219
    v_cvt_pk_bf16_f32 v93, v218, v219
    v_lshlrev_b32 v216, 16, v94
    v_and_b32 v217, 0xffff0000, v94
    v_mul_f32 v216, s41, v216
    v_mul_f32 v217, s41, v217
    v_cvt_pk_bf16_f32 v94, v216, v217
    v_lshlrev_b32 v218, 16, v95
    v_and_b32 v219, 0xffff0000, v95
    v_mul_f32 v218, s41, v218
    v_mul_f32 v219, s41, v219
    v_cvt_pk_bf16_f32 v95, v218, v219
    ds_write_b128 v252, v[92:95] offset:7168
    s_waitcnt lgkmcnt(0)
    s_nop 0
    s_branch L_c1_e
L_c1_v:
    v_add_u32 v252, s46, v241
    s_waitcnt vmcnt(6)
    v_perm_b32 v216, v68, v64, s42
    v_perm_b32 v217, v76, v72, s42
    v_perm_b32 v218, v84, v80, s42
    v_perm_b32 v219, v92, v88, s42
    ds_write_b128 v252, v[216:219] offset:0
    v_pk_maximum3_f16 v254, v64, v65, v66
    v_pk_minimum3_f16 v255, v64, v65, v66
    v_pk_maximum3_f16 v254, v254, v67, v67
    v_pk_minimum3_f16 v255, v255, v67, v67
    buffer_load_dwordx4 v[104:107], v251, s[24:27], s30 offen offset:0 nt
    v_perm_b32 v216, v68, v64, s43
    v_perm_b32 v217, v76, v72, s43
    v_perm_b32 v218, v84, v80, s43
    v_perm_b32 v219, v92, v88, s43
    ds_write_b128 v252, v[216:219] offset:1024
    v_pk_maximum3_f16 v254, v254, v68, v69
    v_pk_minimum3_f16 v255, v255, v68, v69
    v_pk_maximum3_f16 v254, v254, v70, v71
    v_pk_minimum3_f16 v255, v255, v70, v71
    buffer_load_dwordx4 v[108:111], v251, s[24:27], s31 offen offset:0 nt
    v_perm_b32 v216, v69, v65, s42
    v_perm_b32 v217, v77, v73, s42
    v_perm_b32 v218, v85, v81, s42
    v_perm_b32 v219, v93, v89, s42
    ds_write_b128 v252, v[216:219] offset:2048
    v_pk_maximum3_f16 v254, v254, v72, v73
    v_pk_minimum3_f16 v255, v255, v72, v73
    v_pk_maximum3_f16 v254, v254, v74, v75
    v_pk_minimum3_f16 v255, v255, v74, v75
    buffer_load_dwordx4 v[112:115], v251, s[24:27], s28 offen offset:1024 nt
    v_perm_b32 v216, v69, v65, s43
    v_perm_b32 v217, v77, v73, s43
    v_perm_b32 v218, v85, v81, s43
    v_perm_b32 v219, v93, v89, s43
    ds_write_b128 v252, v[216:219] offset:3072
    v_pk_maximum3_f16 v254, v254, v76, v77
    v_pk_minimum3_f16 v255, v255, v76, v77
    v_pk_maximum3_f16 v254, v254, v78, v79
    v_pk_minimum3_f16 v255, v255, v78, v79
    v_perm_b32 v216, v70, v66, s42
    v_perm_b32 v217, v78, v74, s42
    v_perm_b32 v218, v86, v82, s42
    v_perm_b32 v219, v94, v90, s42
    ds_write_b128 v252, v[216:219] offset:4096
    v_pk_maximum3_f16 v254, v254, v80, v81
    v_pk_minimum3_f16 v255, v255, v80, v81
    v_pk_maximum3_f16 v254, v254, v82, v83
    v_pk_minimum3_f16 v255, v255, v82, v83
    buffer_load_dwordx4 v[116:119], v251, s[24:27], s29 offen offset:1024 nt
    v_perm_b32 v216, v70, v66, s43
    v_perm_b32 v217, v78, v74, s43
    v_perm_b32 v218, v86, v82, s43
    v_perm_b32 v219, v94, v90, s43
    ds_write_b128 v252, v[216:219] offset:5120
    v_pk_maximum3_f16 v254, v254, v84, v85
    v_pk_minimum3_f16 v255, v255, v84, v85
    v_pk_maximum3_f16 v254, v254, v86, v87
    v_pk_minimum3_f16 v255, v255, v86, v87
    buffer_load_dwordx4 v[120:123], v251, s[24:27], s30 offen offset:1024 nt
    v_perm_b32 v216, v71, v67, s42
    v_perm_b32 v217, v79, v75, s42
    v_perm_b32 v218, v87, v83, s42
    v_perm_b32 v219, v95, v91, s42
    ds_write_b128 v252, v[216:219] offset:6144
    v_pk_maximum3_f16 v254, v254, v88, v89
    v_pk_minimum3_f16 v255, v255, v88, v89
    v_pk_maximum3_f16 v254, v254, v90, v91
    v_pk_minimum3_f16 v255, v255, v90, v91
    buffer_load_dwordx4 v[124:127], v251, s[24:27], s31 offen offset:1024 nt
    v_perm_b32 v216, v71, v67, s43
    v_perm_b32 v217, v79, v75, s43
    v_perm_b32 v218, v87, v83, s43
    v_perm_b32 v219, v95, v91, s43
    ds_write_b128 v252, v[216:219] offset:7168
    v_pk_maximum3_f16 v254, v254, v92, v93
    v_pk_minimum3_f16 v255, v255, v92, v93
    v_pk_maximum3_f16 v254, v254, v94, v95
    v_pk_minimum3_f16 v255, v255, v94, v95
    v_and_b32 v254, 0x7fff7fff, v254
    v_and_b32 v255, 0x7fff7fff, v255
    v_pk_max_u16 v254, v254, v255
    v_pk_max_u16 v253, v253, v254
    s_waitcnt lgkmcnt(0)
    s_nop 0
L_c1_e:
    s_barrier
    ds_read_b128 a[128:131], v241 offset:8192
    ds_read_b128 a[132:135], v241 offset:9216
    ds_read_b128 a[136:139], v241 offset:10240
    ds_read_b128 a[140:143], v241 offset:11264
    ds_read_b128 a[144:147], v241 offset:12288
    ds_read_b128 a[148:151], v241 offset:13312
    ds_read_b128 a[152:155], v241 offset:14336
    v_smfmac_f32_16x16x64_bf16 a[192:195], a[212:215], v[224:231], v247
    v_cvt_pk_bf16_f32 v228, v168, v169
    s_waitcnt lgkmcnt(3)
    v_mfma_f32_16x16x32_bf16 v[0:3], v[224:227], a[128:131], v[0:3]
    ds_read_b128 a[156:159], v241 offset:15360
    v_cvt_pk_bf16_f32 v229, v170, v171
    v_mfma_f32_16x16x32_bf16 v[4:7], v[224:227], a[132:135], v[4:7]
    v_exp_f32 v164, v164
    ds_read_b128 a[128:131], v240 offset:24576
    v_mfma_f32_16x16x32_bf16 v[8:11], v[224:227], a[136:139], v[8:11]
    ds_read_b128 a[132:135], v240 offset:25600
    v_mfma_f32_16x16x32_bf16 v[12:15], v[224:227], a[140:143], v[12:15]
    ds_read_b128 a[136:139], v240 offset:26624
    s_waitcnt lgkmcnt(3)
    v_mfma_f32_16x16x32_bf16 v[16:19], v[224:227], a[144:147], v[16:19]
    v_exp_f32 v165, v165
    ds_read_b128 a[140:143], v240 offset:27648
    buffer_load_dwordx4 a[48:51], v243, s[12:15], s55 offen offset:0 nt
    v_mfma_f32_16x16x32_bf16 v[20:23], v[224:227], a[148:151], v[20:23]
    ds_read_b128 a[144:147], v240 offset:28672
    v_accvgpr_write_b32 a194, 0
    v_mfma_f32_16x16x32_bf16 v[24:27], v[224:227], a[152:155], v[24:27]
    v_exp_f32 v166, v166
    ds_read_b128 a[148:151], v240 offset:29696
    v_mfma_f32_16x16x32_bf16 v[28:31], v[224:227], a[156:159], v[28:31]
    ds_read_b128 a[152:155], v240 offset:30720
    s_waitcnt lgkmcnt(3)
    v_mfma_f32_16x16x32_bf16 v[192:195], a[128:131], a[0:3], 0
    v_exp_f32 v167, v167
    v_mfma_f32_16x16x32_bf16 v[200:203], a[128:131], a[16:19], 0
    ds_read_b128 a[156:159], v240 offset:31744
    v_accvgpr_write_b32 a195, 0
    v_mfma_f32_16x16x32_bf16 v[192:195], a[132:135], a[4:7], v[192:195]
    v_exp_f32 v172, v172
    v_mfma_f32_16x16x32_bf16 v[200:203], a[132:135], a[20:23], v[200:203]
    ds_read_b128 a[128:131], v241 offset:16384
    v_cvt_pk_bf16_f32 v224, v160, v161
    v_mfma_f32_16x16x32_bf16 v[192:195], a[136:139], a[8:11], v[192:195]
    v_exp_f32 v173, v173
    v_mfma_f32_16x16x32_bf16 v[200:203], a[136:139], a[24:27], v[200:203]
    ds_read_b128 a[132:135], v241 offset:17408
    v_cvt_pk_bf16_f32 v225, v162, v163
    v_mfma_f32_16x16x32_bf16 v[192:195], a[140:143], a[12:15], v[192:195]
    v_exp_f32 v174, v174
    v_mfma_f32_16x16x32_bf16 v[200:203], a[140:143], a[28:31], v[200:203]
    ds_read_b128 a[136:139], v241 offset:18432
    buffer_load_dwordx4 a[52:55], v243, s[12:15], s55 offen offset:64 nt
    s_waitcnt lgkmcnt(3)
    v_mfma_f32_16x16x32_bf16 v[196:199], a[144:147], a[0:3], 0
    v_exp_f32 v175, v175
    v_mfma_f32_16x16x32_bf16 v[204:207], a[144:147], a[16:19], 0
    ds_read_b128 a[140:143], v241 offset:19456
    v_cvt_pk_bf16_f32 v226, v164, v165
    v_mfma_f32_16x16x32_bf16 v[196:199], a[148:151], a[4:7], v[196:199]
    v_exp_f32 v192, v192
    v_mfma_f32_16x16x32_bf16 v[204:207], a[148:151], a[20:23], v[204:207]
    ds_read_b128 a[144:147], v241 offset:20480
    v_cvt_pk_bf16_f32 v227, v166, v167
    v_mfma_f32_16x16x32_bf16 v[196:199], a[152:155], a[8:11], v[196:199]
    v_exp_f32 v193, v193
    v_mfma_f32_16x16x32_bf16 v[204:207], a[152:155], a[24:27], v[204:207]
    ds_read_b128 a[148:151], v241 offset:21504
    v_cvt_pk_bf16_f32 v230, v172, v173
    v_mfma_f32_16x16x32_bf16 v[196:199], a[156:159], a[12:15], v[196:199]
    v_exp_f32 v194, v194
    v_cvt_pk_bf16_f32 v231, v174, v175
    v_mfma_f32_16x16x32_bf16 v[204:207], a[156:159], a[28:31], v[204:207]
    ds_read_b128 a[152:155], v241 offset:22528
    v_smfmac_f32_16x16x64_bf16 a[192:195], a[212:215], v[224:231], v247
    s_waitcnt lgkmcnt(3)
    v_mfma_f32_16x16x32_bf16 v[0:3], v[224:227], a[128:131], v[0:3]
    v_exp_f32 v195, v195
    buffer_load_dwordx4 a[56:59], v243, s[12:15], s55 offen offset:128 nt
    v_mfma_f32_16x16x32_bf16 v[32:35], v[228:231], a[128:131], 0
    ds_read_b128 a[156:159], v241 offset:23552
    v_mfma_f32_16x16x32_bf16 v[4:7], v[224:227], a[132:135], v[4:7]
    v_exp_f32 v200, v200
    v_mfma_f32_16x16x32_bf16 v[36:39], v[228:231], a[132:135], 0
    ds_read_b128 a[128:131], v240 offset:32768
    v_mfma_f32_16x16x32_bf16 v[8:11], v[224:227], a[136:139], v[8:11]
    v_exp_f32 v201, v201
    v_mfma_f32_16x16x32_bf16 v[40:43], v[228:231], a[136:139], 0
    ds_read_b128 a[132:135], v240 offset:33792
    v_mfma_f32_16x16x32_bf16 v[12:15], v[224:227], a[140:143], v[12:15]
    v_exp_f32 v202, v202
    v_mfma_f32_16x16x32_bf16 v[44:47], v[228:231], a[140:143], 0
    ds_read_b128 a[136:139], v240 offset:34816
    s_waitcnt lgkmcnt(3)
    v_mfma_f32_16x16x32_bf16 v[16:19], v[224:227], a[144:147], v[16:19]
    v_exp_f32 v203, v203
    v_mfma_f32_16x16x32_bf16 v[48:51], v[228:231], a[144:147], 0
    ds_read_b128 a[252:255], v240 offset:35840
    v_mfma_f32_16x16x32_bf16 v[20:23], v[224:227], a[148:151], v[20:23]
    v_exp_f32 v196, v196
    v_mfma_f32_16x16x32_bf16 v[52:55], v[228:231], a[148:151], 0
    ds_read_b128 a[248:251], v240 offset:36864
    buffer_load_dwordx4 a[60:63], v243, s[12:15], s55 offen offset:192 nt
    v_mfma_f32_16x16x32_bf16 v[24:27], v[224:227], a[152:155], v[24:27]
    v_exp_f32 v197, v197
    v_mfma_f32_16x16x32_bf16 v[56:59], v[228:231], a[152:155], 0
    ds_read_b128 a[244:247], v240 offset:37888
    v_mfma_f32_16x16x32_bf16 v[28:31], v[224:227], a[156:159], v[28:31]
    v_exp_f32 v198, v198
    v_mfma_f32_16x16x32_bf16 v[60:63], v[228:231], a[156:159], 0
    ds_read_b128 a[240:243], v240 offset:38912
    s_waitcnt vmcnt(12) lgkmcnt(3)
    v_mfma_f32_16x16x32_bf16 v[160:163], a[128:131], a[0:3], 0
    v_exp_f32 v199, v199
    v_mfma_f32_16x16x32_bf16 v[168:171], a[128:131], a[16:19], 0
    ds_read_b128 a[236:239], v240 offset:39936
    v_cvt_pk_bf16_f32 v224, v192, v193
    v_mfma_f32_16x16x32_bf16 v[176:179], a[128:131], a[32:35], 0
    v_exp_f32 v204, v204
    v_mfma_f32_16x16x32_bf16 v[160:163], a[132:135], a[4:7], v[160:163]
    v_cvt_pk_bf16_f32 v225, v194, v195
    v_cvt_pk_bf16_f32 v228, v200, v201
    v_mfma_f32_16x16x32_bf16 v[168:171], a[132:135], a[20:23], v[168:171]
    v_exp_f32 v205, v205
    v_mfma_f32_16x16x32_bf16 v[176:179], a[132:135], a[36:39], v[176:179]
    v_cvt_pk_bf16_f32 v229, v202, v203
    v_cvt_pk_bf16_f32 v226, v196, v197
    v_mfma_f32_16x16x32_bf16 v[160:163], a[136:139], a[8:11], v[160:163]
    v_exp_f32 v206, v206
    s_bfe_u32 s45, s44, 0x3000c
    s_add_u32 s45, s45, s68
    s_and_b32 s45, s45, 7
    s_lshl_b32 s28, s45, 13
    s_bitcmp1_b32 s44, 15
    s_cselect_b64 s[24:25], s[22:23], s[20:21]
    s_cselect_b32 s45, 256, 64
    s_cselect_b64 vcc, -1, 0
    s_add_u32 s29, s28, s45
    v_cndmask_b32 v251, v249, v250, vcc
    s_add_u32 s30, s29, s45
    s_add_u32 s31, s30, s45
    buffer_load_dwordx4 v[128:131], v251, s[24:27], s28 offen offset:0 nt
    v_mfma_f32_16x16x32_bf16 v[168:171], a[136:139], a[24:27], v[168:171]
    v_cvt_pk_bf16_f32 v227, v198, v199
    v_cvt_pk_bf16_f32 v230, v204, v205
    v_mfma_f32_16x16x32_bf16 v[176:179], a[136:139], a[40:43], v[176:179]
    v_exp_f32 v207, v207
    v_mfma_f32_16x16x32_bf16 v[160:163], a[252:255], a[12:15], v[160:163]
    v_cvt_pk_bf16_f32 v231, v206, v207
    v_mfma_f32_16x16x32_bf16 v[168:171], a[252:255], a[28:31], v[168:171]
    v_mfma_f32_16x16x32_bf16 v[176:179], a[252:255], a[44:47], v[176:179]
    s_waitcnt lgkmcnt(0)
    v_mfma_f32_16x16x32_bf16 v[164:167], a[248:251], a[0:3], 0
    v_mfma_f32_16x16x32_bf16 v[172:175], a[248:251], a[16:19], 0
    s_nop 1
    v_exp_f32 v160, v160
    v_mfma_f32_16x16x32_bf16 v[180:183], a[248:251], a[32:35], 0
    v_exp_f32 v161, v161
    v_mfma_f32_16x16x32_bf16 v[164:167], a[244:247], a[4:7], v[164:167]
    v_exp_f32 v162, v162
    v_mfma_f32_16x16x32_bf16 v[172:175], a[244:247], a[20:23], v[172:175]
    v_exp_f32 v163, v163
    buffer_load_dwordx4 v[132:135], v251, s[24:27], s29 offen offset:0 nt
    v_mfma_f32_16x16x32_bf16 v[180:183], a[244:247], a[36:39], v[180:183]
    v_exp_f32 v168, v168
    v_mfma_f32_16x16x32_bf16 v[164:167], a[240:243], a[8:11], v[164:167]
    v_exp_f32 v169, v169
    v_mfma_f32_16x16x32_bf16 v[172:175], a[240:243], a[24:27], v[172:175]
    v_exp_f32 v170, v170
    v_mfma_f32_16x16x32_bf16 v[180:183], a[240:243], a[40:43], v[180:183]
    v_exp_f32 v171, v171
    v_mfma_f32_16x16x32_bf16 v[164:167], a[236:239], a[12:15], v[164:167]
    v_exp_f32 v176, v176
    v_mfma_f32_16x16x32_bf16 v[172:175], a[236:239], a[28:31], v[172:175]
    v_exp_f32 v177, v177
    v_mfma_f32_16x16x32_bf16 v[180:183], a[236:239], a[44:47], v[180:183]
    v_exp_f32 v178, v178
    v_exp_f32 v179, v179
    v_cvt_pk_bf16_f32 v232, v176, v177
    s_bfe_u32 s46, s44, 0x30008
    s_lshl_b32 s46, s46, 13
    s_bitcmp1_b32 s44, 11
    s_cbranch_scc1 L_c2_v
    v_add_u32 v252, s46, v240
    s_waitcnt vmcnt(13)
    v_lshlrev_b32 v216, 16, v96
    v_and_b32 v217, 0xffff0000, v96
    v_mul_f32 v216, s41, v216
    v_mul_f32 v217, s41, v217
    v_cvt_pk_bf16_f32 v96, v216, v217
    v_lshlrev_b32 v218, 16, v97
    v_and_b32 v219, 0xffff0000, v97
    v_mul_f32 v218, s41, v218
    v_mul_f32 v219, s41, v219
    v_cvt_pk_bf16_f32 v97, v218, v219
    v_lshlrev_b32 v216, 16, v98
    v_and_b32 v217, 0xffff0000, v98
    v_mul_f32 v216, s41, v216
    v_mul_f32 v217, s41, v217
    v_cvt_pk_bf16_f32 v98, v216, v217
    v_lshlrev_b32 v218, 16, v99
    v_and_b32 v219, 0xffff0000, v99
    v_mul_f32 v218, s41, v218
    v_mul_f32 v219, s41, v219
    v_cvt_pk_bf16_f32 v99, v218, v219
    ds_write_b128 v252, v[96:99] offset:0
    buffer_load_dwordx4 v[136:139], v251, s[24:27], s30 offen offset:0 nt
    s_waitcnt vmcnt(13)
    v_lshlrev_b32 v216, 16, v100
    v_and_b32 v217, 0xffff0000, v100
    v_mul_f32 v216, s41, v216
    v_mul_f32 v217, s41, v217
    v_cvt_pk_bf16_f32 v100, v216, v217
    v_lshlrev_b32 v218, 16, v101
    v_and_b32 v219, 0xffff0000, v101
    v_mul_f32 v218, s41, v218
    v_mul_f32 v219, s41, v219
    v_cvt_pk_bf16_f32 v101, v218, v219
    v_lshlrev_b32 v216, 16, v102
    v_and_b32 v217, 0xffff0000, v102
    v_mul_f32 v216, s41, v216
    v_mul_f32 v217, s41, v217
    v_cvt_pk_bf16_f32 v102, v216, v217
    v_lshlrev_b32 v218, 16, v103
    v_and_b32 v219, 0xffff0000, v103
    v_mul_f32 v218, s41, v218
    v_mul_f32 v219, s41, v219
    v_cvt_pk_bf16_f32 v103, v218, v219
    ds_write_b128 v252, v[100:103] offset:1024
    s_waitcnt vmcnt(12)
    v_lshlrev_b32 v216, 16, v104
    v_and_b32 v217, 0xffff0000, v104
    v_mul_f32 v216, s41, v216
    v_mul_f32 v217, s41, v217
    v_cvt_pk_bf16_f32 v104, v216, v217
    v_lshlrev_b32 v218, 16, v105
    v_and_b32 v219, 0xffff0000, v105
    v_mul_f32 v218, s41, v218
    v_mul_f32 v219, s41, v219
    v_cvt_pk_bf16_f32 v105, v218, v219
    v_lshlrev_b32 v216, 16, v106
    v_and_b32 v217, 0xffff0000, v106
    v_mul_f32 v216, s41, v216
    v_mul_f32 v217, s41, v217
    v_cvt_pk_bf16_f32 v106, v216, v217
    v_lshlrev_b32 v218, 16, v107
    v_and_b32 v219, 0xffff0000, v107
    v_mul_f32 v218, s41, v218
    v_mul_f32 v219, s41, v219
    v_cvt_pk_bf16_f32 v107, v218, v219
    ds_write_b128 v252, v[104:107] offset:2048
    buffer_load_dwordx4 v[140:143], v251, s[24:27], s31 offen offset:0 nt
    s_waitcnt vmcnt(12)
    v_lshlrev_b32 v216, 16, v108
    v_and_b32 v217, 0xffff0000, v108
    v_mul_f32 v216, s41, v216
    v_mul_f32 v217, s41, v217
    v_cvt_pk_bf16_f32 v108, v216, v217
    v_lshlrev_b32 v218, 16, v109
    v_and_b32 v219, 0xffff0000, v109
    v_mul_f32 v218, s41, v218
    v_mul_f32 v219, s41, v219
    v_cvt_pk_bf16_f32 v109, v218, v219
    v_lshlrev_b32 v216, 16, v110
    v_and_b32 v217, 0xffff0000, v110
    v_mul_f32 v216, s41, v216
    v_mul_f32 v217, s41, v217
    v_cvt_pk_bf16_f32 v110, v216, v217
    v_lshlrev_b32 v218, 16, v111
    v_and_b32 v219, 0xffff0000, v111
    v_mul_f32 v218, s41, v218
    v_mul_f32 v219, s41, v219
    v_cvt_pk_bf16_f32 v111, v218, v219
    ds_write_b128 v252, v[108:111] offset:3072
    s_waitcnt vmcnt(11)
    v_lshlrev_b32 v216, 16, v112
    v_and_b32 v217, 0xffff0000, v112
    v_mul_f32 v216, s41, v216
    v_mul_f32 v217, s41, v217
    v_cvt_pk_bf16_f32 v112, v216, v217
    v_lshlrev_b32 v218, 16, v113
    v_and_b32 v219, 0xffff0000, v113
    v_mul_f32 v218, s41, v218
    v_mul_f32 v219, s41, v219
    v_cvt_pk_bf16_f32 v113, v218, v219
    v_lshlrev_b32 v216, 16, v114
    v_and_b32 v217, 0xffff0000, v114
    v_mul_f32 v216, s41, v216
    v_mul_f32 v217, s41, v217
    v_cvt_pk_bf16_f32 v114, v216, v217
    v_lshlrev_b32 v218, 16, v115
    v_and_b32 v219, 0xffff0000, v115
    v_mul_f32 v218, s41, v218
    v_mul_f32 v219, s41, v219
    v_cvt_pk_bf16_f32 v115, v218, v219
    ds_write_b128 v252, v[112:115] offset:4096
    buffer_load_dwordx4 v[144:147], v251, s[24:27], s28 offen offset:1024 nt
    s_waitcnt vmcnt(11)
    v_lshlrev_b32 v216, 16, v116
    v_and_b32 v217, 0xffff0000, v116
    v_mul_f32 v216, s41, v216
    v_mul_f32 v217, s41, v217
    v_cvt_pk_bf16_f32 v116, v216, v217
    v_lshlrev_b32 v218, 16, v117
    v_and_b32 v219, 0xffff0000, v117
    v_mul_f32 v218, s41, v218
    v_mul_f32 v219, s41, v219
    v_cvt_pk_bf16_f32 v117, v218, v219
    v_lshlrev_b32 v216, 16, v118
    v_and_b32 v217, 0xffff0000, v118
    v_mul_f32 v216, s41, v216
    v_mul_f32 v217, s41, v217
    v_cvt_pk_bf16_f32 v118, v216, v217
    v_lshlrev_b32 v218, 16, v119
    v_and_b32 v219, 0xffff0000, v119
    v_mul_f32 v218, s41, v218
    v_mul_f32 v219, s41, v219
    v_cvt_pk_bf16_f32 v119, v218, v219
    ds_write_b128 v252, v[116:119] offset:5120
    s_waitcnt vmcnt(10)
    v_lshlrev_b32 v216, 16, v120
    v_and_b32 v217, 0xffff0000, v120
    v_mul_f32 v216, s41, v216
    v_mul_f32 v217, s41, v217
    v_cvt_pk_bf16_f32 v120, v216, v217
    v_lshlrev_b32 v218, 16, v121
    v_and_b32 v219, 0xffff0000, v121
    v_mul_f32 v218, s41, v218
    v_mul_f32 v219, s41, v219
    v_cvt_pk_bf16_f32 v121, v218, v219
    v_lshlrev_b32 v216, 16, v122
    v_and_b32 v217, 0xffff0000, v122
    v_mul_f32 v216, s41, v216
    v_mul_f32 v217, s41, v217
    v_cvt_pk_bf16_f32 v122, v216, v217
    v_lshlrev_b32 v218, 16, v123
    v_and_b32 v219, 0xffff0000, v123
    v_mul_f32 v218, s41, v218
    v_mul_f32 v219, s41, v219
    v_cvt_pk_bf16_f32 v123, v218, v219
    ds_write_b128 v252, v[120:123] offset:6144
    buffer_load_dwordx4 v[148:151], v251, s[24:27], s29 offen offset:1024 nt
    s_waitcnt vmcnt(10)
    v_lshlrev_b32 v216, 16, v124
    v_and_b32 v217, 0xffff0000, v124
    v_mul_f32 v216, s41, v216
    v_mul_f32 v217, s41, v217
    v_cvt_pk_bf16_f32 v124, v216, v217
    v_lshlrev_b32 v218, 16, v125
    v_and_b32 v219, 0xffff0000, v125
    v_mul_f32 v218, s41, v218
    v_mul_f32 v219, s41, v219
    v_cvt_pk_bf16_f32 v125, v218, v219
    v_lshlrev_b32 v216, 16, v126
    v_and_b32 v217, 0xffff0000, v126
    v_mul_f32 v216, s41, v216
    v_mul_f32 v217, s41, v217
    v_cvt_pk_bf16_f32 v126, v216, v217
    v_lshlrev_b32 v218, 16, v127
    v_and_b32 v219, 0xffff0000, v127
    v_mul_f32 v218, s41, v218
    v_mul_f32 v219, s41, v219
    v_cvt_pk_bf16_f32 v127, v218, v219
    ds_write_b128 v252, v[124:127] offset:7168
    s_waitcnt lgkmcnt(0)
    s_nop 0
    s_branch L_c2_e
L_c2_v:
    v_add_u32 v252, s46, v241
    s_waitcnt vmcnt(6)
    v_perm_b32 v216, v100, v96, s42
    v_perm_b32 v217, v108, v104, s42
    v_perm_b32 v218, v116, v112, s42
    v_perm_b32 v219, v124, v120, s42
    ds_write_b128 v252, v[216:219] offset:0
    v_pk_maximum3_f16 v254, v96, v97, v98
    v_pk_minimum3_f16 v255, v96, v97, v98
    v_pk_maximum3_f16 v254, v254, v99, v99
    v_pk_minimum3_f16 v255, v255, v99, v99
    buffer_load_dwordx4 v[136:139], v251, s[24:27], s30 offen offset:0 nt
    v_perm_b32 v216, v100, v96, s43
    v_perm_b32 v217, v108, v104, s43
    v_perm_b32 v218, v116, v112, s43
    v_perm_b32 v219, v124, v120, s43
    ds_write_b128 v252, v[216:219] offset:1024
    v_pk_maximum3_f16 v254, v254, v100, v101
    v_pk_minimum3_f16 v255, v255, v100, v101
    v_pk_maximum3_f16 v254, v254, v102, v103
    v_pk_minimum3_f16 v255, v255, v102, v103
    v_perm_b32 v216, v101, v97, s42
    v_perm_b32 v217, v109, v105, s42
    v_perm_b32 v218, v117, v113, s42
    v_perm_b32 v219, v125, v121, s42
    ds_write_b128 v252, v[216:219] offset:2048
    v_pk_maximum3_f16 v254, v254, v104, v105
    v_pk_minimum3_f16 v255, v255, v104, v105
    v_pk_maximum3_f16 v254, v254, v106, v107
    v_pk_minimum3_f16 v255, v255, v106, v107
    buffer_load_dwordx4 v[140:143], v251, s[24:27], s31 offen offset:0 nt
    v_perm_b32 v216, v101, v97, s43
    v_perm_b32 v217, v109, v105, s43
    v_perm_b32 v218, v117, v113, s43
    v_perm_b32 v219, v125, v121, s43
    ds_write_b128 v252, v[216:219] offset:3072
    v_pk_maximum3_f16 v254, v254, v108, v109
    v_pk_minimum3_f16 v255, v255, v108, v109
    v_pk_maximum3_f16 v254, v254, v110, v111
    v_pk_minimum3_f16 v255, v255, v110, v111
    v_perm_b32 v216, v102, v98, s42
    v_perm_b32 v217, v110, v106, s42
    v_perm_b32 v218, v118, v114, s42
    v_perm_b32 v219, v126, v122, s42
    ds_write_b128 v252, v[216:219] offset:4096
    v_pk_maximum3_f16 v254, v254, v112, v113
    v_pk_minimum3_f16 v255, v255, v112, v113
    v_pk_maximum3_f16 v254, v254, v114, v115
    v_pk_minimum3_f16 v255, v255, v114, v115
    buffer_load_dwordx4 v[144:147], v251, s[24:27], s28 offen offset:1024 nt
    v_perm_b32 v216, v102, v98, s43
    v_perm_b32 v217, v110, v106, s43
    v_perm_b32 v218, v118, v114, s43
    v_perm_b32 v219, v126, v122, s43
    ds_write_b128 v252, v[216:219] offset:5120
    v_pk_maximum3_f16 v254, v254, v116, v117
    v_pk_minimum3_f16 v255, v255, v116, v117
    v_pk_maximum3_f16 v254, v254, v118, v119
    v_pk_minimum3_f16 v255, v255, v118, v119
    v_perm_b32 v216, v103, v99, s42
    v_perm_b32 v217, v111, v107, s42
    v_perm_b32 v218, v119, v115, s42
    v_perm_b32 v219, v127, v123, s42
    ds_write_b128 v252, v[216:219] offset:6144
    v_pk_maximum3_f16 v254, v254, v120, v121
    v_pk_minimum3_f16 v255, v255, v120, v121
    v_pk_maximum3_f16 v254, v254, v122, v123
    v_pk_minimum3_f16 v255, v255, v122, v123
    buffer_load_dwordx4 v[148:151], v251, s[24:27], s29 offen offset:1024 nt
    v_perm_b32 v216, v103, v99, s43
    v_perm_b32 v217, v111, v107, s43
    v_perm_b32 v218, v119, v115, s43
    v_perm_b32 v219, v127, v123, s43
    ds_write_b128 v252, v[216:219] offset:7168
    v_pk_maximum3_f16 v254, v254, v124, v125
    v_pk_minimum3_f16 v255, v255, v124, v125
    v_pk_maximum3_f16 v254, v254, v126, v127
    v_pk_minimum3_f16 v255, v255, v126, v127
    v_and_b32 v254, 0x7fff7fff, v254
    v_and_b32 v255, 0x7fff7fff, v255
    v_pk_max_u16 v254, v254, v255
    v_pk_max_u16 v253, v253, v254
    s_waitcnt lgkmcnt(0)
    s_nop 0
L_c2_e:
    s_barrier
    ds_read_b128 a[140:143], v241 offset:24576
    ds_read_b128 a[144:147], v241 offset:25600
    ds_read_b128 a[148:151], v241 offset:26624
    ds_read_b128 a[152:155], v241 offset:27648
    ds_read_b128 a[156:159], v241 offset:28672
    ds_read_b128 a[128:131], v241 offset:29696
    ds_read_b128 a[132:135], v241 offset:30720
    v_smfmac_f32_16x16x64_bf16 a[192:195], a[212:215], v[224:231], v247
    v_cvt_pk_bf16_f32 v233, v178, v179
    s_waitcnt lgkmcnt(3)
    v_mfma_f32_16x16x32_bf16 v[0:3], v[224:227], a[140:143], v[0:3]
    v_exp_f32 v164, v164
    v_mfma_f32_16x16x32_bf16 v[32:35], v[228:231], a[140:143], v[32:35]
    ds_read_b128 a[136:139], v241 offset:31744
    v_mfma_f32_16x16x32_bf16 v[4:7], v[224:227], a[144:147], v[4:7]
    v_exp_f32 v165, v165
    v_mfma_f32_16x16x32_bf16 v[36:39], v[228:231], a[144:147], v[36:39]
    ds_read_b128 a[232:235], v240 offset:40960
    v_mfma_f32_16x16x32_bf16 v[8:11], v[224:227], a[148:151], v[8:11]
    v_exp_f32 v166, v166
    v_mfma_f32_16x16x32_bf16 v[40:43], v[228:231], a[148:151], v[40:43]
    ds_read_b128 a[228:231], v240 offset:41984
    v_mfma_f32_16x16x32_bf16 v[12:15], v[224:227], a[152:155], v[12:15]
    v_exp_f32 v167, v167
    v_mfma_f32_16x16x32_bf16 v[44:47], v[228:231], a[152:155], v[44:47]
    ds_read_b128 a[224:227], v240 offset:43008
    s_waitcnt lgkmcnt(3)
    v_mfma_f32_16x16x32_bf16 v[16:19], v[224:227], a[156:159], v[16:19]
    v_exp_f32 v172, v172
    v_mfma_f32_16x16x32_bf16 v[48:51], v[228:231], a[156:159], v[48:51]
    ds_read_b128 a[220:223], v240 offset:44032
    v_mfma_f32_16x16x32_bf16 v[20:23], v[224:227], a[128:131], v[20:23]
    v_exp_f32 v173, v173
    v_mfma_f32_16x16x32_bf16 v[52:55], v[228:231], a[128:131], v[52:55]
    ds_read_b128 a[216:219], v240 offset:45056
    buffer_load_dwordx4 v[152:155], v251, s[24:27], s30 offen offset:1024 nt
    v_mfma_f32_16x16x32_bf16 v[24:27], v[224:227], a[132:135], v[24:27]
    v_exp_f32 v174, v174
    v_mfma_f32_16x16x32_bf16 v[56:59], v[228:231], a[132:135], v[56:59]
    ds_read_b128 a[208:211], v240 offset:46080
    v_mfma_f32_16x16x32_bf16 v[28:31], v[224:227], a[136:139], v[28:31]
    v_exp_f32 v175, v175
    v_mfma_f32_16x16x32_bf16 v[60:63], v[228:231], a[136:139], v[60:63]
    ds_read_b128 a[204:207], v240 offset:47104
    s_waitcnt lgkmcnt(3)
    v_mfma_f32_16x16x32_bf16 v[192:195], a[232:235], a[0:3], 0
    v_exp_f32 v180, v180
    v_mfma_f32_16x16x32_bf16 v[200:203], a[232:235], a[16:19], 0
    ds_read_b128 a[200:203], v240 offset:48128
    v_cvt_pk_bf16_f32 v224, v160, v161
    v_mfma_f32_16x16x32_bf16 v[208:211], a[232:235], a[32:35], 0
    v_exp_f32 v181, v181
    v_mfma_f32_16x16x32_bf16 v[192:195], a[228:231], a[4:7], v[192:195]
    ds_read_b128 a[188:191], v241 offset:32768
    v_cvt_pk_bf16_f32 v225, v162, v163
    v_mfma_f32_16x16x32_bf16 v[200:203], a[228:231], a[20:23], v[200:203]
    v_exp_f32 v182, v182
    v_mfma_f32_16x16x32_bf16 v[208:211], a[228:231], a[36:39], v[208:211]
    v_cvt_pk_bf16_f32 v228, v168, v169
    v_cvt_pk_bf16_f32 v229, v170, v171
    v_mfma_f32_16x16x32_bf16 v[192:195], a[224:227], a[8:11], v[192:195]
    v_exp_f32 v183, v183
    v_mfma_f32_16x16x32_bf16 v[200:203], a[224:227], a[24:27], v[200:203]
    ds_read_b128 a[184:187], v241 offset:33792
    v_cvt_pk_bf16_f32 v226, v164, v165
    v_mfma_f32_16x16x32_bf16 v[208:211], a[224:227], a[40:43], v[208:211]
    v_cvt_pk_bf16_f32 v227, v166, v167
    v_cvt_pk_bf16_f32 v230, v172, v173
    v_mfma_f32_16x16x32_bf16 v[192:195], a[220:223], a[12:15], v[192:195]
    ds_read_b128 a[180:183], v241 offset:34816
    v_cvt_pk_bf16_f32 v231, v174, v175
    v_mfma_f32_16x16x32_bf16 v[200:203], a[220:223], a[28:31], v[200:203]
    v_cvt_pk_bf16_f32 v234, v180, v181
    v_cvt_pk_bf16_f32 v235, v182, v183
    v_mfma_f32_16x16x32_bf16 v[208:211], a[220:223], a[44:47], v[208:211]
    s_waitcnt lgkmcnt(3)
    v_mfma_f32_16x16x32_bf16 v[196:199], a[216:219], a[0:3], 0
    ds_read_b128 a[176:179], v241 offset:35840
    v_mfma_f32_16x16x32_bf16 v[204:207], a[216:219], a[16:19], 0
    v_exp_f32 v192, v192
    v_mfma_f32_16x16x32_bf16 v[212:215], a[216:219], a[32:35], 0
    v_exp_f32 v193, v193
    v_mfma_f32_16x16x32_bf16 v[196:199], a[208:211], a[4:7], v[196:199]
    ds_read_b128 a[172:175], v241 offset:36864
    v_mfma_f32_16x16x32_bf16 v[204:207], a[208:211], a[20:23], v[204:207]
    v_exp_f32 v194, v194
    v_mfma_f32_16x16x32_bf16 v[212:215], a[208:211], a[36:39], v[212:215]
    v_exp_f32 v195, v195
    v_mfma_f32_16x16x32_bf16 v[196:199], a[204:207], a[8:11], v[196:199]
    ds_read_b128 a[168:171], v241 offset:37888
    v_mfma_f32_16x16x32_bf16 v[204:207], a[204:207], a[24:27], v[204:207]
    v_exp_f32 v200, v200
    buffer_load_dwordx4 v[156:159], v251, s[24:27], s31 offen offset:1024 nt
    v_mfma_f32_16x16x32_bf16 v[212:215], a[204:207], a[40:43], v[212:215]
    v_exp_f32 v201, v201
    v_mfma_f32_16x16x32_bf16 v[196:199], a[200:203], a[12:15], v[196:199]
    ds_read_b128 a[164:167], v241 offset:38912
    v_mfma_f32_16x16x32_bf16 v[204:207], a[200:203], a[28:31], v[204:207]
    v_exp_f32 v202, v202
    v_mfma_f32_16x16x32_bf16 v[212:215], a[200:203], a[44:47], v[212:215]
    v_exp_f32 v203, v203
    v_smfmac_f32_16x16x64_bf16 a[192:195], a[212:215], v[224:231], v247
    v_exp_f32 v208, v208
    v_smfmac_f32_16x16x64_bf16 a[196:199], a[212:215], v[232:239], v247
    s_waitcnt lgkmcnt(3)
    v_mfma_f32_16x16x32_bf16 v[0:3], v[224:227], a[188:191], v[0:3]
    v_exp_f32 v209, v209
    v_mfma_f32_16x16x32_bf16 v[32:35], v[228:231], a[188:191], v[32:35]
    ds_read_b128 a[160:163], v241 offset:39936
    v_mfma_f32_16x16x32_bf16 v[64:67], v[232:235], a[188:191], 0
    v_exp_f32 v210, v210
    v_mfma_f32_16x16x32_bf16 v[4:7], v[224:227], a[184:187], v[4:7]
    ds_read_b128 a[140:143], v240 offset:49152
    v_mfma_f32_16x16x32_bf16 v[36:39], v[228:231], a[184:187], v[36:39]
    v_exp_f32 v211, v211
    v_mfma_f32_16x16x32_bf16 v[68:71], v[232:235], a[184:187], 0
    v_exp_f32 v196, v196
    v_mfma_f32_16x16x32_bf16 v[8:11], v[224:227], a[180:183], v[8:11]
    ds_read_b128 a[144:147], v240 offset:50176
    v_mfma_f32_16x16x32_bf16 v[40:43], v[228:231], a[180:183], v[40:43]
    v_exp_f32 v197, v197
    v_mfma_f32_16x16x32_bf16 v[72:75], v[232:235], a[180:183], 0
    v_exp_f32 v198, v198
    v_mfma_f32_16x16x32_bf16 v[12:15], v[224:227], a[176:179], v[12:15]
    ds_read_b128 a[148:151], v240 offset:51200
    v_mfma_f32_16x16x32_bf16 v[44:47], v[228:231], a[176:179], v[44:47]
    v_exp_f32 v199, v199
    v_mfma_f32_16x16x32_bf16 v[76:79], v[232:235], a[176:179], 0
    s_waitcnt lgkmcnt(3)
    v_mfma_f32_16x16x32_bf16 v[16:19], v[224:227], a[172:175], v[16:19]
    v_exp_f32 v204, v204
    v_mfma_f32_16x16x32_bf16 v[48:51], v[228:231], a[172:175], v[48:51]
    ds_read_b128 a[152:155], v240 offset:52224
    v_mfma_f32_16x16x32_bf16 v[80:83], v[232:235], a[172:175], 0
    v_exp_f32 v205, v205
    v_mfma_f32_16x16x32_bf16 v[20:23], v[224:227], a[168:171], v[20:23]
    ds_read_b128 a[156:159], v240 offset:53248
    v_mfma_f32_16x16x32_bf16 v[52:55], v[228:231], a[168:171], v[52:55]
    v_exp_f32 v206, v206
    v_mfma_f32_16x16x32_bf16 v[84:87], v[232:235], a[168:171], 0
    v_exp_f32 v207, v207
    buffer_load_dwordx4 a[64:67], v243, s[12:15], s56 offen offset:0 nt
    v_mfma_f32_16x16x32_bf16 v[24:27], v[224:227], a[164:167], v[24:27]
    ds_read_b128 a[128:131], v240 offset:54272
    v_mfma_f32_16x16x32_bf16 v[56:59], v[228:231], a[164:167], v[56:59]
    v_exp_f32 v212, v212
    v_mfma_f32_16x16x32_bf16 v[88:91], v[232:235], a[164:167], 0
    v_exp_f32 v213, v213
    v_mfma_f32_16x16x32_bf16 v[28:31], v[224:227], a[160:163], v[28:31]
    ds_read_b128 a[132:135], v240 offset:55296
    v_cvt_pk_bf16_f32 v224, v192, v193
    v_mfma_f32_16x16x32_bf16 v[60:63], v[228:231], a[160:163], v[60:63]
    v_exp_f32 v214, v214
    v_mfma_f32_16x16x32_bf16 v[92:95], v[232:235], a[160:163], 0
    v_cvt_pk_bf16_f32 v225, v194, v195
    s_waitcnt vmcnt(9) lgkmcnt(3)
    v_mfma_f32_16x16x32_bf16 v[160:163], a[140:143], a[0:3], 0
    v_exp_f32 v215, v215
    v_mfma_f32_16x16x32_bf16 v[168:171], a[140:143], a[16:19], 0
    ds_read_b128 a[136:139], v240 offset:56320
    v_cvt_pk_bf16_f32 v228, v200, v201
    v_mfma_f32_16x16x32_bf16 v[176:179], a[140:143], a[32:35], 0
    v_cvt_pk_bf16_f32 v229, v202, v203
    v_cvt_pk_bf16_f32 v226, v196, v197
    v_mfma_f32_16x16x32_bf16 v[184:187], a[140:143], a[48:51], 0
    v_cvt_pk_bf16_f32 v227, v198, v199
    v_cvt_pk_bf16_f32 v230, v204, v205
    v_mfma_f32_16x16x32_bf16 v[160:163], a[144:147], a[4:7], v[160:163]
    v_cvt_pk_bf16_f32 v231, v206, v207
    v_cvt_pk_bf16_f32 v232, v208, v209
    v_mfma_f32_16x16x32_bf16 v[168:171], a[144:147], a[20:23], v[168:171]
    v_cvt_pk_bf16_f32 v233, v210, v211
    v_cvt_pk_bf16_f32 v234, v212, v213
    v_mfma_f32_16x16x32_bf16 v[176:179], a[144:147], a[36:39], v[176:179]
    v_cvt_pk_bf16_f32 v235, v214, v215
    v_mfma_f32_16x16x32_bf16 v[184:187], a[144:147], a[52:55], v[184:187]
    v_mfma_f32_16x16x32_bf16 v[160:163], a[148:151], a[8:11], v[160:163]
    v_mfma_f32_16x16x32_bf16 v[168:171], a[148:151], a[24:27], v[168:171]
    v_mfma_f32_16x16x32_bf16 v[176:179], a[148:151], a[40:43], v[176:179]
    v_mfma_f32_16x16x32_bf16 v[184:187], a[148:151], a[56:59], v[184:187]
    v_mfma_f32_16x16x32_bf16 v[160:163], a[152:155], a[12:15], v[160:163]
    v_mfma_f32_16x16x32_bf16 v[168:171], a[152:155], a[28:31], v[168:171]
    v_mfma_f32_16x16x32_bf16 v[176:179], a[152:155], a[44:47], v[176:179]
    v_mfma_f32_16x16x32_bf16 v[184:187], a[152:155], a[60:63], v[184:187]
    s_waitcnt lgkmcnt(0)
    v_mfma_f32_16x16x32_bf16 v[164:167], a[156:159], a[0:3], 0
    s_nop 2
    v_exp_f32 v160, v160
    v_mfma_f32_16x16x32_bf16 v[172:175], a[156:159], a[16:19], 0
    v_exp_f32 v161, v161
    buffer_load_dwordx4 a[68:71], v243, s[12:15], s56 offen offset:64 nt
    v_mfma_f32_16x16x32_bf16 v[180:183], a[156:159], a[32:35], 0
    v_exp_f32 v162, v162
    v_mfma_f32_16x16x32_bf16 v[188:191], a[156:159], a[48:51], 0
    v_exp_f32 v163, v163
    v_mfma_f32_16x16x32_bf16 v[164:167], a[128:131], a[4:7], v[164:167]
    v_exp_f32 v168, v168
    v_mfma_f32_16x16x32_bf16 v[172:175], a[128:131], a[20:23], v[172:175]
    v_exp_f32 v169, v169
    v_mfma_f32_16x16x32_bf16 v[180:183], a[128:131], a[36:39], v[180:183]
    v_exp_f32 v170, v170
    v_mfma_f32_16x16x32_bf16 v[188:191], a[128:131], a[52:55], v[188:191]
    v_exp_f32 v171, v171
    v_mfma_f32_16x16x32_bf16 v[164:167], a[132:135], a[8:11], v[164:167]
    v_exp_f32 v176, v176
    v_mfma_f32_16x16x32_bf16 v[172:175], a[132:135], a[24:27], v[172:175]
    v_exp_f32 v177, v177
    v_mfma_f32_16x16x32_bf16 v[180:183], a[132:135], a[40:43], v[180:183]
    v_exp_f32 v178, v178
    v_mfma_f32_16x16x32_bf16 v[188:191], a[132:135], a[56:59], v[188:191]
    v_exp_f32 v179, v179
    v_mfma_f32_16x16x32_bf16 v[164:167], a[136:139], a[12:15], v[164:167]
    v_exp_f32 v184, v184
    v_mfma_f32_16x16x32_bf16 v[172:175], a[136:139], a[28:31], v[172:175]
    v_exp_f32 v185, v185
    v_mfma_f32_16x16x32_bf16 v[180:183], a[136:139], a[44:47], v[180:183]
    v_cvt_pk_bf16_f32 v236, v184, v185
    v_mfma_f32_16x16x32_bf16 v[188:191], a[136:139], a[60:63], v[188:191]
    v_exp_f32 v186, v186
    v_exp_f32 v187, v187
    s_bfe_u32 s46, s44, 0x3000c
    s_lshl_b32 s46, s46, 13
    s_bitcmp1_b32 s44, 15
    s_cbranch_scc1 L_c3_v
    v_add_u32 v252, s46, v240
    s_waitcnt vmcnt(9)
    v_lshlrev_b32 v216, 16, v128
    v_and_b32 v217, 0xffff0000, v128
    v_mul_f32 v216, s41, v216
    v_mul_f32 v217, s41, v217
    v_cvt_pk_bf16_f32 v128, v216, v217
    v_lshlrev_b32 v218, 16, v129
    v_and_b32 v219, 0xffff0000, v129
    v_mul_f32 v218, s41, v218
    v_mul_f32 v219, s41, v219
    v_cvt_pk_bf16_f32 v129, v218, v219
    v_lshlrev_b32 v216, 16, v130
    v_and_b32 v217, 0xffff0000, v130
    v_mul_f32 v216, s41, v216
    v_mul_f32 v217, s41, v217
    v_cvt_pk_bf16_f32 v130, v216, v217
    v_lshlrev_b32 v218, 16, v131
    v_and_b32 v219, 0xffff0000, v131
    v_mul_f32 v218, s41, v218
    v_mul_f32 v219, s41, v219
    v_cvt_pk_bf16_f32 v131, v218, v219
    ds_write_b128 v252, v[128:131] offset:0
    s_waitcnt vmcnt(8)
    v_lshlrev_b32 v216, 16, v132
    v_and_b32 v217, 0xffff0000, v132
    v_mul_f32 v216, s41, v216
    v_mul_f32 v217, s41, v217
    v_cvt_pk_bf16_f32 v132, v216, v217
    v_lshlrev_b32 v218, 16, v133
    v_and_b32 v219, 0xffff0000, v133
    v_mul_f32 v218, s41, v218
    v_mul_f32 v219, s41, v219
    v_cvt_pk_bf16_f32 v133, v218, v219
    v_lshlrev_b32 v216, 16, v134
    v_and_b32 v217, 0xffff0000, v134
    v_mul_f32 v216, s41, v216
    v_mul_f32 v217, s41, v217
    v_cvt_pk_bf16_f32 v134, v216, v217
    v_lshlrev_b32 v218, 16, v135
    v_and_b32 v219, 0xffff0000, v135
    v_mul_f32 v218, s41, v218
    v_mul_f32 v219, s41, v219
    v_cvt_pk_bf16_f32 v135, v218, v219
    ds_write_b128 v252, v[132:135] offset:1024
    s_waitcnt vmcnt(7)
    v_lshlrev_b32 v216, 16, v136
    v_and_b32 v217, 0xffff0000, v136
    v_mul_f32 v216, s41, v216
    v_mul_f32 v217, s41, v217
    v_cvt_pk_bf16_f32 v136, v216, v217
    v_lshlrev_b32 v218, 16, v137
    v_and_b32 v219, 0xffff0000, v137
    v_mul_f32 v218, s41, v218
    v_mul_f32 v219, s41, v219
    v_cvt_pk_bf16_f32 v137, v218, v219
    v_lshlrev_b32 v216, 16, v138
    v_and_b32 v217, 0xffff0000, v138
    v_mul_f32 v216, s41, v216
    v_mul_f32 v217, s41, v217
    v_cvt_pk_bf16_f32 v138, v216, v217
    v_lshlrev_b32 v218, 16, v139
    v_and_b32 v219, 0xffff0000, v139
    v_mul_f32 v218, s41, v218
    v_mul_f32 v219, s41, v219
    v_cvt_pk_bf16_f32 v139, v218, v219
    ds_write_b128 v252, v[136:139] offset:2048
    s_waitcnt vmcnt(6)
    v_lshlrev_b32 v216, 16, v140
    v_and_b32 v217, 0xffff0000, v140
    v_mul_f32 v216, s41, v216
    v_mul_f32 v217, s41, v217
    v_cvt_pk_bf16_f32 v140, v216, v217
    v_lshlrev_b32 v218, 16, v141
    v_and_b32 v219, 0xffff0000, v141
    v_mul_f32 v218, s41, v218
    v_mul_f32 v219, s41, v219
    v_cvt_pk_bf16_f32 v141, v218, v219
    v_lshlrev_b32 v216, 16, v142
    v_and_b32 v217, 0xffff0000, v142
    v_mul_f32 v216, s41, v216
    v_mul_f32 v217, s41, v217
    v_cvt_pk_bf16_f32 v142, v216, v217
    v_lshlrev_b32 v218, 16, v143
    v_and_b32 v219, 0xffff0000, v143
    v_mul_f32 v218, s41, v218
    v_mul_f32 v219, s41, v219
    v_cvt_pk_bf16_f32 v143, v218, v219
    ds_write_b128 v252, v[140:143] offset:3072
    s_waitcnt vmcnt(5)
    v_lshlrev_b32 v216, 16, v144
    v_and_b32 v217, 0xffff0000, v144
    v_mul_f32 v216, s41, v216
    v_mul_f32 v217, s41, v217
    v_cvt_pk_bf16_f32 v144, v216, v217
    v_lshlrev_b32 v218, 16, v145
    v_and_b32 v219, 0xffff0000, v145
    v_mul_f32 v218, s41, v218
    v_mul_f32 v219, s41, v219
    v_cvt_pk_bf16_f32 v145, v218, v219
    v_lshlrev_b32 v216, 16, v146
    v_and_b32 v217, 0xffff0000, v146
    v_mul_f32 v216, s41, v216
    v_mul_f32 v217, s41, v217
    v_cvt_pk_bf16_f32 v146, v216, v217
    v_lshlrev_b32 v218, 16, v147
    v_and_b32 v219, 0xffff0000, v147
    v_mul_f32 v218, s41, v218
    v_mul_f32 v219, s41, v219
    v_cvt_pk_bf16_f32 v147, v218, v219
    ds_write_b128 v252, v[144:147] offset:4096
    s_waitcnt vmcnt(4)
    v_lshlrev_b32 v216, 16, v148
    v_and_b32 v217, 0xffff0000, v148
    v_mul_f32 v216, s41, v216
    v_mul_f32 v217, s41, v217
    v_cvt_pk_bf16_f32 v148, v216, v217
    v_lshlrev_b32 v218, 16, v149
    v_and_b32 v219, 0xffff0000, v149
    v_mul_f32 v218, s41, v218
    v_mul_f32 v219, s41, v219
    v_cvt_pk_bf16_f32 v149, v218, v219
    v_lshlrev_b32 v216, 16, v150
    v_and_b32 v217, 0xffff0000, v150
    v_mul_f32 v216, s41, v216
    v_mul_f32 v217, s41, v217
    v_cvt_pk_bf16_f32 v150, v216, v217
    v_lshlrev_b32 v218, 16, v151
    v_and_b32 v219, 0xffff0000, v151
    v_mul_f32 v218, s41, v218
    v_mul_f32 v219, s41, v219
    v_cvt_pk_bf16_f32 v151, v218, v219
    ds_write_b128 v252, v[148:151] offset:5120
    s_waitcnt vmcnt(3)
    v_lshlrev_b32 v216, 16, v152
    v_and_b32 v217, 0xffff0000, v152
    v_mul_f32 v216, s41, v216
    v_mul_f32 v217, s41, v217
    v_cvt_pk_bf16_f32 v152, v216, v217
    v_lshlrev_b32 v218, 16, v153
    v_and_b32 v219, 0xffff0000, v153
    v_mul_f32 v218, s41, v218
    v_mul_f32 v219, s41, v219
    v_cvt_pk_bf16_f32 v153, v218, v219
    v_lshlrev_b32 v216, 16, v154
    v_and_b32 v217, 0xffff0000, v154
    v_mul_f32 v216, s41, v216
    v_mul_f32 v217, s41, v217
    v_cvt_pk_bf16_f32 v154, v216, v217
    v_lshlrev_b32 v218, 16, v155
    v_and_b32 v219, 0xffff0000, v155
    v_mul_f32 v218, s41, v218
    v_mul_f32 v219, s41, v219
    v_cvt_pk_bf16_f32 v155, v218, v219
    ds_write_b128 v252, v[152:155] offset:6144
    s_waitcnt vmcnt(2)
    v_lshlrev_b32 v216, 16, v156
    v_and_b32 v217, 0xffff0000, v156
    v_mul_f32 v216, s41, v216
    v_mul_f32 v217, s41, v217
    v_cvt_pk_bf16_f32 v156, v216, v217
    v_lshlrev_b32 v218, 16, v157
    v_and_b32 v219, 0xffff0000, v157
    v_mul_f32 v218, s41, v218
    v_mul_f32 v219, s41, v219
    v_cvt_pk_bf16_f32 v157, v218, v219
    v_lshlrev_b32 v216, 16, v158
    v_and_b32 v217, 0xffff0000, v158
    v_mul_f32 v216, s41, v216
    v_mul_f32 v217, s41, v217
    v_cvt_pk_bf16_f32 v158, v216, v217
    v_lshlrev_b32 v218, 16, v159
    v_and_b32 v219, 0xffff0000, v159
    v_mul_f32 v218, s41, v218
    v_mul_f32 v219, s41, v219
    v_cvt_pk_bf16_f32 v159, v218, v219
    ds_write_b128 v252, v[156:159] offset:7168
    s_waitcnt lgkmcnt(0)
    s_nop 0
    s_branch L_c3_e
L_c3_v:
    v_add_u32 v252, s46, v241
    s_waitcnt vmcnt(2)
    v_perm_b32 v216, v132, v128, s42
    v_perm_b32 v217, v140, v136, s42
    v_perm_b32 v218, v148, v144, s42
    v_perm_b32 v219, v156, v152, s42
    ds_write_b128 v252, v[216:219] offset:0
    v_pk_maximum3_f16 v254, v128, v129, v130
    v_pk_minimum3_f16 v255, v128, v129, v130
    v_pk_maximum3_f16 v254, v254, v131, v131
    v_pk_minimum3_f16 v255, v255, v131, v131
    v_perm_b32 v216, v132, v128, s43
    v_perm_b32 v217, v140, v136, s43
    v_perm_b32 v218, v148, v144, s43
    v_perm_b32 v219, v156, v152, s43
    ds_write_b128 v252, v[216:219] offset:1024
    v_pk_maximum3_f16 v254, v254, v132, v133
    v_pk_minimum3_f16 v255, v255, v132, v133
    v_pk_maximum3_f16 v254, v254, v134, v135
    v_pk_minimum3_f16 v255, v255, v134, v135
    v_perm_b32 v216, v133, v129, s42
    v_perm_b32 v217, v141, v137, s42
    v_perm_b32 v218, v149, v145, s42
    v_perm_b32 v219, v157, v153, s42
    ds_write_b128 v252, v[216:219] offset:2048
    v_pk_maximum3_f16 v254, v254, v136, v137
    v_pk_minimum3_f16 v255, v255, v136, v137
    v_pk_maximum3_f16 v254, v254, v138, v139
    v_pk_minimum3_f16 v255, v255, v138, v139
    v_perm_b32 v216, v133, v129, s43
    v_perm_b32 v217, v141, v137, s43
    v_perm_b32 v218, v149, v145, s43
    v_perm_b32 v219, v157, v153, s43
    ds_write_b128 v252, v[216:219] offset:3072
    v_pk_maximum3_f16 v254, v254, v140, v141
    v_pk_minimum3_f16 v255, v255, v140, v141
    v_pk_maximum3_f16 v254, v254, v142, v143
    v_pk_minimum3_f16 v255, v255, v142, v143
    v_perm_b32 v216, v134, v130, s42
    v_perm_b32 v217, v142, v138, s42
    v_perm_b32 v218, v150, v146, s42
    v_perm_b32 v219, v158, v154, s42
    ds_write_b128 v252, v[216:219] offset:4096
    v_pk_maximum3_f16 v254, v254, v144, v145
    v_pk_minimum3_f16 v255, v255, v144, v145
    v_pk_maximum3_f16 v254, v254, v146, v147
    v_pk_minimum3_f16 v255, v255, v146, v147
    v_perm_b32 v216, v134, v130, s43
    v_perm_b32 v217, v142, v138, s43
    v_perm_b32 v218, v150, v146, s43
    v_perm_b32 v219, v158, v154, s43
    ds_write_b128 v252, v[216:219] offset:5120
    v_pk_maximum3_f16 v254, v254, v148, v149
    v_pk_minimum3_f16 v255, v255, v148, v149
    v_pk_maximum3_f16 v254, v254, v150, v151
    v_pk_minimum3_f16 v255, v255, v150, v151
    v_perm_b32 v216, v135, v131, s42
    v_perm_b32 v217, v143, v139, s42
    v_perm_b32 v218, v151, v147, s42
    v_perm_b32 v219, v159, v155, s42
    ds_write_b128 v252, v[216:219] offset:6144
    v_pk_maximum3_f16 v254, v254, v152, v153
    v_pk_minimum3_f16 v255, v255, v152, v153
    v_pk_maximum3_f16 v254, v254, v154, v155
    v_pk_minimum3_f16 v255, v255, v154, v155
    v_perm_b32 v216, v135, v131, s43
    v_perm_b32 v217, v143, v139, s43
    v_perm_b32 v218, v151, v147, s43
    v_perm_b32 v219, v159, v155, s43
    ds_write_b128 v252, v[216:219] offset:7168
    v_pk_maximum3_f16 v254, v254, v156, v157
    v_pk_minimum3_f16 v255, v255, v156, v157
    v_pk_maximum3_f16 v254, v254, v158, v159
    v_pk_minimum3_f16 v255, v255, v158, v159
    v_and_b32 v254, 0x7fff7fff, v254
    v_and_b32 v255, 0x7fff7fff, v255
    v_pk_max_u16 v254, v254, v255
    v_pk_max_u16 v253, v253, v254
    s_waitcnt lgkmcnt(0)
    s_nop 0
L_c3_e:
    v_lshrrev_b32 v216, 16, v253
    v_and_b32 v253, 0xffff, v253
    v_max_u32 v253, v253, v216
    v_cmp_le_u32 vcc, 0x6780, v253
    s_lshl_b32 s45, s40, 2
    s_add_u32 s45, s45, 0x20000
    s_cmp_lg_u64 vcc, 0
    s_cselect_b32 s46, -1, 0
    v_mov_b32 v216, s45
    v_mov_b32 v217, s46
    ds_write_b32 v216, v217
    s_waitcnt lgkmcnt(0)
    s_nop 0
    s_barrier
    v_mov_b32 v252, 0x20000
    ds_read_b128 v[216:219], v252
    s_waitcnt lgkmcnt(0)
    v_or3_b32 v253, v216, v217, v218
    v_or_b32 v253, v253, v219
    buffer_load_dwordx4 a[72:75], v243, s[12:15], s56 offen offset:128 nt
    buffer_load_dwordx4 a[76:79], v243, s[12:15], s56 offen offset:192 nt
    ds_read_b128 a[124:127], v241 offset:40960
    ds_read_b128 a[120:123], v241 offset:41984
    ds_read_b128 a[116:119], v241 offset:43008
    ds_read_b128 a[112:115], v241 offset:44032
    ds_read_b128 a[108:111], v241 offset:45056
    ds_read_b128 a[104:107], v241 offset:46080
    ds_read_b128 a[100:103], v241 offset:47104
    v_smfmac_f32_16x16x64_bf16 a[192:195], a[212:215], v[224:231], v247
    v_cvt_pk_bf16_f32 v237, v186, v187
    s_nop 1
    v_smfmac_f32_16x16x64_bf16 a[196:199], a[212:215], v[232:239], v247
    s_waitcnt lgkmcnt(3)
    v_mfma_f32_16x16x32_bf16 v[0:3], v[224:227], a[124:127], v[0:3]
    v_exp_f32 v164, v164
    v_mfma_f32_16x16x32_bf16 v[32:35], v[228:231], a[124:127], v[32:35]
    ds_read_b128 a[96:99], v241 offset:48128
    v_mfma_f32_16x16x32_bf16 v[64:67], v[232:235], a[124:127], v[64:67]
    v_exp_f32 v165, v165
    v_mfma_f32_16x16x32_bf16 v[4:7], v[224:227], a[120:123], v[4:7]
    ds_read_b128 a[140:143], v240 offset:57344
    v_accvgpr_write_b32 a198, 0
    v_mfma_f32_16x16x32_bf16 v[36:39], v[228:231], a[120:123], v[36:39]
    v_exp_f32 v166, v166
    v_mfma_f32_16x16x32_bf16 v[68:71], v[232:235], a[120:123], v[68:71]
    v_accvgpr_write_b32 a199, 0
    v_mfma_f32_16x16x32_bf16 v[8:11], v[224:227], a[116:119], v[8:11]
    v_exp_f32 v167, v167
    v_mfma_f32_16x16x32_bf16 v[40:43], v[228:231], a[116:119], v[40:43]
    ds_read_b128 a[144:147], v240 offset:58368
    v_mfma_f32_16x16x32_bf16 v[72:75], v[232:235], a[116:119], v[72:75]
    v_exp_f32 v172, v172
    v_mfma_f32_16x16x32_bf16 v[12:15], v[224:227], a[112:115], v[12:15]
    ds_read_b128 a[148:151], v240 offset:59392
    v_mfma_f32_16x16x32_bf16 v[44:47], v[228:231], a[112:115], v[44:47]
    v_exp_f32 v173, v173
    v_mfma_f32_16x16x32_bf16 v[76:79], v[232:235], a[112:115], v[76:79]
    s_waitcnt lgkmcnt(3)
    v_mfma_f32_16x16x32_bf16 v[16:19], v[224:227], a[108:111], v[16:19]
    v_exp_f32 v174, v174
    v_mfma_f32_16x16x32_bf16 v[48:51], v[228:231], a[108:111], v[48:51]
    ds_read_b128 a[152:155], v240 offset:60416
    v_mfma_f32_16x16x32_bf16 v[80:83], v[232:235], a[108:111], v[80:83]
    v_exp_f32 v175, v175
    v_mfma_f32_16x16x32_bf16 v[20:23], v[224:227], a[104:107], v[20:23]
    ds_read_b128 a[156:159], v240 offset:61440
    buffer_load_dwordx4 a[80:83], v243, s[12:15], s57 offen offset:0 nt
    v_mfma_f32_16x16x32_bf16 v[52:55], v[228:231], a[104:107], v[52:55]
    v_exp_f32 v180, v180
    v_mfma_f32_16x16x32_bf16 v[84:87], v[232:235], a[104:107], v[84:87]
    v_exp_f32 v181, v181
    v_mfma_f32_16x16x32_bf16 v[24:27], v[224:227], a[100:103], v[24:27]
    ds_read_b128 a[128:131], v240 offset:62464
    v_mfma_f32_16x16x32_bf16 v[56:59], v[228:231], a[100:103], v[56:59]
    v_exp_f32 v182, v182
    v_mfma_f32_16x16x32_bf16 v[88:91], v[232:235], a[100:103], v[88:91]
    v_exp_f32 v183, v183
    v_mfma_f32_16x16x32_bf16 v[28:31], v[224:227], a[96:99], v[28:31]
    ds_read_b128 a[132:135], v240 offset:63488
    v_cvt_pk_bf16_f32 v224, v160, v161
    v_mfma_f32_16x16x32_bf16 v[60:63], v[228:231], a[96:99], v[60:63]
    v_exp_f32 v188, v188
    v_mfma_f32_16x16x32_bf16 v[92:95], v[232:235], a[96:99], v[92:95]
    v_cvt_pk_bf16_f32 v225, v162, v163
    s_waitcnt lgkmcnt(3)
    v_mfma_f32_16x16x32_bf16 v[192:195], a[140:143], a[0:3], 0
    v_exp_f32 v189, v189
    v_mfma_f32_16x16x32_bf16 v[200:203], a[140:143], a[16:19], 0
    ds_read_b128 a[136:139], v240 offset:64512
    v_cvt_pk_bf16_f32 v228, v168, v169
    v_mfma_f32_16x16x32_bf16 v[208:211], a[140:143], a[32:35], 0
    v_exp_f32 v190, v190
    v_mfma_f32_16x16x32_bf16 v[216:219], a[140:143], a[48:51], 0
    v_cvt_pk_bf16_f32 v229, v170, v171
    v_cvt_pk_bf16_f32 v226, v164, v165
    v_mfma_f32_16x16x32_bf16 v[192:195], a[144:147], a[4:7], v[192:195]
    v_exp_f32 v191, v191
    v_mfma_f32_16x16x32_bf16 v[200:203], a[144:147], a[20:23], v[200:203]
    ds_read_b128 a[140:143], v241 offset:49152
    v_cvt_pk_bf16_f32 v227, v166, v167
    v_mfma_f32_16x16x32_bf16 v[208:211], a[144:147], a[36:39], v[208:211]
    v_cvt_pk_bf16_f32 v230, v172, v173
    v_cvt_pk_bf16_f32 v231, v174, v175
    v_mfma_f32_16x16x32_bf16 v[216:219], a[144:147], a[52:55], v[216:219]
    v_cvt_pk_bf16_f32 v232, v176, v177
    v_cvt_pk_bf16_f32 v233, v178, v179
    v_mfma_f32_16x16x32_bf16 v[192:195], a[148:151], a[8:11], v[192:195]
    ds_read_b128 a[144:147], v241 offset:50176
    v_cvt_pk_bf16_f32 v234, v180, v181
    v_mfma_f32_16x16x32_bf16 v[200:203], a[148:151], a[24:27], v[200:203]
    v_cvt_pk_bf16_f32 v235, v182, v183
    v_cvt_pk_bf16_f32 v238, v188, v189
    v_mfma_f32_16x16x32_bf16 v[208:211], a[148:151], a[40:43], v[208:211]
    v_cvt_pk_bf16_f32 v239, v190, v191
    v_mfma_f32_16x16x32_bf16 v[216:219], a[148:151], a[56:59], v[216:219]
    v_mfma_f32_16x16x32_bf16 v[192:195], a[152:155], a[12:15], v[192:195]
    ds_read_b128 a[148:151], v241 offset:51200
    v_mfma_f32_16x16x32_bf16 v[200:203], a[152:155], a[28:31], v[200:203]
    v_mfma_f32_16x16x32_bf16 v[208:211], a[152:155], a[44:47], v[208:211]
    v_mfma_f32_16x16x32_bf16 v[216:219], a[152:155], a[60:63], v[216:219]
    s_waitcnt lgkmcnt(3)
    v_mfma_f32_16x16x32_bf16 v[196:199], a[156:159], a[0:3], 0
    s_nop 1
    v_exp_f32 v192, v192
    v_mfma_f32_16x16x32_bf16 v[204:207], a[156:159], a[16:19], 0
    ds_read_b128 a[152:155], v241 offset:52224
    v_mfma_f32_16x16x32_bf16 v[212:215], a[156:159], a[32:35], 0
    v_exp_f32 v193, v193
    v_mfma_f32_16x16x32_bf16 v[220:223], a[156:159], a[48:51], 0
    v_exp_f32 v194, v194
    v_mfma_f32_16x16x32_bf16 v[196:199], a[128:131], a[4:7], v[196:199]
    ds_read_b128 a[156:159], v241 offset:53248
    v_mfma_f32_16x16x32_bf16 v[204:207], a[128:131], a[20:23], v[204:207]
    v_exp_f32 v195, v195
    v_mfma_f32_16x16x32_bf16 v[212:215], a[128:131], a[36:39], v[212:215]
    v_exp_f32 v200, v200
    v_mfma_f32_16x16x32_bf16 v[220:223], a[128:131], a[52:55], v[220:223]
    v_exp_f32 v201, v201
    v_mfma_f32_16x16x32_bf16 v[196:199], a[132:135], a[8:11], v[196:199]
    ds_read_b128 a[128:131], v241 offset:54272
    v_mfma_f32_16x16x32_bf16 v[204:207], a[132:135], a[24:27], v[204:207]
    v_exp_f32 v202, v202
    v_mfma_f32_16x16x32_bf16 v[212:215], a[132:135], a[40:43], v[212:215]
    buffer_load_dwordx4 a[84:87], v243, s[12:15], s57 offen offset:64 nt
    v_mfma_f32_16x16x32_bf16 v[220:223], a[132:135], a[56:59], v[220:223]
    v_exp_f32 v203, v203
    v_mfma_f32_16x16x32_bf16 v[196:199], a[136:139], a[12:15], v[196:199]
    ds_read_b128 a[132:135], v241 offset:55296
    v_mfma_f32_16x16x32_bf16 v[204:207], a[136:139], a[28:31], v[204:207]
    v_exp_f32 v208, v208
    v_mfma_f32_16x16x32_bf16 v[212:215], a[136:139], a[44:47], v[212:215]
    v_exp_f32 v209, v209
    v_mfma_f32_16x16x32_bf16 v[220:223], a[136:139], a[60:63], v[220:223]
    v_exp_f32 v210, v210
    v_smfmac_f32_16x16x64_bf16 a[192:195], a[212:215], v[224:231], v247
    v_exp_f32 v211, v211
    v_smfmac_f32_16x16x64_bf16 a[196:199], a[212:215], v[232:239], v247
    s_waitcnt lgkmcnt(3)
    v_mfma_f32_16x16x32_bf16 v[0:3], v[224:227], a[140:143], v[0:3]
    v_exp_f32 v216, v216
    v_mfma_f32_16x16x32_bf16 v[32:35], v[228:231], a[140:143], v[32:35]
    ds_read_b128 a[136:139], v241 offset:56320
    v_mfma_f32_16x16x32_bf16 v[64:67], v[232:235], a[140:143], v[64:67]
    v_exp_f32 v217, v217
    v_mfma_f32_16x16x32_bf16 v[96:99], v[236:239], a[140:143], 0
    v_exp_f32 v218, v218
    v_mfma_f32_16x16x32_bf16 v[4:7], v[224:227], a[144:147], v[4:7]
    ds_read_b128 a[140:143], v240 offset:0
    v_mfma_f32_16x16x32_bf16 v[36:39], v[228:231], a[144:147], v[36:39]
    v_exp_f32 v219, v219
    v_mfma_f32_16x16x32_bf16 v[68:71], v[232:235], a[144:147], v[68:71]
    v_exp_f32 v196, v196
    v_mfma_f32_16x16x32_bf16 v[100:103], v[236:239], a[144:147], 0
    v_exp_f32 v197, v197
    v_mfma_f32_16x16x32_bf16 v[8:11], v[224:227], a[148:151], v[8:11]
    ds_read_b128 a[144:147], v240 offset:1024
    v_mfma_f32_16x16x32_bf16 v[40:43], v[228:231], a[148:151], v[40:43]
    v_exp_f32 v198, v198
    v_mfma_f32_16x16x32_bf16 v[72:75], v[232:235], a[148:151], v[72:75]
    v_exp_f32 v199, v199
    v_mfma_f32_16x16x32_bf16 v[104:107], v[236:239], a[148:151], 0
    v_exp_f32 v204, v204
    v_mfma_f32_16x16x32_bf16 v[12:15], v[224:227], a[152:155], v[12:15]
    ds_read_b128 a[148:151], v240 offset:2048
    v_mfma_f32_16x16x32_bf16 v[44:47], v[228:231], a[152:155], v[44:47]
    v_exp_f32 v205, v205
    v_mfma_f32_16x16x32_bf16 v[76:79], v[232:235], a[152:155], v[76:79]
    v_exp_f32 v206, v206
    v_mfma_f32_16x16x32_bf16 v[108:111], v[236:239], a[152:155], 0
    s_waitcnt lgkmcnt(3)
    v_mfma_f32_16x16x32_bf16 v[16:19], v[224:227], a[156:159], v[16:19]
    v_exp_f32 v207, v207
    v_mfma_f32_16x16x32_bf16 v[48:51], v[228:231], a[156:159], v[48:51]
    ds_read_b128 a[152:155], v240 offset:3072
    v_mfma_f32_16x16x32_bf16 v[80:83], v[232:235], a[156:159], v[80:83]
    v_exp_f32 v212, v212
    v_mfma_f32_16x16x32_bf16 v[112:115], v[236:239], a[156:159], 0
    v_exp_f32 v213, v213
    v_mfma_f32_16x16x32_bf16 v[20:23], v[224:227], a[128:131], v[20:23]
    ds_read_b128 a[156:159], v240 offset:4096
    v_mfma_f32_16x16x32_bf16 v[52:55], v[228:231], a[128:131], v[52:55]
    v_exp_f32 v214, v214
    v_mfma_f32_16x16x32_bf16 v[84:87], v[232:235], a[128:131], v[84:87]
    v_exp_f32 v215, v215
    v_mfma_f32_16x16x32_bf16 v[116:119], v[236:239], a[128:131], 0
    v_exp_f32 v220, v220
    v_mfma_f32_16x16x32_bf16 v[24:27], v[224:227], a[132:135], v[24:27]
    ds_read_b128 a[128:131], v240 offset:5120
    v_mfma_f32_16x16x32_bf16 v[56:59], v[228:231], a[132:135], v[56:59]
    v_exp_f32 v221, v221
    v_mfma_f32_16x16x32_bf16 v[88:91], v[232:235], a[132:135], v[88:91]
    buffer_load_dwordx4 a[88:91], v243, s[12:15], s57 offen offset:128 nt
    v_mfma_f32_16x16x32_bf16 v[120:123], v[236:239], a[132:135], 0
    v_exp_f32 v222, v222
    v_mfma_f32_16x16x32_bf16 v[28:31], v[224:227], a[136:139], v[28:31]
    ds_read_b128 a[132:135], v240 offset:6144
    v_cvt_pk_bf16_f32 v224, v192, v193
    v_mfma_f32_16x16x32_bf16 v[60:63], v[228:231], a[136:139], v[60:63]
    v_exp_f32 v223, v223
    v_mfma_f32_16x16x32_bf16 v[92:95], v[232:235], a[136:139], v[92:95]
    v_cvt_pk_bf16_f32 v225, v194, v195
    v_cvt_pk_bf16_f32 v228, v200, v201
    v_mfma_f32_16x16x32_bf16 v[124:127], v[236:239], a[136:139], 0
    v_cvt_pk_bf16_f32 v229, v202, v203
    s_waitcnt vmcnt(3) lgkmcnt(3)
    v_mfma_f32_16x16x32_bf16 v[168:171], a[140:143], a[16:19], 0
    ds_read_b128 a[136:139], v240 offset:7168
    v_cvt_pk_bf16_f32 v226, v196, v197
    v_mfma_f32_16x16x32_bf16 v[176:179], a[140:143], a[32:35], 0
    v_cvt_pk_bf16_f32 v227, v198, v199
    v_cvt_pk_bf16_f32 v230, v204, v205
    v_mfma_f32_16x16x32_bf16 v[184:187], a[140:143], a[48:51], 0
    v_cvt_pk_bf16_f32 v231, v206, v207
    v_cvt_pk_bf16_f32 v232, v208, v209
    v_mfma_f32_16x16x32_bf16 v[160:163], a[140:143], a[64:67], 0
    v_cvt_pk_bf16_f32 v233, v210, v211
    v_cvt_pk_bf16_f32 v236, v216, v217
    v_mfma_f32_16x16x32_bf16 v[168:171], a[144:147], a[20:23], v[168:171]
    ds_read_b128 a[140:143], v241 offset:57344
    v_cvt_pk_bf16_f32 v237, v218, v219
    v_mfma_f32_16x16x32_bf16 v[176:179], a[144:147], a[36:39], v[176:179]
    v_cvt_pk_bf16_f32 v234, v212, v213
    v_cvt_pk_bf16_f32 v235, v214, v215
    v_mfma_f32_16x16x32_bf16 v[184:187], a[144:147], a[52:55], v[184:187]
    v_cvt_pk_bf16_f32 v238, v220, v221
    v_cvt_pk_bf16_f32 v239, v222, v223
    v_mfma_f32_16x16x32_bf16 v[160:163], a[144:147], a[68:71], v[160:163]
    v_mfma_f32_16x16x32_bf16 v[168:171], a[148:151], a[24:27], v[168:171]
    ds_read_b128 a[144:147], v241 offset:58368
    v_mfma_f32_16x16x32_bf16 v[176:179], a[148:151], a[40:43], v[176:179]
    v_mfma_f32_16x16x32_bf16 v[184:187], a[148:151], a[56:59], v[184:187]
    v_mfma_f32_16x16x32_bf16 v[160:163], a[148:151], a[72:75], v[160:163]
    v_mfma_f32_16x16x32_bf16 v[168:171], a[152:155], a[28:31], v[168:171]
    ds_read_b128 a[148:151], v241 offset:59392
    v_mfma_f32_16x16x32_bf16 v[176:179], a[152:155], a[44:47], v[176:179]
    v_mfma_f32_16x16x32_bf16 v[184:187], a[152:155], a[60:63], v[184:187]
    v_mfma_f32_16x16x32_bf16 v[160:163], a[152:155], a[76:79], v[160:163]
    s_waitcnt lgkmcnt(3)
    v_mfma_f32_16x16x32_bf16 v[172:175], a[156:159], a[16:19], 0
    s_nop 1
    v_exp_f32 v168, v168
    v_mfma_f32_16x16x32_bf16 v[180:183], a[156:159], a[32:35], 0
    ds_read_b128 a[152:155], v241 offset:60416
    buffer_load_dwordx4 a[0:3], v243, s[12:15], s58 offen offset:0 nt
    v_mfma_f32_16x16x32_bf16 v[188:191], a[156:159], a[48:51], 0
    v_exp_f32 v169, v169
    v_mfma_f32_16x16x32_bf16 v[164:167], a[156:159], a[64:67], 0
    v_exp_f32 v170, v170
    v_mfma_f32_16x16x32_bf16 v[172:175], a[128:131], a[20:23], v[172:175]
    ds_read_b128 a[156:159], v241 offset:61440
    v_mfma_f32_16x16x32_bf16 v[180:183], a[128:131], a[36:39], v[180:183]
    v_exp_f32 v171, v171
    v_mfma_f32_16x16x32_bf16 v[188:191], a[128:131], a[52:55], v[188:191]
    v_exp_f32 v176, v176
    v_mfma_f32_16x16x32_bf16 v[164:167], a[128:131], a[68:71], v[164:167]
    v_exp_f32 v177, v177
    v_mfma_f32_16x16x32_bf16 v[172:175], a[132:135], a[24:27], v[172:175]
    ds_read_b128 a[128:131], v241 offset:62464
    v_mfma_f32_16x16x32_bf16 v[180:183], a[132:135], a[40:43], v[180:183]
    v_exp_f32 v178, v178
    v_mfma_f32_16x16x32_bf16 v[188:191], a[132:135], a[56:59], v[188:191]
    v_exp_f32 v179, v179
    v_mfma_f32_16x16x32_bf16 v[164:167], a[132:135], a[72:75], v[164:167]
    buffer_load_dwordx4 a[92:95], v243, s[12:15], s57 offen offset:192 nt
    v_mfma_f32_16x16x32_bf16 v[172:175], a[136:139], a[28:31], v[172:175]
    v_exp_f32 v184, v184
    v_mfma_f32_16x16x32_bf16 v[180:183], a[136:139], a[44:47], v[180:183]
    ds_read_b128 a[132:135], v241 offset:63488
    v_mfma_f32_16x16x32_bf16 v[188:191], a[136:139], a[60:63], v[188:191]
    v_exp_f32 v185, v185
    v_mfma_f32_16x16x32_bf16 v[164:167], a[136:139], a[76:79], v[164:167]
    v_exp_f32 v186, v186
    v_smfmac_f32_16x16x64_bf16 a[192:195], a[212:215], v[224:231], v247
    v_exp_f32 v187, v187
    v_smfmac_f32_16x16x64_bf16 a[196:199], a[212:215], v[232:239], v247
    s_waitcnt lgkmcnt(3)
    v_mfma_f32_16x16x32_bf16 v[0:3], v[224:227], a[140:143], v[0:3]
    v_exp_f32 v160, v160
    v_mfma_f32_16x16x32_bf16 v[32:35], v[228:231], a[140:143], v[32:35]
    ds_read_b128 a[136:139], v241 offset:64512
    v_mfma_f32_16x16x32_bf16 v[64:67], v[232:235], a[140:143], v[64:67]
    v_exp_f32 v161, v161
    v_mfma_f32_16x16x32_bf16 v[96:99], v[236:239], a[140:143], v[96:99]
    v_accvgpr_read_b32 v249, a192
    v_accvgpr_read_b32 v251, a193
    v_mfma_f32_16x16x32_bf16 v[4:7], v[224:227], a[144:147], v[4:7]
    v_exp_f32 v162, v162
    v_mfma_f32_16x16x32_bf16 v[36:39], v[228:231], a[144:147], v[36:39]
    ds_read_b128 a[140:143], v240 offset:8192
    v_add_f32 v249, v249, v251
    v_mfma_f32_16x16x32_bf16 v[68:71], v[232:235], a[144:147], v[68:71]
    v_exp_f32 v163, v163
    v_mfma_f32_16x16x32_bf16 v[100:103], v[236:239], a[144:147], v[100:103]
    v_subrev_u32 v246, s48, v249
    v_accvgpr_write_b32 a192, 0
    v_mfma_f32_16x16x32_bf16 v[8:11], v[224:227], a[148:151], v[8:11]
    v_exp_f32 v172, v172
    v_mfma_f32_16x16x32_bf16 v[40:43], v[228:231], a[148:151], v[40:43]
    ds_read_b128 a[144:147], v240 offset:9216
    v_max_u32 v253, v253, v246
    v_mfma_f32_16x16x32_bf16 v[72:75], v[232:235], a[148:151], v[72:75]
    v_exp_f32 v173, v173
    v_mfma_f32_16x16x32_bf16 v[104:107], v[236:239], a[148:151], v[104:107]
    v_rcp_f32 v244, v249
    v_mfma_f32_16x16x32_bf16 v[12:15], v[224:227], a[152:155], v[12:15]
    v_exp_f32 v174, v174
    v_mfma_f32_16x16x32_bf16 v[44:47], v[228:231], a[152:155], v[44:47]
    ds_read_b128 a[148:151], v240 offset:10240
    ds_bpermute_b32 v244, v242, v244
    v_mfma_f32_16x16x32_bf16 v[76:79], v[232:235], a[152:155], v[76:79]
    v_exp_f32 v175, v175
    v_mfma_f32_16x16x32_bf16 v[108:111], v[236:239], a[152:155], v[108:111]
    v_accvgpr_write_b32 a193, 0
    s_waitcnt lgkmcnt(4)
    v_mfma_f32_16x16x32_bf16 v[16:19], v[224:227], a[156:159], v[16:19]
    v_exp_f32 v180, v180
    v_mfma_f32_16x16x32_bf16 v[48:51], v[228:231], a[156:159], v[48:51]
    ds_read_b128 a[152:155], v240 offset:11264
    buffer_load_dwordx4 a[4:7], v243, s[12:15], s58 offen offset:64 nt
    v_mfma_f32_16x16x32_bf16 v[80:83], v[232:235], a[156:159], v[80:83]
    v_exp_f32 v181, v181
    v_mfma_f32_16x16x32_bf16 v[112:115], v[236:239], a[156:159], v[112:115]
    v_exp_f32 v182, v182
    v_mfma_f32_16x16x32_bf16 v[20:23], v[224:227], a[128:131], v[20:23]
    ds_read_b128 a[156:159], v240 offset:12288
    v_mfma_f32_16x16x32_bf16 v[52:55], v[228:231], a[128:131], v[52:55]
    v_exp_f32 v183, v183
    v_mfma_f32_16x16x32_bf16 v[84:87], v[232:235], a[128:131], v[84:87]
    s_waitcnt lgkmcnt(2)
    v_mul_f32_dpp v0, v244, v0 row_newbcast:0 row_mask:0xf bank_mask:0xf
    v_mul_f32_dpp v1, v244, v1 row_newbcast:1 row_mask:0xf bank_mask:0xf
    v_mfma_f32_16x16x32_bf16 v[116:119], v[236:239], a[128:131], v[116:119]
    v_exp_f32 v188, v188
    v_mfma_f32_16x16x32_bf16 v[24:27], v[224:227], a[132:135], v[24:27]
    ds_read_b128 a[128:131], v240 offset:13312
    v_mul_f32_dpp v2, v244, v2 row_newbcast:2 row_mask:0xf bank_mask:0xf
    v_mfma_f32_16x16x32_bf16 v[56:59], v[228:231], a[132:135], v[56:59]
    v_exp_f32 v189, v189
    v_mfma_f32_16x16x32_bf16 v[88:91], v[232:235], a[132:135], v[88:91]
    v_mul_f32_dpp v3, v244, v3 row_newbcast:3 row_mask:0xf bank_mask:0xf
    v_mul_f32_dpp v4, v244, v4 row_newbcast:0 row_mask:0xf bank_mask:0xf
    v_mfma_f32_16x16x32_bf16 v[120:123], v[236:239], a[132:135], v[120:123]
    v_exp_f32 v190, v190
    v_mfma_f32_16x16x32_bf16 v[28:31], v[224:227], a[136:139], v[28:31]
    ds_read_b128 a[132:135], v240 offset:14336
    v_cvt_pk_bf16_f32 v224, v160, v161
    v_mfma_f32_16x16x32_bf16 v[60:63], v[228:231], a[136:139], v[60:63]
    v_exp_f32 v191, v191
    v_mfma_f32_16x16x32_bf16 v[92:95], v[232:235], a[136:139], v[92:95]
    v_cvt_pk_bf16_f32 v228, v168, v169
    v_cvt_pk_bf16_f32 v229, v170, v171
    v_mfma_f32_16x16x32_bf16 v[124:127], v[236:239], a[136:139], v[124:127]
    v_cvt_pk_bf16_f32 v225, v162, v163
    v_mfma_f32_16x16x32_bf16 v[200:203], a[140:143], a[16:19], 0
    v_exp_f32 v164, v164
    v_mfma_f32_16x16x32_bf16 v[208:211], a[140:143], a[32:35], 0
    ds_read_b128 a[136:139], v240 offset:15360
    v_cvt_pk_bf16_f32 v230, v172, v173
    v_mfma_f32_16x16x32_bf16 v[216:219], a[140:143], a[48:51], 0
    v_exp_f32 v165, v165
    v_mfma_f32_16x16x32_bf16 v[192:195], a[140:143], a[64:67], 0
    v_cvt_pk_bf16_f32 v231, v174, v175
    v_cvt_pk_bf16_f32 v226, v164, v165
    v_mfma_f32_16x16x32_bf16 v[200:203], a[144:147], a[20:23], v[200:203]
    v_exp_f32 v166, v166
    v_mfma_f32_16x16x32_bf16 v[208:211], a[144:147], a[36:39], v[208:211]
    ds_read_b128 a[140:143], v241 offset:0
    v_cvt_pk_bf16_f32 v232, v176, v177
    v_mfma_f32_16x16x32_bf16 v[216:219], a[144:147], a[52:55], v[216:219]
    v_exp_f32 v167, v167
    v_mfma_f32_16x16x32_bf16 v[192:195], a[144:147], a[68:71], v[192:195]
    v_cvt_pk_bf16_f32 v227, v166, v167
    v_cvt_pk_bf16_f32 v233, v178, v179
    v_mfma_f32_16x16x32_bf16 v[200:203], a[148:151], a[24:27], v[200:203]
    ds_read_b128 a[144:147], v241 offset:1024
    v_cvt_pk_bf16_f32 v236, v184, v185
    v_mfma_f32_16x16x32_bf16 v[208:211], a[148:151], a[40:43], v[208:211]
    v_cvt_pk_bf16_f32 v237, v186, v187
    v_cvt_pk_bf16_f32 v234, v180, v181
    v_mfma_f32_16x16x32_bf16 v[216:219], a[148:151], a[56:59], v[216:219]
    v_cvt_pk_bf16_f32 v235, v182, v183
    v_cvt_pk_bf16_f32 v238, v188, v189
    v_mfma_f32_16x16x32_bf16 v[192:195], a[148:151], a[72:75], v[192:195]
    v_cvt_pk_bf16_f32 v239, v190, v191
    v_mul_f32_dpp v5, v244, v5 row_newbcast:1 row_mask:0xf bank_mask:0xf
    s_waitcnt lgkmcnt(6)
    v_mfma_f32_16x16x32_bf16 v[200:203], a[152:155], a[28:31], v[200:203]
    ds_read_b128 a[148:151], v241 offset:2048
    v_mul_f32_dpp v6, v244, v6 row_newbcast:2 row_mask:0xf bank_mask:0xf
    v_mfma_f32_16x16x32_bf16 v[208:211], a[152:155], a[44:47], v[208:211]
    v_mul_f32_dpp v7, v244, v7 row_newbcast:3 row_mask:0xf bank_mask:0xf
    v_mul_f32_dpp v8, v244, v8 row_newbcast:0 row_mask:0xf bank_mask:0xf
    v_mfma_f32_16x16x32_bf16 v[216:219], a[152:155], a[60:63], v[216:219]
    v_mul_f32_dpp v12, v244, v12 row_newbcast:0 row_mask:0xf bank_mask:0xf
    v_mul_f32_dpp v16, v244, v16 row_newbcast:0 row_mask:0xf bank_mask:0xf
    v_mfma_f32_16x16x32_bf16 v[192:195], a[152:155], a[76:79], v[192:195]
    v_mul_f32_dpp v20, v244, v20 row_newbcast:0 row_mask:0xf bank_mask:0xf
    s_waitcnt lgkmcnt(3)
    v_mfma_f32_16x16x32_bf16 v[204:207], a[156:159], a[16:19], 0
    v_exp_f32 v200, v200
    v_mfma_f32_16x16x32_bf16 v[212:215], a[156:159], a[32:35], 0
    ds_read_b128 a[152:155], v241 offset:3072
    v_mul_f32_dpp v24, v244, v24 row_newbcast:0 row_mask:0xf bank_mask:0xf
    v_mfma_f32_16x16x32_bf16 v[220:223], a[156:159], a[48:51], 0
    v_exp_f32 v201, v201
    v_mfma_f32_16x16x32_bf16 v[196:199], a[156:159], a[64:67], 0
    buffer_load_dwordx4 a[8:11], v243, s[12:15], s58 offen offset:128 nt
    v_mul_f32_dpp v28, v244, v28 row_newbcast:0 row_mask:0xf bank_mask:0xf
    v_mfma_f32_16x16x32_bf16 v[204:207], a[128:131], a[20:23], v[204:207]
    v_exp_f32 v202, v202
    v_mfma_f32_16x16x32_bf16 v[212:215], a[128:131], a[36:39], v[212:215]
    ds_read_b128 a[156:159], v241 offset:4096
    v_cvt_pk_bf16_f32 v0, v0, v4
    v_mfma_f32_16x16x32_bf16 v[220:223], a[128:131], a[52:55], v[220:223]
    v_exp_f32 v203, v203
    v_mfma_f32_16x16x32_bf16 v[196:199], a[128:131], a[68:71], v[196:199]
    v_cvt_pk_bf16_f32 v4, v1, v5
    v_cvt_pk_bf16_f32 v1, v8, v12
    v_mfma_f32_16x16x32_bf16 v[204:207], a[132:135], a[24:27], v[204:207]
    v_exp_f32 v208, v208
    v_mfma_f32_16x16x32_bf16 v[212:215], a[132:135], a[40:43], v[212:215]
    ds_read_b128 a[128:131], v241 offset:5120
    v_cvt_pk_bf16_f32 v8, v2, v6
    v_mfma_f32_16x16x32_bf16 v[220:223], a[132:135], a[56:59], v[220:223]
    v_exp_f32 v209, v209
    v_mfma_f32_16x16x32_bf16 v[196:199], a[132:135], a[72:75], v[196:199]
    v_cvt_pk_bf16_f32 v12, v3, v7
    v_cvt_pk_bf16_f32 v2, v16, v20
    v_mfma_f32_16x16x32_bf16 v[204:207], a[136:139], a[28:31], v[204:207]
    v_exp_f32 v210, v210
    v_mfma_f32_16x16x32_bf16 v[212:215], a[136:139], a[44:47], v[212:215]
    ds_read_b128 a[132:135], v241 offset:6144
    v_cvt_pk_bf16_f32 v3, v24, v28
    v_mfma_f32_16x16x32_bf16 v[220:223], a[136:139], a[60:63], v[220:223]
    v_exp_f32 v211, v211
    v_mfma_f32_16x16x32_bf16 v[196:199], a[136:139], a[76:79], v[196:199]
    v_mul_f32_dpp v9, v244, v9 row_newbcast:1 row_mask:0xf bank_mask:0xf
    v_mul_f32_dpp v13, v244, v13 row_newbcast:1 row_mask:0xf bank_mask:0xf
    v_smfmac_f32_16x16x64_bf16 a[192:195], a[212:215], v[224:231], v247
    v_exp_f32 v216, v216
    v_smfmac_f32_16x16x64_bf16 a[196:199], a[212:215], v[232:239], v247
    v_mul_f32_dpp v17, v244, v17 row_newbcast:1 row_mask:0xf bank_mask:0xf
    s_waitcnt lgkmcnt(3)
    v_mfma_f32_16x16x32_bf16 v[32:35], v[228:231], a[140:143], v[32:35]
    v_exp_f32 v217, v217
    v_mfma_f32_16x16x32_bf16 v[64:67], v[232:235], a[140:143], v[64:67]
    ds_read_b128 a[136:139], v241 offset:7168
    v_mul_f32_dpp v21, v244, v21 row_newbcast:1 row_mask:0xf bank_mask:0xf
    v_mfma_f32_16x16x32_bf16 v[96:99], v[236:239], a[140:143], v[96:99]
    v_exp_f32 v218, v218
    v_mfma_f32_16x16x32_bf16 v[128:131], v[224:227], a[140:143], 0
    v_mul_f32_dpp v25, v244, v25 row_newbcast:1 row_mask:0xf bank_mask:0xf
    v_mul_f32_dpp v29, v244, v29 row_newbcast:1 row_mask:0xf bank_mask:0xf
    v_mfma_f32_16x16x32_bf16 v[36:39], v[228:231], a[144:147], v[36:39]
    v_exp_f32 v219, v219
    v_mfma_f32_16x16x32_bf16 v[68:71], v[232:235], a[144:147], v[68:71]
    ds_read_b128 a[140:143], v240 offset:16384
    v_cvt_pk_bf16_f32 v5, v9, v13
    v_mfma_f32_16x16x32_bf16 v[100:103], v[236:239], a[144:147], v[100:103]
    v_exp_f32 v192, v192
    v_mfma_f32_16x16x32_bf16 v[132:135], v[224:227], a[144:147], 0
    v_cvt_pk_bf16_f32 v6, v17, v21
    v_cvt_pk_bf16_f32 v7, v25, v29
    v_mfma_f32_16x16x32_bf16 v[40:43], v[228:231], a[148:151], v[40:43]
    v_exp_f32 v193, v193
    v_mfma_f32_16x16x32_bf16 v[72:75], v[232:235], a[148:151], v[72:75]
    ds_read_b128 a[144:147], v240 offset:17408
    v_mul_f32_dpp v10, v244, v10 row_newbcast:2 row_mask:0xf bank_mask:0xf
    v_mfma_f32_16x16x32_bf16 v[104:107], v[236:239], a[148:151], v[104:107]
    v_exp_f32 v194, v194
    v_mfma_f32_16x16x32_bf16 v[136:139], v[224:227], a[148:151], 0
    v_mul_f32_dpp v11, v244, v11 row_newbcast:3 row_mask:0xf bank_mask:0xf
    v_mul_f32_dpp v14, v244, v14 row_newbcast:2 row_mask:0xf bank_mask:0xf
    v_mfma_f32_16x16x32_bf16 v[44:47], v[228:231], a[152:155], v[44:47]
    v_exp_f32 v195, v195
    v_mfma_f32_16x16x32_bf16 v[76:79], v[232:235], a[152:155], v[76:79]
    ds_read_b128 a[148:151], v240 offset:18432
    v_mul_f32_dpp v15, v244, v15 row_newbcast:3 row_mask:0xf bank_mask:0xf
    v_mfma_f32_16x16x32_bf16 v[108:111], v[236:239], a[152:155], v[108:111]
    v_exp_f32 v204, v204
    v_mfma_f32_16x16x32_bf16 v[140:143], v[224:227], a[152:155], 0
    v_mul_f32_dpp v18, v244, v18 row_newbcast:2 row_mask:0xf bank_mask:0xf
    s_waitcnt lgkmcnt(3)
    v_mfma_f32_16x16x32_bf16 v[48:51], v[228:231], a[156:159], v[48:51]
    v_exp_f32 v205, v205
    v_mfma_f32_16x16x32_bf16 v[80:83], v[232:235], a[156:159], v[80:83]
    ds_read_b128 a[152:155], v240 offset:19456
    v_mul_f32_dpp v22, v244, v22 row_newbcast:2 row_mask:0xf bank_mask:0xf
    v_mfma_f32_16x16x32_bf16 v[112:115], v[236:239], a[156:159], v[112:115]
    v_exp_f32 v206, v206
    v_mfma_f32_16x16x32_bf16 v[144:147], v[224:227], a[156:159], 0
    buffer_load_dwordx4 a[12:15], v243, s[12:15], s58 offen offset:192 nt
    v_mul_f32_dpp v26, v244, v26 row_newbcast:2 row_mask:0xf bank_mask:0xf
    v_mfma_f32_16x16x32_bf16 v[52:55], v[228:231], a[128:131], v[52:55]
    v_exp_f32 v207, v207
    v_mfma_f32_16x16x32_bf16 v[84:87], v[232:235], a[128:131], v[84:87]
    ds_read_b128 a[156:159], v240 offset:20480
    v_mul_f32_dpp v30, v244, v30 row_newbcast:2 row_mask:0xf bank_mask:0xf
    v_mfma_f32_16x16x32_bf16 v[116:119], v[236:239], a[128:131], v[116:119]
    v_exp_f32 v212, v212
    v_mfma_f32_16x16x32_bf16 v[148:151], v[224:227], a[128:131], 0
    v_cvt_pk_bf16_f32 v9, v10, v14
    v_cvt_pk_bf16_f32 v10, v18, v22
    v_mfma_f32_16x16x32_bf16 v[56:59], v[228:231], a[132:135], v[56:59]
    v_exp_f32 v213, v213
    v_mfma_f32_16x16x32_bf16 v[88:91], v[232:235], a[132:135], v[88:91]
    ds_read_b128 a[128:131], v240 offset:21504
    buffer_store_dwordx4 v[0:3], v248, s[16:19], s52 offen offset:0 sc0 sc1
    v_mfma_f32_16x16x32_bf16 v[120:123], v[236:239], a[132:135], v[120:123]
    v_exp_f32 v214, v214
    v_mfma_f32_16x16x32_bf16 v[152:155], v[224:227], a[132:135], 0
    v_cvt_pk_bf16_f32 v13, v11, v15
    v_cvt_pk_bf16_f32 v11, v26, v30
    v_mfma_f32_16x16x32_bf16 v[60:63], v[228:231], a[136:139], v[60:63]
    v_exp_f32 v215, v215
    v_mfma_f32_16x16x32_bf16 v[92:95], v[232:235], a[136:139], v[92:95]
    ds_read_b128 a[132:135], v240 offset:22528
    v_cvt_pk_bf16_f32 v228, v200, v201
    v_mfma_f32_16x16x32_bf16 v[124:127], v[236:239], a[136:139], v[124:127]
    v_exp_f32 v220, v220
    v_mfma_f32_16x16x32_bf16 v[156:159], v[224:227], a[136:139], 0
    v_cvt_pk_bf16_f32 v229, v202, v203
    s_waitcnt vmcnt(4) lgkmcnt(3)
    v_mfma_f32_16x16x32_bf16 v[176:179], a[140:143], a[32:35], 0
    v_exp_f32 v221, v221
    v_mfma_f32_16x16x32_bf16 v[184:187], a[140:143], a[48:51], 0
    ds_read_b128 a[136:139], v240 offset:23552
    v_cvt_pk_bf16_f32 v224, v192, v193
    v_mfma_f32_16x16x32_bf16 v[160:163], a[140:143], a[64:67], 0
    v_exp_f32 v222, v222
    v_mfma_f32_16x16x32_bf16 v[168:171], a[140:143], a[80:83], 0
    v_cvt_pk_bf16_f32 v225, v194, v195
    v_cvt_pk_bf16_f32 v230, v204, v205
    v_mfma_f32_16x16x32_bf16 v[176:179], a[144:147], a[36:39], v[176:179]
    v_exp_f32 v223, v223
    v_mfma_f32_16x16x32_bf16 v[184:187], a[144:147], a[52:55], v[184:187]
    ds_read_b128 a[140:143], v241 offset:8192
    v_cvt_pk_bf16_f32 v231, v206, v207
    v_mfma_f32_16x16x32_bf16 v[160:163], a[144:147], a[68:71], v[160:163]
    v_exp_f32 v196, v196
    v_mfma_f32_16x16x32_bf16 v[168:171], a[144:147], a[84:87], v[168:171]
    v_cvt_pk_bf16_f32 v232, v208, v209
    v_cvt_pk_bf16_f32 v233, v210, v211
    v_mfma_f32_16x16x32_bf16 v[176:179], a[148:151], a[40:43], v[176:179]
    v_exp_f32 v197, v197
    v_mfma_f32_16x16x32_bf16 v[184:187], a[148:151], a[56:59], v[184:187]
    ds_read_b128 a[144:147], v241 offset:9216
    v_cvt_pk_bf16_f32 v226, v196, v197
    v_mfma_f32_16x16x32_bf16 v[160:163], a[148:151], a[72:75], v[160:163]
    v_exp_f32 v198, v198
    v_mfma_f32_16x16x32_bf16 v[168:171], a[148:151], a[88:91], v[168:171]
    v_cvt_pk_bf16_f32 v236, v216, v217
    v_cvt_pk_bf16_f32 v237, v218, v219
    v_mfma_f32_16x16x32_bf16 v[176:179], a[152:155], a[44:47], v[176:179]
    v_exp_f32 v199, v199
    v_mfma_f32_16x16x32_bf16 v[184:187], a[152:155], a[60:63], v[184:187]
    ds_read_b128 a[148:151], v241 offset:10240
    v_cvt_pk_bf16_f32 v227, v198, v199
    v_mfma_f32_16x16x32_bf16 v[160:163], a[152:155], a[76:79], v[160:163]
    v_cvt_pk_bf16_f32 v234, v212, v213
    v_cvt_pk_bf16_f32 v235, v214, v215
    v_mfma_f32_16x16x32_bf16 v[168:171], a[152:155], a[92:95], v[168:171]
    v_cvt_pk_bf16_f32 v238, v220, v221
    s_waitcnt lgkmcnt(3)
    v_mfma_f32_16x16x32_bf16 v[180:183], a[156:159], a[32:35], 0
    v_exp_f32 v176, v176
    v_mfma_f32_16x16x32_bf16 v[188:191], a[156:159], a[48:51], 0
    ds_read_b128 a[152:155], v241 offset:11264
    buffer_load_dwordx4 a[16:19], v243, s[12:15], s59 offen offset:0 nt
    v_mfma_f32_16x16x32_bf16 v[164:167], a[156:159], a[64:67], 0
    v_exp_f32 v177, v177
    v_mfma_f32_16x16x32_bf16 v[172:175], a[156:159], a[80:83], 0
    v_cvt_pk_bf16_f32 v239, v222, v223
    v_mul_f32_dpp v19, v244, v19 row_newbcast:3 row_mask:0xf bank_mask:0xf
    v_mfma_f32_16x16x32_bf16 v[180:183], a[128:131], a[36:39], v[180:183]
    v_exp_f32 v178, v178
    v_mfma_f32_16x16x32_bf16 v[188:191], a[128:131], a[52:55], v[188:191]
    ds_read_b128 a[156:159], v241 offset:12288
    v_mul_f32_dpp v23, v244, v23 row_newbcast:3 row_mask:0xf bank_mask:0xf
    v_mfma_f32_16x16x32_bf16 v[164:167], a[128:131], a[68:71], v[164:167]
    v_exp_f32 v179, v179
    v_mfma_f32_16x16x32_bf16 v[172:175], a[128:131], a[84:87], v[172:175]
    v_mul_f32_dpp v27, v244, v27 row_newbcast:3 row_mask:0xf bank_mask:0xf
    v_mul_f32_dpp v31, v244, v31 row_newbcast:3 row_mask:0xf bank_mask:0xf
    v_mfma_f32_16x16x32_bf16 v[180:183], a[132:135], a[40:43], v[180:183]
    v_exp_f32 v184, v184
    v_mfma_f32_16x16x32_bf16 v[188:191], a[132:135], a[56:59], v[188:191]
    ds_read_b128 a[128:131], v241 offset:13312
    v_cvt_pk_bf16_f32 v14, v19, v23
    v_mfma_f32_16x16x32_bf16 v[164:167], a[132:135], a[72:75], v[164:167]
    v_exp_f32 v185, v185
    v_mfma_f32_16x16x32_bf16 v[172:175], a[132:135], a[88:91], v[172:175]
    v_cvt_pk_bf16_f32 v15, v27, v31
    v_mfma_f32_16x16x32_bf16 v[180:183], a[136:139], a[44:47], v[180:183]
    v_exp_f32 v186, v186
    v_mfma_f32_16x16x32_bf16 v[188:191], a[136:139], a[60:63], v[188:191]
    buffer_store_dwordx4 v[4:7], v248, s[16:19], s52 offen offset:256 sc0 sc1
    ds_read_b128 a[132:135], v241 offset:14336
    v_mfma_f32_16x16x32_bf16 v[164:167], a[136:139], a[76:79], v[164:167]
    v_exp_f32 v187, v187
    v_mfma_f32_16x16x32_bf16 v[172:175], a[136:139], a[92:95], v[172:175]
    v_exp_f32 v160, v160
    v_smfmac_f32_16x16x64_bf16 a[192:195], a[212:215], v[224:231], v247
    v_exp_f32 v161, v161
    v_smfmac_f32_16x16x64_bf16 a[196:199], a[212:215], v[232:239], v247
    s_waitcnt lgkmcnt(3)
    v_mfma_f32_16x16x32_bf16 v[32:35], v[228:231], a[140:143], v[32:35]
    v_exp_f32 v162, v162
    v_mfma_f32_16x16x32_bf16 v[64:67], v[232:235], a[140:143], v[64:67]
    ds_read_b128 a[136:139], v241 offset:15360
    v_mfma_f32_16x16x32_bf16 v[96:99], v[236:239], a[140:143], v[96:99]
    v_exp_f32 v163, v163
    v_mfma_f32_16x16x32_bf16 v[128:131], v[224:227], a[140:143], v[128:131]
    v_accvgpr_read_b32 v250, a194
    v_accvgpr_read_b32 v251, a195
    v_mfma_f32_16x16x32_bf16 v[36:39], v[228:231], a[144:147], v[36:39]
    v_exp_f32 v168, v168
    v_mfma_f32_16x16x32_bf16 v[68:71], v[232:235], a[144:147], v[68:71]
    ds_read_b128 a[140:143], v240 offset:24576
    v_add_f32 v250, v250, v251
    v_mfma_f32_16x16x32_bf16 v[100:103], v[236:239], a[144:147], v[100:103]
    v_exp_f32 v169, v169
    v_mfma_f32_16x16x32_bf16 v[132:135], v[224:227], a[144:147], v[132:135]
    v_subrev_u32 v246, s48, v250
    v_accvgpr_write_b32 a194, 0
    v_mfma_f32_16x16x32_bf16 v[40:43], v[228:231], a[148:151], v[40:43]
    v_exp_f32 v170, v170
    v_mfma_f32_16x16x32_bf16 v[72:75], v[232:235], a[148:151], v[72:75]
    ds_read_b128 a[144:147], v240 offset:25600
    v_max_u32 v253, v253, v246
    v_mfma_f32_16x16x32_bf16 v[104:107], v[236:239], a[148:151], v[104:107]
    v_exp_f32 v171, v171
    v_mfma_f32_16x16x32_bf16 v[136:139], v[224:227], a[148:151], v[136:139]
    v_rcp_f32 v245, v250
    v_mfma_f32_16x16x32_bf16 v[44:47], v[228:231], a[152:155], v[44:47]
    v_exp_f32 v180, v180
    v_mfma_f32_16x16x32_bf16 v[76:79], v[232:235], a[152:155], v[76:79]
    ds_read_b128 a[148:151], v240 offset:26624
    ds_bpermute_b32 v245, v242, v245
    v_mfma_f32_16x16x32_bf16 v[108:111], v[236:239], a[152:155], v[108:111]
    v_exp_f32 v181, v181
    v_mfma_f32_16x16x32_bf16 v[140:143], v[224:227], a[152:155], v[140:143]
    v_accvgpr_write_b32 a195, 0
    s_waitcnt lgkmcnt(4)
    v_mfma_f32_16x16x32_bf16 v[48:51], v[228:231], a[156:159], v[48:51]
    v_exp_f32 v182, v182
    v_mfma_f32_16x16x32_bf16 v[80:83], v[232:235], a[156:159], v[80:83]
    ds_read_b128 a[152:155], v240 offset:27648
    buffer_load_dwordx4 a[20:23], v243, s[12:15], s59 offen offset:64 nt
    v_mfma_f32_16x16x32_bf16 v[112:115], v[236:239], a[156:159], v[112:115]
    v_exp_f32 v183, v183
    v_mfma_f32_16x16x32_bf16 v[144:147], v[224:227], a[156:159], v[144:147]
    v_exp_f32 v188, v188
    v_mfma_f32_16x16x32_bf16 v[52:55], v[228:231], a[128:131], v[52:55]
    ds_read_b128 a[156:159], v240 offset:28672
    v_mfma_f32_16x16x32_bf16 v[84:87], v[232:235], a[128:131], v[84:87]
    v_exp_f32 v189, v189
    v_mfma_f32_16x16x32_bf16 v[116:119], v[236:239], a[128:131], v[116:119]
    s_waitcnt lgkmcnt(2)
    v_mul_f32_dpp v32, v245, v32 row_newbcast:0 row_mask:0xf bank_mask:0xf
    v_mul_f32_dpp v33, v245, v33 row_newbcast:1 row_mask:0xf bank_mask:0xf
    v_mfma_f32_16x16x32_bf16 v[148:151], v[224:227], a[128:131], v[148:151]
    v_exp_f32 v190, v190
    v_mfma_f32_16x16x32_bf16 v[56:59], v[228:231], a[132:135], v[56:59]
    ds_read_b128 a[128:131], v240 offset:29696
    v_mul_f32_dpp v34, v245, v34 row_newbcast:2 row_mask:0xf bank_mask:0xf
    v_mfma_f32_16x16x32_bf16 v[88:91], v[232:235], a[132:135], v[88:91]
    v_exp_f32 v191, v191
    v_mfma_f32_16x16x32_bf16 v[120:123], v[236:239], a[132:135], v[120:123]
    v_mul_f32_dpp v35, v245, v35 row_newbcast:3 row_mask:0xf bank_mask:0xf
    v_mul_f32_dpp v36, v245, v36 row_newbcast:0 row_mask:0xf bank_mask:0xf
    v_mfma_f32_16x16x32_bf16 v[152:155], v[224:227], a[132:135], v[152:155]
    v_exp_f32 v164, v164
    v_mfma_f32_16x16x32_bf16 v[60:63], v[228:231], a[136:139], v[60:63]
    ds_read_b128 a[132:135], v240 offset:30720
    v_cvt_pk_bf16_f32 v228, v168, v169
    v_mfma_f32_16x16x32_bf16 v[92:95], v[232:235], a[136:139], v[92:95]
    v_exp_f32 v165, v165
    v_mfma_f32_16x16x32_bf16 v[124:127], v[236:239], a[136:139], v[124:127]
    buffer_store_dwordx4 v[8:11], v248, s[16:19], s52 offen offset:512 sc0 sc1
    v_cvt_pk_bf16_f32 v232, v176, v177
    v_mfma_f32_16x16x32_bf16 v[156:159], v[224:227], a[136:139], v[156:159]
    v_cvt_pk_bf16_f32 v233, v178, v179
    v_mfma_f32_16x16x32_bf16 v[208:211], a[140:143], a[32:35], 0
    v_exp_f32 v166, v166
    v_mfma_f32_16x16x32_bf16 v[216:219], a[140:143], a[48:51], 0
    ds_read_b128 a[136:139], v240 offset:31744
    v_cvt_pk_bf16_f32 v236, v184, v185
    v_mfma_f32_16x16x32_bf16 v[192:195], a[140:143], a[64:67], 0
    v_exp_f32 v167, v167
    v_mfma_f32_16x16x32_bf16 v[200:203], a[140:143], a[80:83], 0
    v_cvt_pk_bf16_f32 v237, v186, v187
    v_cvt_pk_bf16_f32 v234, v180, v181
    v_mfma_f32_16x16x32_bf16 v[208:211], a[144:147], a[36:39], v[208:211]
    v_exp_f32 v172, v172
    v_mfma_f32_16x16x32_bf16 v[216:219], a[144:147], a[52:55], v[216:219]
    ds_read_b128 a[140:143], v241 offset:16384
    v_cvt_pk_bf16_f32 v235, v182, v183
    v_mfma_f32_16x16x32_bf16 v[192:195], a[144:147], a[68:71], v[192:195]
    v_exp_f32 v173, v173
    v_mfma_f32_16x16x32_bf16 v[200:203], a[144:147], a[84:87], v[200:203]
    v_cvt_pk_bf16_f32 v238, v188, v189
    v_cvt_pk_bf16_f32 v239, v190, v191
    v_mfma_f32_16x16x32_bf16 v[208:211], a[148:151], a[40:43], v[208:211]
    v_exp_f32 v174, v174
    v_mfma_f32_16x16x32_bf16 v[216:219], a[148:151], a[56:59], v[216:219]
    ds_read_b128 a[144:147], v241 offset:17408
    v_cvt_pk_bf16_f32 v224, v160, v161
    v_mfma_f32_16x16x32_bf16 v[192:195], a[148:151], a[72:75], v[192:195]
    v_exp_f32 v175, v175
    v_mfma_f32_16x16x32_bf16 v[200:203], a[148:151], a[88:91], v[200:203]
    v_cvt_pk_bf16_f32 v225, v162, v163
    v_cvt_pk_bf16_f32 v229, v170, v171
    s_waitcnt lgkmcnt(6)
    v_mfma_f32_16x16x32_bf16 v[208:211], a[152:155], a[44:47], v[208:211]
    ds_read_b128 a[148:151], v241 offset:18432
    v_cvt_pk_bf16_f32 v226, v164, v165
    v_mfma_f32_16x16x32_bf16 v[216:219], a[152:155], a[60:63], v[216:219]
    v_cvt_pk_bf16_f32 v227, v166, v167
    v_cvt_pk_bf16_f32 v230, v172, v173
    v_mfma_f32_16x16x32_bf16 v[192:195], a[152:155], a[76:79], v[192:195]
    v_cvt_pk_bf16_f32 v231, v174, v175
    v_mul_f32_dpp v37, v245, v37 row_newbcast:1 row_mask:0xf bank_mask:0xf
    v_mfma_f32_16x16x32_bf16 v[200:203], a[152:155], a[92:95], v[200:203]
    v_mul_f32_dpp v38, v245, v38 row_newbcast:2 row_mask:0xf bank_mask:0xf
    s_waitcnt lgkmcnt(3)
    v_mfma_f32_16x16x32_bf16 v[212:215], a[156:159], a[32:35], 0
    v_exp_f32 v208, v208
    v_mfma_f32_16x16x32_bf16 v[220:223], a[156:159], a[48:51], 0
    ds_read_b128 a[152:155], v241 offset:19456
    v_mul_f32_dpp v39, v245, v39 row_newbcast:3 row_mask:0xf bank_mask:0xf
    v_mfma_f32_16x16x32_bf16 v[196:199], a[156:159], a[64:67], 0
    v_exp_f32 v209, v209
    v_mfma_f32_16x16x32_bf16 v[204:207], a[156:159], a[80:83], 0
    buffer_load_dwordx4 a[24:27], v243, s[12:15], s59 offen offset:128 nt
    v_mul_f32_dpp v40, v245, v40 row_newbcast:0 row_mask:0xf bank_mask:0xf
    v_mfma_f32_16x16x32_bf16 v[212:215], a[128:131], a[36:39], v[212:215]
    v_exp_f32 v210, v210
    v_mfma_f32_16x16x32_bf16 v[220:223], a[128:131], a[52:55], v[220:223]
    ds_read_b128 a[156:159], v241 offset:20480
    v_mul_f32_dpp v44, v245, v44 row_newbcast:0 row_mask:0xf bank_mask:0xf
    v_mfma_f32_16x16x32_bf16 v[196:199], a[128:131], a[68:71], v[196:199]
    v_exp_f32 v211, v211
    v_mfma_f32_16x16x32_bf16 v[204:207], a[128:131], a[84:87], v[204:207]
    v_mul_f32_dpp v48, v245, v48 row_newbcast:0 row_mask:0xf bank_mask:0xf
    v_mul_f32_dpp v52, v245, v52 row_newbcast:0 row_mask:0xf bank_mask:0xf
    v_mfma_f32_16x16x32_bf16 v[212:215], a[132:135], a[40:43], v[212:215]
    v_exp_f32 v216, v216
    v_mfma_f32_16x16x32_bf16 v[220:223], a[132:135], a[56:59], v[220:223]
    ds_read_b128 a[128:131], v241 offset:21504
    v_mul_f32_dpp v56, v245, v56 row_newbcast:0 row_mask:0xf bank_mask:0xf
    v_mfma_f32_16x16x32_bf16 v[196:199], a[132:135], a[72:75], v[196:199]
    v_exp_f32 v217, v217
    v_mfma_f32_16x16x32_bf16 v[204:207], a[132:135], a[88:91], v[204:207]
    v_mul_f32_dpp v60, v245, v60 row_newbcast:0 row_mask:0xf bank_mask:0xf
    v_cvt_pk_bf16_f32 v32, v32, v36
    v_mfma_f32_16x16x32_bf16 v[212:215], a[136:139], a[44:47], v[212:215]
    v_exp_f32 v218, v218
    v_mfma_f32_16x16x32_bf16 v[220:223], a[136:139], a[60:63], v[220:223]
    ds_read_b128 a[132:135], v241 offset:22528
    v_cvt_pk_bf16_f32 v36, v33, v37
    v_mfma_f32_16x16x32_bf16 v[196:199], a[136:139], a[76:79], v[196:199]
    v_exp_f32 v219, v219
    v_mfma_f32_16x16x32_bf16 v[204:207], a[136:139], a[92:95], v[204:207]
    v_cvt_pk_bf16_f32 v33, v40, v44
    v_cvt_pk_bf16_f32 v40, v34, v38
    v_smfmac_f32_16x16x64_bf16 a[196:199], a[212:215], v[232:239], v247
    v_exp_f32 v192, v192
    v_smfmac_f32_16x16x64_bf16 a[192:195], a[212:215], v[224:231], v247
    buffer_store_dwordx4 v[12:15], v248, s[16:19], s52 offen offset:768 sc0 sc1
    s_waitcnt lgkmcnt(3)
    v_mfma_f32_16x16x32_bf16 v[64:67], v[232:235], a[140:143], v[64:67]
    v_exp_f32 v193, v193
    v_mfma_f32_16x16x32_bf16 v[96:99], v[236:239], a[140:143], v[96:99]
    ds_read_b128 a[136:139], v241 offset:23552
    v_cvt_pk_bf16_f32 v44, v35, v39
    v_mfma_f32_16x16x32_bf16 v[128:131], v[224:227], a[140:143], v[128:131]
    v_exp_f32 v194, v194
    v_mfma_f32_16x16x32_bf16 v[0:3], v[228:231], a[140:143], 0
    v_cvt_pk_bf16_f32 v34, v48, v52
    v_cvt_pk_bf16_f32 v35, v56, v60
    v_mfma_f32_16x16x32_bf16 v[68:71], v[232:235], a[144:147], v[68:71]
    v_exp_f32 v195, v195
    v_mfma_f32_16x16x32_bf16 v[100:103], v[236:239], a[144:147], v[100:103]
    ds_read_b128 a[140:143], v240 offset:32768
    v_mul_f32_dpp v41, v245, v41 row_newbcast:1 row_mask:0xf bank_mask:0xf
    v_mfma_f32_16x16x32_bf16 v[132:135], v[224:227], a[144:147], v[132:135]
    v_exp_f32 v200, v200
    v_mfma_f32_16x16x32_bf16 v[4:7], v[228:231], a[144:147], 0
    v_mul_f32_dpp v45, v245, v45 row_newbcast:1 row_mask:0xf bank_mask:0xf
    v_mul_f32_dpp v49, v245, v49 row_newbcast:1 row_mask:0xf bank_mask:0xf
    v_mfma_f32_16x16x32_bf16 v[72:75], v[232:235], a[148:151], v[72:75]
    v_exp_f32 v201, v201
    v_mfma_f32_16x16x32_bf16 v[104:107], v[236:239], a[148:151], v[104:107]
    ds_read_b128 a[144:147], v240 offset:33792
    v_mul_f32_dpp v53, v245, v53 row_newbcast:1 row_mask:0xf bank_mask:0xf
    v_mfma_f32_16x16x32_bf16 v[136:139], v[224:227], a[148:151], v[136:139]
    v_exp_f32 v202, v202
    v_mfma_f32_16x16x32_bf16 v[8:11], v[228:231], a[148:151], 0
    v_mul_f32_dpp v57, v245, v57 row_newbcast:1 row_mask:0xf bank_mask:0xf
    v_mul_f32_dpp v61, v245, v61 row_newbcast:1 row_mask:0xf bank_mask:0xf
    v_mfma_f32_16x16x32_bf16 v[76:79], v[232:235], a[152:155], v[76:79]
    v_exp_f32 v203, v203
    v_mfma_f32_16x16x32_bf16 v[108:111], v[236:239], a[152:155], v[108:111]
    ds_read_b128 a[148:151], v240 offset:34816
    v_cvt_pk_bf16_f32 v37, v41, v45
    v_mfma_f32_16x16x32_bf16 v[140:143], v[224:227], a[152:155], v[140:143]
    v_exp_f32 v212, v212
    v_mfma_f32_16x16x32_bf16 v[12:15], v[228:231], a[152:155], 0
    v_cvt_pk_bf16_f32 v38, v49, v53
    s_waitcnt lgkmcnt(3)
    v_mfma_f32_16x16x32_bf16 v[80:83], v[232:235], a[156:159], v[80:83]
    v_exp_f32 v213, v213
    v_mfma_f32_16x16x32_bf16 v[112:115], v[236:239], a[156:159], v[112:115]
    ds_read_b128 a[152:155], v241 offset:24576
    v_cvt_pk_bf16_f32 v39, v57, v61
    v_mfma_f32_16x16x32_bf16 v[144:147], v[224:227], a[156:159], v[144:147]
    v_exp_f32 v214, v214
    v_mfma_f32_16x16x32_bf16 v[16:19], v[228:231], a[156:159], 0
    buffer_load_dwordx4 a[28:31], v243, s[12:15], s59 offen offset:192 nt
    v_mul_f32_dpp v42, v245, v42 row_newbcast:2 row_mask:0xf bank_mask:0xf
    v_mfma_f32_16x16x32_bf16 v[84:87], v[232:235], a[128:131], v[84:87]
    v_exp_f32 v215, v215
    v_mfma_f32_16x16x32_bf16 v[116:119], v[236:239], a[128:131], v[116:119]
    ds_read_b128 a[156:159], v241 offset:25600
    v_mul_f32_dpp v43, v245, v43 row_newbcast:3 row_mask:0xf bank_mask:0xf
    v_mfma_f32_16x16x32_bf16 v[148:151], v[224:227], a[128:131], v[148:151]
    v_exp_f32 v220, v220
    v_mfma_f32_16x16x32_bf16 v[20:23], v[228:231], a[128:131], 0
    v_mul_f32_dpp v46, v245, v46 row_newbcast:2 row_mask:0xf bank_mask:0xf
    v_mul_f32_dpp v47, v245, v47 row_newbcast:3 row_mask:0xf bank_mask:0xf
    v_mfma_f32_16x16x32_bf16 v[88:91], v[232:235], a[132:135], v[88:91]
    v_exp_f32 v221, v221
    v_mfma_f32_16x16x32_bf16 v[120:123], v[236:239], a[132:135], v[120:123]
    ds_read_b128 a[128:131], v241 offset:26624
    buffer_store_dwordx4 v[32:35], v248, s[16:19], s53 offen offset:0 sc0 sc1
    v_mfma_f32_16x16x32_bf16 v[152:155], v[224:227], a[132:135], v[152:155]
    v_exp_f32 v222, v222
    v_mfma_f32_16x16x32_bf16 v[24:27], v[228:231], a[132:135], 0
    v_mul_f32_dpp v50, v245, v50 row_newbcast:2 row_mask:0xf bank_mask:0xf
    v_mul_f32_dpp v54, v245, v54 row_newbcast:2 row_mask:0xf bank_mask:0xf
    v_mfma_f32_16x16x32_bf16 v[92:95], v[232:235], a[136:139], v[92:95]
    v_exp_f32 v223, v223
    v_mfma_f32_16x16x32_bf16 v[124:127], v[236:239], a[136:139], v[124:127]
    ds_read_b128 a[132:135], v241 offset:27648
    v_cvt_pk_bf16_f32 v232, v208, v209
    v_mfma_f32_16x16x32_bf16 v[156:159], v[224:227], a[136:139], v[156:159]
    v_exp_f32 v196, v196
    v_mfma_f32_16x16x32_bf16 v[28:31], v[228:231], a[136:139], 0
    v_cvt_pk_bf16_f32 v233, v210, v211
    s_waitcnt vmcnt(9) lgkmcnt(3)
    v_mfma_f32_16x16x32_bf16 v[184:187], a[140:143], a[48:51], 0
    v_exp_f32 v197, v197
    v_mfma_f32_16x16x32_bf16 v[160:163], a[140:143], a[64:67], 0
    ds_read_b128 a[136:139], v241 offset:28672
    v_cvt_pk_bf16_f32 v236, v216, v217
    v_mfma_f32_16x16x32_bf16 v[168:171], a[140:143], a[80:83], 0
    v_exp_f32 v198, v198
    v_mfma_f32_16x16x32_bf16 v[176:179], a[140:143], a[0:3], 0
    v_cvt_pk_bf16_f32 v237, v218, v219
    v_cvt_pk_bf16_f32 v234, v212, v213
    v_mfma_f32_16x16x32_bf16 v[184:187], a[144:147], a[52:55], v[184:187]
    v_exp_f32 v199, v199
    v_mfma_f32_16x16x32_bf16 v[160:163], a[144:147], a[68:71], v[160:163]
    ds_read_b128 a[140:143], v241 offset:29696
    v_cvt_pk_bf16_f32 v235, v214, v215
    v_mfma_f32_16x16x32_bf16 v[168:171], a[144:147], a[84:87], v[168:171]
    v_exp_f32 v204, v204
    v_mfma_f32_16x16x32_bf16 v[176:179], a[144:147], a[4:7], v[176:179]
    v_cvt_pk_bf16_f32 v238, v220, v221
    v_cvt_pk_bf16_f32 v239, v222, v223
    v_mfma_f32_16x16x32_bf16 v[184:187], a[148:151], a[56:59], v[184:187]
    v_exp_f32 v205, v205
    v_mfma_f32_16x16x32_bf16 v[160:163], a[148:151], a[72:75], v[160:163]
    ds_read_b128 a[144:147], v241 offset:30720
    v_cvt_pk_bf16_f32 v224, v192, v193
    v_mfma_f32_16x16x32_bf16 v[168:171], a[148:151], a[88:91], v[168:171]
    v_exp_f32 v206, v206
    v_mfma_f32_16x16x32_bf16 v[176:179], a[148:151], a[8:11], v[176:179]
    v_cvt_pk_bf16_f32 v225, v194, v195
    v_cvt_pk_bf16_f32 v228, v200, v201
    v_mfma_f32_16x16x32_bf16 v[184:187], a[252:255], a[60:63], v[184:187]
    v_exp_f32 v207, v207
    v_mfma_f32_16x16x32_bf16 v[160:163], a[252:255], a[76:79], v[160:163]
    v_cvt_pk_bf16_f32 v229, v202, v203
    v_cvt_pk_bf16_f32 v226, v196, v197
    v_mfma_f32_16x16x32_bf16 v[168:171], a[252:255], a[92:95], v[168:171]
    v_cvt_pk_bf16_f32 v227, v198, v199
    v_cvt_pk_bf16_f32 v230, v204, v205
    v_mfma_f32_16x16x32_bf16 v[176:179], a[252:255], a[12:15], v[176:179]
    v_cvt_pk_bf16_f32 v231, v206, v207
    v_mul_f32_dpp v58, v245, v58 row_newbcast:2 row_mask:0xf bank_mask:0xf
    v_mfma_f32_16x16x32_bf16 v[188:191], a[248:251], a[48:51], 0
    v_exp_f32 v184, v184
    v_mfma_f32_16x16x32_bf16 v[164:167], a[248:251], a[64:67], 0
    buffer_load_dwordx4 a[32:35], v243, s[12:15], s60 offen offset:0 nt
    v_mul_f32_dpp v62, v245, v62 row_newbcast:2 row_mask:0xf bank_mask:0xf
    v_mfma_f32_16x16x32_bf16 v[172:175], a[248:251], a[80:83], 0
    v_exp_f32 v185, v185
    v_mfma_f32_16x16x32_bf16 v[180:183], a[248:251], a[0:3], 0
    v_cvt_pk_bf16_f32 v41, v42, v46
    v_cvt_pk_bf16_f32 v42, v50, v54
    v_mfma_f32_16x16x32_bf16 v[188:191], a[244:247], a[52:55], v[188:191]
    v_exp_f32 v186, v186
    v_mfma_f32_16x16x32_bf16 v[164:167], a[244:247], a[68:71], v[164:167]
    v_cvt_pk_bf16_f32 v45, v43, v47
    v_cvt_pk_bf16_f32 v43, v58, v62
    v_mfma_f32_16x16x32_bf16 v[172:175], a[244:247], a[84:87], v[172:175]
    v_exp_f32 v187, v187
    v_mfma_f32_16x16x32_bf16 v[180:183], a[244:247], a[4:7], v[180:183]
    v_mul_f32_dpp v51, v245, v51 row_newbcast:3 row_mask:0xf bank_mask:0xf
    v_mul_f32_dpp v55, v245, v55 row_newbcast:3 row_mask:0xf bank_mask:0xf
    v_mfma_f32_16x16x32_bf16 v[188:191], a[240:243], a[56:59], v[188:191]
    v_exp_f32 v160, v160
    v_mfma_f32_16x16x32_bf16 v[164:167], a[240:243], a[72:75], v[164:167]
    v_mul_f32_dpp v59, v245, v59 row_newbcast:3 row_mask:0xf bank_mask:0xf
    v_mul_f32_dpp v63, v245, v63 row_newbcast:3 row_mask:0xf bank_mask:0xf
    v_mfma_f32_16x16x32_bf16 v[172:175], a[240:243], a[88:91], v[172:175]
    v_exp_f32 v161, v161
    v_mfma_f32_16x16x32_bf16 v[180:183], a[240:243], a[8:11], v[180:183]
    v_cvt_pk_bf16_f32 v46, v51, v55
    v_cvt_pk_bf16_f32 v47, v59, v63
    v_mfma_f32_16x16x32_bf16 v[188:191], a[236:239], a[60:63], v[188:191]
    v_exp_f32 v162, v162
    v_mfma_f32_16x16x32_bf16 v[164:167], a[236:239], a[76:79], v[164:167]
    buffer_store_dwordx4 v[36:39], v248, s[16:19], s53 offen offset:256 sc0 sc1
    v_mfma_f32_16x16x32_bf16 v[172:175], a[236:239], a[92:95], v[172:175]
    v_exp_f32 v163, v163
    v_mfma_f32_16x16x32_bf16 v[180:183], a[236:239], a[12:15], v[180:183]
    v_exp_f32 v168, v168
    v_smfmac_f32_16x16x64_bf16 a[196:199], a[212:215], v[232:239], v247
    v_exp_f32 v169, v169
    v_smfmac_f32_16x16x64_bf16 a[192:195], a[212:215], v[224:231], v247
    v_exp_f32 v170, v170
    v_mfma_f32_16x16x32_bf16 v[64:67], v[232:235], a[152:155], v[64:67]
    ds_read_b128 a[148:151], v241 offset:31744
    v_mfma_f32_16x16x32_bf16 v[96:99], v[236:239], a[152:155], v[96:99]
    v_exp_f32 v171, v171
    v_mfma_f32_16x16x32_bf16 v[128:131], v[224:227], a[152:155], v[128:131]
    v_accvgpr_read_b32 v249, a196
    v_accvgpr_read_b32 v251, a197
    v_mfma_f32_16x16x32_bf16 v[0:3], v[228:231], a[152:155], v[0:3]
    v_add_f32 v249, v249, v251
    s_waitcnt lgkmcnt(3)
    v_mfma_f32_16x16x32_bf16 v[68:71], v[232:235], a[156:159], v[68:71]
    v_exp_f32 v176, v176
    v_mfma_f32_16x16x32_bf16 v[100:103], v[236:239], a[156:159], v[100:103]
    ds_read_b128 a[152:155], v240 offset:49152
    v_subrev_u32 v246, s48, v249
    v_mfma_f32_16x16x32_bf16 v[132:135], v[224:227], a[156:159], v[132:135]
    v_exp_f32 v177, v177
    v_mfma_f32_16x16x32_bf16 v[4:7], v[228:231], a[156:159], v[4:7]
    v_rcp_f32 v244, v249
    v_mfma_f32_16x16x32_bf16 v[72:75], v[232:235], a[128:131], v[72:75]
    v_exp_f32 v178, v178
    v_mfma_f32_16x16x32_bf16 v[104:107], v[236:239], a[128:131], v[104:107]
    ds_read_b128 a[156:159], v240 offset:50176
    v_max_u32 v253, v253, v246
    v_mfma_f32_16x16x32_bf16 v[136:139], v[224:227], a[128:131], v[136:139]
    v_exp_f32 v179, v179
    v_mfma_f32_16x16x32_bf16 v[8:11], v[228:231], a[128:131], v[8:11]
    ds_bpermute_b32 v244, v242, v244
    v_accvgpr_write_b32 a196, 0
    v_mfma_f32_16x16x32_bf16 v[76:79], v[232:235], a[132:135], v[76:79]
    v_exp_f32 v188, v188
    v_mfma_f32_16x16x32_bf16 v[108:111], v[236:239], a[132:135], v[108:111]
    ds_read_b128 a[128:131], v240 offset:51200
    v_accvgpr_write_b32 a197, 0
    v_mfma_f32_16x16x32_bf16 v[140:143], v[224:227], a[132:135], v[140:143]
    v_exp_f32 v189, v189
    v_mfma_f32_16x16x32_bf16 v[12:15], v[228:231], a[132:135], v[12:15]
    v_exp_f32 v190, v190
    v_mfma_f32_16x16x32_bf16 v[80:83], v[232:235], a[136:139], v[80:83]
    ds_read_b128 a[132:135], v240 offset:52224
    v_mfma_f32_16x16x32_bf16 v[112:115], v[236:239], a[136:139], v[112:115]
    v_exp_f32 v191, v191
    v_mfma_f32_16x16x32_bf16 v[144:147], v[224:227], a[136:139], v[144:147]
    buffer_load_dwordx4 a[36:39], v243, s[12:15], s60 offen offset:64 nt
    v_mfma_f32_16x16x32_bf16 v[16:19], v[228:231], a[136:139], v[16:19]
    s_waitcnt lgkmcnt(2)
    v_mul_f32_dpp v64, v244, v64 row_newbcast:0 row_mask:0xf bank_mask:0xf
    v_mfma_f32_16x16x32_bf16 v[84:87], v[232:235], a[140:143], v[84:87]
    v_exp_f32 v164, v164
    v_mfma_f32_16x16x32_bf16 v[116:119], v[236:239], a[140:143], v[116:119]
    ds_read_b128 a[136:139], v240 offset:53248
    v_mul_f32_dpp v65, v244, v65 row_newbcast:1 row_mask:0xf bank_mask:0xf
    v_mfma_f32_16x16x32_bf16 v[148:151], v[224:227], a[140:143], v[148:151]
    v_exp_f32 v165, v165
    v_mfma_f32_16x16x32_bf16 v[20:23], v[228:231], a[140:143], v[20:23]
    v_mul_f32_dpp v66, v244, v66 row_newbcast:2 row_mask:0xf bank_mask:0xf
    v_mul_f32_dpp v67, v244, v67 row_newbcast:3 row_mask:0xf bank_mask:0xf
    v_mfma_f32_16x16x32_bf16 v[88:91], v[232:235], a[144:147], v[88:91]
    v_exp_f32 v166, v166
    v_mfma_f32_16x16x32_bf16 v[120:123], v[236:239], a[144:147], v[120:123]
    ds_read_b128 a[140:143], v240 offset:54272
    v_mul_f32_dpp v68, v244, v68 row_newbcast:0 row_mask:0xf bank_mask:0xf
    v_mfma_f32_16x16x32_bf16 v[152:155], v[224:227], a[144:147], v[152:155]
    v_exp_f32 v167, v167
    v_mfma_f32_16x16x32_bf16 v[24:27], v[228:231], a[144:147], v[24:27]
    v_mul_f32_dpp v69, v244, v69 row_newbcast:1 row_mask:0xf bank_mask:0xf
    v_mul_f32_dpp v70, v244, v70 row_newbcast:2 row_mask:0xf bank_mask:0xf
    v_mfma_f32_16x16x32_bf16 v[92:95], v[232:235], a[148:151], v[92:95]
    v_exp_f32 v172, v172
    v_mfma_f32_16x16x32_bf16 v[124:127], v[236:239], a[148:151], v[124:127]
    ds_read_b128 a[144:147], v240 offset:55296
    v_cvt_pk_bf16_f32 v236, v184, v185
    v_mfma_f32_16x16x32_bf16 v[156:159], v[224:227], a[148:151], v[156:159]
    v_exp_f32 v173, v173
    v_mfma_f32_16x16x32_bf16 v[28:31], v[228:231], a[148:151], v[28:31]
    buffer_store_dwordx4 v[40:43], v248, s[16:19], s53 offen offset:512 sc0 sc1
    v_cvt_pk_bf16_f32 v237, v186, v187
    v_mfma_f32_16x16x32_bf16 v[216:219], a[232:235], a[48:51], 0
    v_exp_f32 v174, v174
    v_mfma_f32_16x16x32_bf16 v[192:195], a[232:235], a[64:67], 0
    v_cvt_pk_bf16_f32 v232, v176, v177
    v_cvt_pk_bf16_f32 v233, v178, v179
    v_mfma_f32_16x16x32_bf16 v[200:203], a[232:235], a[80:83], 0
    v_exp_f32 v175, v175
    v_mfma_f32_16x16x32_bf16 v[208:211], a[232:235], a[0:3], 0
    v_cvt_pk_bf16_f32 v238, v188, v189
    v_cvt_pk_bf16_f32 v239, v190, v191
    v_mfma_f32_16x16x32_bf16 v[216:219], a[228:231], a[52:55], v[216:219]
    v_exp_f32 v180, v180
    v_mfma_f32_16x16x32_bf16 v[192:195], a[228:231], a[68:71], v[192:195]
    v_cvt_pk_bf16_f32 v224, v160, v161
    v_cvt_pk_bf16_f32 v225, v162, v163
    v_mfma_f32_16x16x32_bf16 v[200:203], a[228:231], a[84:87], v[200:203]
    v_exp_f32 v181, v181
    v_mfma_f32_16x16x32_bf16 v[208:211], a[228:231], a[4:7], v[208:211]
    v_cvt_pk_bf16_f32 v234, v180, v181
    v_cvt_pk_bf16_f32 v228, v168, v169
    v_mfma_f32_16x16x32_bf16 v[216:219], a[224:227], a[56:59], v[216:219]
    v_exp_f32 v182, v182
    v_mfma_f32_16x16x32_bf16 v[192:195], a[224:227], a[72:75], v[192:195]
    v_cvt_pk_bf16_f32 v229, v170, v171
    v_cvt_pk_bf16_f32 v226, v164, v165
    v_mfma_f32_16x16x32_bf16 v[200:203], a[224:227], a[88:91], v[200:203]
    v_exp_f32 v183, v183
    v_mfma_f32_16x16x32_bf16 v[208:211], a[224:227], a[8:11], v[208:211]
    v_cvt_pk_bf16_f32 v235, v182, v183
    v_cvt_pk_bf16_f32 v227, v166, v167
    v_mfma_f32_16x16x32_bf16 v[216:219], a[220:223], a[60:63], v[216:219]
    v_cvt_pk_bf16_f32 v230, v172, v173
    v_cvt_pk_bf16_f32 v231, v174, v175
    v_mfma_f32_16x16x32_bf16 v[192:195], a[220:223], a[76:79], v[192:195]
    v_mul_f32_dpp v71, v244, v71 row_newbcast:3 row_mask:0xf bank_mask:0xf
    v_mul_f32_dpp v72, v244, v72 row_newbcast:0 row_mask:0xf bank_mask:0xf
    v_mfma_f32_16x16x32_bf16 v[200:203], a[220:223], a[92:95], v[200:203]
    v_mul_f32_dpp v76, v244, v76 row_newbcast:0 row_mask:0xf bank_mask:0xf
    v_mul_f32_dpp v80, v244, v80 row_newbcast:0 row_mask:0xf bank_mask:0xf
    v_mfma_f32_16x16x32_bf16 v[208:211], a[220:223], a[12:15], v[208:211]
    v_mul_f32_dpp v84, v244, v84 row_newbcast:0 row_mask:0xf bank_mask:0xf
    v_mul_f32_dpp v88, v244, v88 row_newbcast:0 row_mask:0xf bank_mask:0xf
    v_mfma_f32_16x16x32_bf16 v[220:223], a[216:219], a[48:51], 0
    v_exp_f32 v216, v216
    v_mfma_f32_16x16x32_bf16 v[196:199], a[216:219], a[64:67], 0
    v_mul_f32_dpp v92, v244, v92 row_newbcast:0 row_mask:0xf bank_mask:0xf
    v_cvt_pk_bf16_f32 v64, v64, v68
    v_mfma_f32_16x16x32_bf16 v[204:207], a[216:219], a[80:83], 0
    v_exp_f32 v217, v217
    v_mfma_f32_16x16x32_bf16 v[212:215], a[216:219], a[0:3], 0
    buffer_load_dwordx4 a[40:43], v243, s[12:15], s60 offen offset:128 nt
    v_cvt_pk_bf16_f32 v68, v65, v69
    v_mfma_f32_16x16x32_bf16 v[220:223], a[208:211], a[52:55], v[220:223]
    v_exp_f32 v218, v218
    v_mfma_f32_16x16x32_bf16 v[196:199], a[208:211], a[68:71], v[196:199]
    v_cvt_pk_bf16_f32 v65, v72, v76
    v_cvt_pk_bf16_f32 v72, v66, v70
    v_mfma_f32_16x16x32_bf16 v[204:207], a[208:211], a[84:87], v[204:207]
    v_exp_f32 v219, v219
    v_mfma_f32_16x16x32_bf16 v[212:215], a[208:211], a[4:7], v[212:215]
    v_cvt_pk_bf16_f32 v76, v67, v71
    v_cvt_pk_bf16_f32 v66, v80, v84
    v_mfma_f32_16x16x32_bf16 v[220:223], a[204:207], a[56:59], v[220:223]
    v_exp_f32 v192, v192
    v_mfma_f32_16x16x32_bf16 v[196:199], a[204:207], a[72:75], v[196:199]
    v_cvt_pk_bf16_f32 v67, v88, v92
    v_mul_f32_dpp v73, v244, v73 row_newbcast:1 row_mask:0xf bank_mask:0xf
    v_mfma_f32_16x16x32_bf16 v[204:207], a[204:207], a[88:91], v[204:207]
    v_exp_f32 v193, v193
    v_mfma_f32_16x16x32_bf16 v[212:215], a[204:207], a[8:11], v[212:215]
    v_mul_f32_dpp v77, v244, v77 row_newbcast:1 row_mask:0xf bank_mask:0xf
    v_mul_f32_dpp v81, v244, v81 row_newbcast:1 row_mask:0xf bank_mask:0xf
    v_mfma_f32_16x16x32_bf16 v[220:223], a[200:203], a[60:63], v[220:223]
    v_exp_f32 v194, v194
    v_mfma_f32_16x16x32_bf16 v[196:199], a[200:203], a[76:79], v[196:199]
    v_mul_f32_dpp v85, v244, v85 row_newbcast:1 row_mask:0xf bank_mask:0xf
    v_mul_f32_dpp v89, v244, v89 row_newbcast:1 row_mask:0xf bank_mask:0xf
    v_mfma_f32_16x16x32_bf16 v[204:207], a[200:203], a[92:95], v[204:207]
    v_exp_f32 v195, v195
    v_mfma_f32_16x16x32_bf16 v[212:215], a[200:203], a[12:15], v[212:215]
    v_mul_f32_dpp v93, v244, v93 row_newbcast:1 row_mask:0xf bank_mask:0xf
    v_cvt_pk_bf16_f32 v69, v73, v77
    v_smfmac_f32_16x16x64_bf16 a[196:199], a[212:215], v[232:239], v247
    v_exp_f32 v200, v200
    v_smfmac_f32_16x16x64_bf16 a[192:195], a[212:215], v[224:231], v247
    buffer_store_dwordx4 v[44:47], v248, s[16:19], s53 offen offset:768 sc0 sc1
    v_cvt_pk_bf16_f32 v70, v81, v85
    v_mfma_f32_16x16x32_bf16 v[96:99], v[236:239], a[188:191], v[96:99]
    v_exp_f32 v201, v201
    v_mfma_f32_16x16x32_bf16 v[128:131], v[224:227], a[188:191], v[128:131]
    v_cvt_pk_bf16_f32 v71, v89, v93
    v_mul_f32_dpp v74, v244, v74 row_newbcast:2 row_mask:0xf bank_mask:0xf
    v_mfma_f32_16x16x32_bf16 v[0:3], v[228:231], a[188:191], v[0:3]
    v_exp_f32 v202, v202
    v_mfma_f32_16x16x32_bf16 v[32:35], v[232:235], a[188:191], 0
    v_mul_f32_dpp v75, v244, v75 row_newbcast:3 row_mask:0xf bank_mask:0xf
    v_mul_f32_dpp v78, v244, v78 row_newbcast:2 row_mask:0xf bank_mask:0xf
    v_mfma_f32_16x16x32_bf16 v[100:103], v[236:239], a[184:187], v[100:103]
    v_exp_f32 v203, v203
    v_mfma_f32_16x16x32_bf16 v[132:135], v[224:227], a[184:187], v[132:135]
    v_mul_f32_dpp v79, v244, v79 row_newbcast:3 row_mask:0xf bank_mask:0xf
    v_mul_f32_dpp v82, v244, v82 row_newbcast:2 row_mask:0xf bank_mask:0xf
    v_mfma_f32_16x16x32_bf16 v[4:7], v[228:231], a[184:187], v[4:7]
    v_exp_f32 v208, v208
    v_mfma_f32_16x16x32_bf16 v[36:39], v[232:235], a[184:187], 0
    v_mul_f32_dpp v86, v244, v86 row_newbcast:2 row_mask:0xf bank_mask:0xf
    v_mul_f32_dpp v90, v244, v90 row_newbcast:2 row_mask:0xf bank_mask:0xf
    v_mfma_f32_16x16x32_bf16 v[104:107], v[236:239], a[180:183], v[104:107]
    v_exp_f32 v209, v209
    v_mfma_f32_16x16x32_bf16 v[136:139], v[224:227], a[180:183], v[136:139]
    v_mul_f32_dpp v94, v244, v94 row_newbcast:2 row_mask:0xf bank_mask:0xf
    v_cvt_pk_bf16_f32 v73, v74, v78
    v_mfma_f32_16x16x32_bf16 v[8:11], v[228:231], a[180:183], v[8:11]
    v_exp_f32 v210, v210
    v_mfma_f32_16x16x32_bf16 v[40:43], v[232:235], a[180:183], 0
    v_cvt_pk_bf16_f32 v74, v82, v86
    v_cvt_pk_bf16_f32 v77, v75, v79
    v_mfma_f32_16x16x32_bf16 v[108:111], v[236:239], a[176:179], v[108:111]
    v_exp_f32 v211, v211
    v_mfma_f32_16x16x32_bf16 v[140:143], v[224:227], a[176:179], v[140:143]
    v_cvt_pk_bf16_f32 v75, v90, v94
    v_mul_f32_dpp v83, v244, v83 row_newbcast:3 row_mask:0xf bank_mask:0xf
    v_mfma_f32_16x16x32_bf16 v[12:15], v[228:231], a[176:179], v[12:15]
    v_exp_f32 v220, v220
    v_mfma_f32_16x16x32_bf16 v[44:47], v[232:235], a[176:179], 0
    v_mul_f32_dpp v87, v244, v87 row_newbcast:3 row_mask:0xf bank_mask:0xf
    v_mul_f32_dpp v91, v244, v91 row_newbcast:3 row_mask:0xf bank_mask:0xf
    v_mfma_f32_16x16x32_bf16 v[112:115], v[236:239], a[172:175], v[112:115]
    v_exp_f32 v221, v221
    v_mfma_f32_16x16x32_bf16 v[144:147], v[224:227], a[172:175], v[144:147]
    v_mul_f32_dpp v95, v244, v95 row_newbcast:3 row_mask:0xf bank_mask:0xf
    v_cvt_pk_bf16_f32 v78, v83, v87
    v_mfma_f32_16x16x32_bf16 v[16:19], v[228:231], a[172:175], v[16:19]
    v_exp_f32 v222, v222
    v_mfma_f32_16x16x32_bf16 v[48:51], v[232:235], a[172:175], 0
    buffer_load_dwordx4 a[44:47], v243, s[12:15], s60 offen offset:192 nt
    v_cvt_pk_bf16_f32 v79, v91, v95
    v_mfma_f32_16x16x32_bf16 v[116:119], v[236:239], a[168:171], v[116:119]
    v_exp_f32 v223, v223
    v_mfma_f32_16x16x32_bf16 v[148:151], v[224:227], a[168:171], v[148:151]
    v_exp_f32 v196, v196
    v_mfma_f32_16x16x32_bf16 v[20:23], v[228:231], a[168:171], v[20:23]
    v_exp_f32 v197, v197
    v_mfma_f32_16x16x32_bf16 v[52:55], v[232:235], a[168:171], 0
    v_exp_f32 v198, v198
    v_mfma_f32_16x16x32_bf16 v[120:123], v[236:239], a[164:167], v[120:123]
    v_exp_f32 v199, v199
    v_mfma_f32_16x16x32_bf16 v[152:155], v[224:227], a[164:167], v[152:155]
    buffer_store_dwordx4 v[64:67], v248, s[16:19], s54 offen offset:0 sc0 sc1
    v_mfma_f32_16x16x32_bf16 v[24:27], v[228:231], a[164:167], v[24:27]
    v_exp_f32 v204, v204
    v_mfma_f32_16x16x32_bf16 v[56:59], v[232:235], a[164:167], 0
    v_exp_f32 v205, v205
    v_mfma_f32_16x16x32_bf16 v[124:127], v[236:239], a[160:163], v[124:127]
    v_cvt_pk_bf16_f32 v236, v216, v217
    v_cvt_pk_bf16_f32 v237, v218, v219
    v_mfma_f32_16x16x32_bf16 v[156:159], v[224:227], a[160:163], v[156:159]
    v_exp_f32 v206, v206
    v_mfma_f32_16x16x32_bf16 v[28:31], v[228:231], a[160:163], v[28:31]
    v_cvt_pk_bf16_f32 v238, v220, v221
    v_cvt_pk_bf16_f32 v239, v222, v223
    v_mfma_f32_16x16x32_bf16 v[60:63], v[232:235], a[160:163], 0
    v_cvt_pk_bf16_f32 v232, v208, v209
    s_waitcnt vmcnt(9)
    v_mfma_f32_16x16x32_bf16 v[160:163], a[152:155], a[64:67], 0
    v_exp_f32 v207, v207
    v_mfma_f32_16x16x32_bf16 v[168:171], a[152:155], a[80:83], 0
    ds_read_b128 a[148:151], v240 offset:56320
    v_cvt_pk_bf16_f32 v233, v210, v211
    v_mfma_f32_16x16x32_bf16 v[176:179], a[152:155], a[0:3], 0
    v_exp_f32 v212, v212
    v_mfma_f32_16x16x32_bf16 v[184:187], a[152:155], a[16:19], 0
    v_cvt_pk_bf16_f32 v224, v192, v193
    v_mfma_f32_16x16x32_bf16 v[160:163], a[156:159], a[68:71], v[160:163]
    v_exp_f32 v213, v213
    v_mfma_f32_16x16x32_bf16 v[168:171], a[156:159], a[84:87], v[168:171]
    ds_read_b128 a[152:155], v240 offset:57344
    v_cvt_pk_bf16_f32 v234, v212, v213
    v_mfma_f32_16x16x32_bf16 v[176:179], a[156:159], a[4:7], v[176:179]
    v_exp_f32 v214, v214
    v_mfma_f32_16x16x32_bf16 v[184:187], a[156:159], a[20:23], v[184:187]
    v_cvt_pk_bf16_f32 v225, v194, v195
    v_cvt_pk_bf16_f32 v228, v200, v201
    s_waitcnt lgkmcnt(6)
    v_mfma_f32_16x16x32_bf16 v[160:163], a[128:131], a[72:75], v[160:163]
    v_exp_f32 v215, v215
    v_mfma_f32_16x16x32_bf16 v[168:171], a[128:131], a[88:91], v[168:171]
    ds_read_b128 a[156:159], v240 offset:58368
    v_cvt_pk_bf16_f32 v235, v214, v215
    v_mfma_f32_16x16x32_bf16 v[176:179], a[128:131], a[8:11], v[176:179]
    v_cvt_pk_bf16_f32 v229, v202, v203
    v_cvt_pk_bf16_f32 v226, v196, v197
    v_mfma_f32_16x16x32_bf16 v[184:187], a[128:131], a[24:27], v[184:187]
    v_cvt_pk_bf16_f32 v227, v198, v199
    v_cvt_pk_bf16_f32 v230, v204, v205
    s_waitcnt lgkmcnt(6)
    v_mfma_f32_16x16x32_bf16 v[160:163], a[132:135], a[76:79], v[160:163]
    ds_read_b128 a[128:131], v240 offset:59392
    v_cvt_pk_bf16_f32 v231, v206, v207
    v_mfma_f32_16x16x32_bf16 v[168:171], a[132:135], a[92:95], v[168:171]
    v_mfma_f32_16x16x32_bf16 v[176:179], a[132:135], a[12:15], v[176:179]
    v_mfma_f32_16x16x32_bf16 v[184:187], a[132:135], a[28:31], v[184:187]
    s_waitcnt lgkmcnt(6)
    v_mfma_f32_16x16x32_bf16 v[164:167], a[136:139], a[64:67], 0
    s_nop 0
    v_exp_f32 v160, v160
    v_mfma_f32_16x16x32_bf16 v[172:175], a[136:139], a[80:83], 0
    ds_read_b128 a[132:135], v240 offset:60416
    buffer_load_dwordx4 a[48:51], v243, s[12:15], s61 offen offset:0 nt
    v_mfma_f32_16x16x32_bf16 v[180:183], a[136:139], a[0:3], 0
    v_exp_f32 v161, v161
    v_mfma_f32_16x16x32_bf16 v[188:191], a[136:139], a[16:19], 0
    s_waitcnt lgkmcnt(3)
    v_mfma_f32_16x16x32_bf16 v[164:167], a[140:143], a[68:71], v[164:167]
    v_exp_f32 v162, v162
    v_mfma_f32_16x16x32_bf16 v[172:175], a[140:143], a[84:87], v[172:175]
    ds_read_b128 a[136:139], v240 offset:61440
    v_mfma_f32_16x16x32_bf16 v[180:183], a[140:143], a[4:7], v[180:183]
    v_exp_f32 v163, v163
    v_mfma_f32_16x16x32_bf16 v[188:191], a[140:143], a[20:23], v[188:191]
    v_exp_f32 v168, v168
    v_mfma_f32_16x16x32_bf16 v[164:167], a[144:147], a[72:75], v[164:167]
    ds_read_b128 a[140:143], v240 offset:62464
    v_mfma_f32_16x16x32_bf16 v[172:175], a[144:147], a[88:91], v[172:175]
    v_exp_f32 v169, v169
    v_mfma_f32_16x16x32_bf16 v[180:183], a[144:147], a[8:11], v[180:183]
    v_exp_f32 v170, v170
    v_mfma_f32_16x16x32_bf16 v[188:191], a[144:147], a[24:27], v[188:191]
    v_exp_f32 v171, v171
    v_mfma_f32_16x16x32_bf16 v[164:167], a[148:151], a[76:79], v[164:167]
    buffer_store_dwordx4 v[68:71], v248, s[16:19], s54 offen offset:256 sc0 sc1
    ds_read_b128 a[144:147], v240 offset:63488
    v_mfma_f32_16x16x32_bf16 v[172:175], a[148:151], a[92:95], v[172:175]
    v_exp_f32 v176, v176
    v_mfma_f32_16x16x32_bf16 v[180:183], a[148:151], a[12:15], v[180:183]
    v_exp_f32 v177, v177
    v_mfma_f32_16x16x32_bf16 v[188:191], a[148:151], a[28:31], v[188:191]
    v_exp_f32 v178, v178
    v_smfmac_f32_16x16x64_bf16 a[196:199], a[212:215], v[232:239], v247
    v_exp_f32 v179, v179
    v_smfmac_f32_16x16x64_bf16 a[192:195], a[212:215], v[224:231], v247
    v_exp_f32 v184, v184
    v_mfma_f32_16x16x32_bf16 v[96:99], v[236:239], a[124:127], v[96:99]
    v_exp_f32 v185, v185
    v_mfma_f32_16x16x32_bf16 v[128:131], v[224:227], a[124:127], v[128:131]
    v_exp_f32 v186, v186
    v_mfma_f32_16x16x32_bf16 v[0:3], v[228:231], a[124:127], v[0:3]
    v_accvgpr_read_b32 v250, a198
    v_accvgpr_read_b32 v251, a199
    v_mfma_f32_16x16x32_bf16 v[32:35], v[232:235], a[124:127], v[32:35]
    v_exp_f32 v187, v187
    v_mfma_f32_16x16x32_bf16 v[100:103], v[236:239], a[120:123], v[100:103]
    v_add_f32 v250, v250, v251
    v_accvgpr_write_b32 a198, 0
    v_mfma_f32_16x16x32_bf16 v[132:135], v[224:227], a[120:123], v[132:135]
    v_exp_f32 v164, v164
    v_mfma_f32_16x16x32_bf16 v[4:7], v[228:231], a[120:123], v[4:7]
    v_subrev_u32 v246, s48, v250
    v_accvgpr_write_b32 a199, 0
    v_mfma_f32_16x16x32_bf16 v[36:39], v[232:235], a[120:123], v[36:39]
    v_exp_f32 v165, v165
    v_mfma_f32_16x16x32_bf16 v[104:107], v[236:239], a[116:119], v[104:107]
    v_rcp_f32 v245, v250
    v_mfma_f32_16x16x32_bf16 v[136:139], v[224:227], a[116:119], v[136:139]
    v_exp_f32 v166, v166
    v_mfma_f32_16x16x32_bf16 v[8:11], v[228:231], a[116:119], v[8:11]
    v_max_u32 v253, v253, v246
    ds_bpermute_b32 v245, v242, v245
    v_mfma_f32_16x16x32_bf16 v[40:43], v[232:235], a[116:119], v[40:43]
    v_exp_f32 v167, v167
    v_mfma_f32_16x16x32_bf16 v[108:111], v[236:239], a[112:115], v[108:111]
    v_exp_f32 v172, v172
    v_mfma_f32_16x16x32_bf16 v[140:143], v[224:227], a[112:115], v[140:143]
    v_exp_f32 v173, v173
    v_mfma_f32_16x16x32_bf16 v[12:15], v[228:231], a[112:115], v[12:15]
    v_exp_f32 v174, v174
    v_mfma_f32_16x16x32_bf16 v[44:47], v[232:235], a[112:115], v[44:47]
    v_exp_f32 v175, v175
    v_mfma_f32_16x16x32_bf16 v[112:115], v[236:239], a[108:111], v[112:115]
    v_exp_f32 v180, v180
    v_mfma_f32_16x16x32_bf16 v[144:147], v[224:227], a[108:111], v[144:147]
    buffer_load_dwordx4 a[52:55], v243, s[12:15], s61 offen offset:64 nt
    v_mfma_f32_16x16x32_bf16 v[16:19], v[228:231], a[108:111], v[16:19]
    v_exp_f32 v181, v181
    v_mfma_f32_16x16x32_bf16 v[48:51], v[232:235], a[108:111], v[48:51]
    s_waitcnt lgkmcnt(0)
    v_mul_f32_dpp v96, v245, v96 row_newbcast:0 row_mask:0xf bank_mask:0xf
    v_mul_f32_dpp v97, v245, v97 row_newbcast:1 row_mask:0xf bank_mask:0xf
    v_mfma_f32_16x16x32_bf16 v[116:119], v[236:239], a[104:107], v[116:119]
    v_exp_f32 v182, v182
    v_mfma_f32_16x16x32_bf16 v[148:151], v[224:227], a[104:107], v[148:151]
    v_mul_f32_dpp v98, v245, v98 row_newbcast:2 row_mask:0xf bank_mask:0xf
    v_mul_f32_dpp v99, v245, v99 row_newbcast:3 row_mask:0xf bank_mask:0xf
    v_mfma_f32_16x16x32_bf16 v[20:23], v[228:231], a[104:107], v[20:23]
    v_exp_f32 v183, v183
    v_mfma_f32_16x16x32_bf16 v[52:55], v[232:235], a[104:107], v[52:55]
    v_mul_f32_dpp v100, v245, v100 row_newbcast:0 row_mask:0xf bank_mask:0xf
    v_mul_f32_dpp v101, v245, v101 row_newbcast:1 row_mask:0xf bank_mask:0xf
    v_mfma_f32_16x16x32_bf16 v[120:123], v[236:239], a[100:103], v[120:123]
    v_exp_f32 v188, v188
    v_mfma_f32_16x16x32_bf16 v[152:155], v[224:227], a[100:103], v[152:155]
    v_mul_f32_dpp v102, v245, v102 row_newbcast:2 row_mask:0xf bank_mask:0xf
    v_mul_f32_dpp v103, v245, v103 row_newbcast:3 row_mask:0xf bank_mask:0xf
    v_mfma_f32_16x16x32_bf16 v[24:27], v[228:231], a[100:103], v[24:27]
    v_exp_f32 v189, v189
    v_mfma_f32_16x16x32_bf16 v[56:59], v[232:235], a[100:103], v[56:59]
    v_mul_f32_dpp v104, v245, v104 row_newbcast:0 row_mask:0xf bank_mask:0xf
    v_mul_f32_dpp v108, v245, v108 row_newbcast:0 row_mask:0xf bank_mask:0xf
    v_mfma_f32_16x16x32_bf16 v[124:127], v[236:239], a[96:99], v[124:127]
    v_exp_f32 v190, v190
    v_mfma_f32_16x16x32_bf16 v[156:159], v[224:227], a[96:99], v[156:159]
    v_cvt_pk_bf16_f32 v224, v160, v161
    v_cvt_pk_bf16_f32 v225, v162, v163
    v_mfma_f32_16x16x32_bf16 v[28:31], v[228:231], a[96:99], v[28:31]
    v_exp_f32 v191, v191
    v_mfma_f32_16x16x32_bf16 v[60:63], v[232:235], a[96:99], v[60:63]
    buffer_store_dwordx4 v[72:75], v248, s[16:19], s54 offen offset:512 sc0 sc1
    v_cvt_pk_bf16_f32 v228, v168, v169
    v_mfma_f32_16x16x32_bf16 v[192:195], a[152:155], a[64:67], 0
    ds_read_b128 a[148:151], v240 offset:64512
    v_cvt_pk_bf16_f32 v229, v170, v171
    v_mfma_f32_16x16x32_bf16 v[200:203], a[152:155], a[80:83], 0
    v_cvt_pk_bf16_f32 v226, v164, v165
    v_cvt_pk_bf16_f32 v227, v166, v167
    v_mfma_f32_16x16x32_bf16 v[208:211], a[152:155], a[0:3], 0
    v_cvt_pk_bf16_f32 v230, v172, v173
    v_cvt_pk_bf16_f32 v231, v174, v175
    v_mfma_f32_16x16x32_bf16 v[216:219], a[152:155], a[16:19], 0
    v_cvt_pk_bf16_f32 v232, v176, v177
    v_mfma_f32_16x16x32_bf16 v[192:195], a[156:159], a[68:71], v[192:195]
    ds_read_b128 a[152:155], v241 offset:49152
    v_cvt_pk_bf16_f32 v233, v178, v179
    v_mfma_f32_16x16x32_bf16 v[200:203], a[156:159], a[84:87], v[200:203]
    v_cvt_pk_bf16_f32 v236, v184, v185
    v_cvt_pk_bf16_f32 v237, v186, v187
    v_mfma_f32_16x16x32_bf16 v[208:211], a[156:159], a[4:7], v[208:211]
    v_cvt_pk_bf16_f32 v234, v180, v181
    v_cvt_pk_bf16_f32 v235, v182, v183
    v_mfma_f32_16x16x32_bf16 v[216:219], a[156:159], a[20:23], v[216:219]
    v_cvt_pk_bf16_f32 v238, v188, v189
    v_cvt_pk_bf16_f32 v239, v190, v191
    v_mfma_f32_16x16x32_bf16 v[192:195], a[128:131], a[72:75], v[192:195]
    ds_read_b128 a[156:159], v241 offset:50176
    v_mul_f32_dpp v112, v245, v112 row_newbcast:0 row_mask:0xf bank_mask:0xf
    v_mfma_f32_16x16x32_bf16 v[200:203], a[128:131], a[88:91], v[200:203]
    v_mul_f32_dpp v116, v245, v116 row_newbcast:0 row_mask:0xf bank_mask:0xf
    v_mul_f32_dpp v120, v245, v120 row_newbcast:0 row_mask:0xf bank_mask:0xf
    v_mfma_f32_16x16x32_bf16 v[208:211], a[128:131], a[8:11], v[208:211]
    v_mul_f32_dpp v124, v245, v124 row_newbcast:0 row_mask:0xf bank_mask:0xf
    v_cvt_pk_bf16_f32 v96, v96, v100
    v_mfma_f32_16x16x32_bf16 v[216:219], a[128:131], a[24:27], v[216:219]
    v_cvt_pk_bf16_f32 v100, v97, v101
    v_cvt_pk_bf16_f32 v97, v104, v108
    v_mfma_f32_16x16x32_bf16 v[192:195], a[132:135], a[76:79], v[192:195]
    ds_read_b128 a[128:131], v241 offset:51200
    v_cvt_pk_bf16_f32 v104, v98, v102
    v_mfma_f32_16x16x32_bf16 v[200:203], a[132:135], a[92:95], v[200:203]
    v_cvt_pk_bf16_f32 v108, v99, v103
    v_cvt_pk_bf16_f32 v98, v112, v116
    v_mfma_f32_16x16x32_bf16 v[208:211], a[132:135], a[12:15], v[208:211]
    v_cvt_pk_bf16_f32 v99, v120, v124
    v_mul_f32_dpp v105, v245, v105 row_newbcast:1 row_mask:0xf bank_mask:0xf
    v_mfma_f32_16x16x32_bf16 v[216:219], a[132:135], a[28:31], v[216:219]
    v_mul_f32_dpp v109, v245, v109 row_newbcast:1 row_mask:0xf bank_mask:0xf
    v_mul_f32_dpp v113, v245, v113 row_newbcast:1 row_mask:0xf bank_mask:0xf
    v_mfma_f32_16x16x32_bf16 v[196:199], a[136:139], a[64:67], 0
    v_exp_f32 v192, v192
    v_mfma_f32_16x16x32_bf16 v[204:207], a[136:139], a[80:83], 0
    ds_read_b128 a[132:135], v241 offset:52224
    v_mul_f32_dpp v117, v245, v117 row_newbcast:1 row_mask:0xf bank_mask:0xf
    v_mfma_f32_16x16x32_bf16 v[212:215], a[136:139], a[0:3], 0
    v_exp_f32 v193, v193
    v_mfma_f32_16x16x32_bf16 v[220:223], a[136:139], a[16:19], 0
    buffer_load_dwordx4 a[56:59], v243, s[12:15], s61 offen offset:128 nt
    v_mfma_f32_16x16x32_bf16 v[196:199], a[140:143], a[68:71], v[196:199]
    v_exp_f32 v194, v194
    v_mfma_f32_16x16x32_bf16 v[204:207], a[140:143], a[84:87], v[204:207]
    ds_read_b128 a[136:139], v241 offset:53248
    v_mul_f32_dpp v121, v245, v121 row_newbcast:1 row_mask:0xf bank_mask:0xf
    v_mfma_f32_16x16x32_bf16 v[212:215], a[140:143], a[4:7], v[212:215]
    v_exp_f32 v195, v195
    v_mfma_f32_16x16x32_bf16 v[220:223], a[140:143], a[20:23], v[220:223]
    v_mul_f32_dpp v125, v245, v125 row_newbcast:1 row_mask:0xf bank_mask:0xf
    v_cvt_pk_bf16_f32 v101, v105, v109
    v_mfma_f32_16x16x32_bf16 v[196:199], a[144:147], a[72:75], v[196:199]
    v_exp_f32 v200, v200
    v_mfma_f32_16x16x32_bf16 v[204:207], a[144:147], a[88:91], v[204:207]
    ds_read_b128 a[140:143], v241 offset:54272
    v_cvt_pk_bf16_f32 v102, v113, v117
    v_mfma_f32_16x16x32_bf16 v[212:215], a[144:147], a[8:11], v[212:215]
    v_exp_f32 v201, v201
    v_mfma_f32_16x16x32_bf16 v[220:223], a[144:147], a[24:27], v[220:223]
    v_cvt_pk_bf16_f32 v103, v121, v125
    v_mul_f32_dpp v106, v245, v106 row_newbcast:2 row_mask:0xf bank_mask:0xf
    s_waitcnt lgkmcnt(6)
    v_mfma_f32_16x16x32_bf16 v[196:199], a[148:151], a[76:79], v[196:199]
    v_exp_f32 v202, v202
    v_mfma_f32_16x16x32_bf16 v[204:207], a[148:151], a[92:95], v[204:207]
    ds_read_b128 a[144:147], v241 offset:55296
    v_mul_f32_dpp v107, v245, v107 row_newbcast:3 row_mask:0xf bank_mask:0xf
    v_mfma_f32_16x16x32_bf16 v[212:215], a[148:151], a[12:15], v[212:215]
    v_exp_f32 v203, v203
    v_mfma_f32_16x16x32_bf16 v[220:223], a[148:151], a[28:31], v[220:223]
    v_mul_f32_dpp v110, v245, v110 row_newbcast:2 row_mask:0xf bank_mask:0xf
    v_mul_f32_dpp v111, v245, v111 row_newbcast:3 row_mask:0xf bank_mask:0xf
    v_smfmac_f32_16x16x64_bf16 a[192:195], a[212:215], v[224:231], v247
    v_exp_f32 v208, v208
    v_smfmac_f32_16x16x64_bf16 a[196:199], a[212:215], v[232:239], v247
    buffer_store_dwordx4 v[76:79], v248, s[16:19], s54 offen offset:768 sc0 sc1
    v_mul_f32_dpp v114, v245, v114 row_newbcast:2 row_mask:0xf bank_mask:0xf
    s_waitcnt lgkmcnt(6)
    v_mfma_f32_16x16x32_bf16 v[128:131], v[224:227], a[152:155], v[128:131]
    v_exp_f32 v209, v209
    v_mfma_f32_16x16x32_bf16 v[0:3], v[228:231], a[152:155], v[0:3]
    ds_read_b128 a[148:151], v241 offset:56320
    v_mul_f32_dpp v118, v245, v118 row_newbcast:2 row_mask:0xf bank_mask:0xf
    v_mfma_f32_16x16x32_bf16 v[32:35], v[232:235], a[152:155], v[32:35]
    v_exp_f32 v210, v210
    v_mfma_f32_16x16x32_bf16 v[64:67], v[236:239], a[152:155], 0
    v_mul_f32_dpp v122, v245, v122 row_newbcast:2 row_mask:0xf bank_mask:0xf
    s_waitcnt lgkmcnt(3)
    v_mfma_f32_16x16x32_bf16 v[132:135], v[224:227], a[156:159], v[132:135]
    v_exp_f32 v211, v211
    v_mfma_f32_16x16x32_bf16 v[4:7], v[228:231], a[156:159], v[4:7]
    ds_read_b128 a[152:155], v240 offset:0
    v_mul_f32_dpp v126, v245, v126 row_newbcast:2 row_mask:0xf bank_mask:0xf
    v_mfma_f32_16x16x32_bf16 v[36:39], v[232:235], a[156:159], v[36:39]
    v_exp_f32 v216, v216
    v_mfma_f32_16x16x32_bf16 v[68:71], v[236:239], a[156:159], 0
    v_cvt_pk_bf16_f32 v105, v106, v110
    v_cvt_pk_bf16_f32 v106, v114, v118
    v_mfma_f32_16x16x32_bf16 v[136:139], v[224:227], a[128:131], v[136:139]
    v_exp_f32 v217, v217
    v_mfma_f32_16x16x32_bf16 v[8:11], v[228:231], a[128:131], v[8:11]
    ds_read_b128 a[156:159], v240 offset:1024
    v_cvt_pk_bf16_f32 v109, v107, v111
    v_mfma_f32_16x16x32_bf16 v[40:43], v[232:235], a[128:131], v[40:43]
    v_exp_f32 v218, v218
    v_mfma_f32_16x16x32_bf16 v[72:75], v[236:239], a[128:131], 0
    v_cvt_pk_bf16_f32 v107, v122, v126
    v_mul_f32_dpp v115, v245, v115 row_newbcast:3 row_mask:0xf bank_mask:0xf
    v_mfma_f32_16x16x32_bf16 v[140:143], v[224:227], a[132:135], v[140:143]
    v_exp_f32 v219, v219
    v_mfma_f32_16x16x32_bf16 v[12:15], v[228:231], a[132:135], v[12:15]
    ds_read_b128 a[128:131], v240 offset:2048
    v_mul_f32_dpp v119, v245, v119 row_newbcast:3 row_mask:0xf bank_mask:0xf
    v_mfma_f32_16x16x32_bf16 v[44:47], v[232:235], a[132:135], v[44:47]
    v_exp_f32 v196, v196
    v_mfma_f32_16x16x32_bf16 v[76:79], v[236:239], a[132:135], 0
    v_mul_f32_dpp v123, v245, v123 row_newbcast:3 row_mask:0xf bank_mask:0xf
    v_mul_f32_dpp v127, v245, v127 row_newbcast:3 row_mask:0xf bank_mask:0xf
    v_mfma_f32_16x16x32_bf16 v[144:147], v[224:227], a[136:139], v[144:147]
    v_exp_f32 v197, v197
    v_mfma_f32_16x16x32_bf16 v[16:19], v[228:231], a[136:139], v[16:19]
    ds_read_b128 a[132:135], v240 offset:3072
    v_cvt_pk_bf16_f32 v110, v115, v119
    v_mfma_f32_16x16x32_bf16 v[48:51], v[232:235], a[136:139], v[48:51]
    v_exp_f32 v198, v198
    v_mfma_f32_16x16x32_bf16 v[80:83], v[236:239], a[136:139], 0
    buffer_load_dwordx4 a[60:63], v243, s[12:15], s61 offen offset:192 nt
    s_waitcnt lgkmcnt(3)
    v_mfma_f32_16x16x32_bf16 v[148:151], v[224:227], a[140:143], v[148:151]
    v_exp_f32 v199, v199
    v_mfma_f32_16x16x32_bf16 v[20:23], v[228:231], a[140:143], v[20:23]
    ds_read_b128 a[136:139], v240 offset:4096
    v_cvt_pk_bf16_f32 v111, v123, v127
    v_mfma_f32_16x16x32_bf16 v[52:55], v[232:235], a[140:143], v[52:55]
    v_exp_f32 v204, v204
    v_mfma_f32_16x16x32_bf16 v[84:87], v[236:239], a[140:143], 0
    v_exp_f32 v205, v205
    v_mfma_f32_16x16x32_bf16 v[152:155], v[224:227], a[144:147], v[152:155]
    ds_read_b128 a[140:143], v240 offset:5120
    v_mfma_f32_16x16x32_bf16 v[24:27], v[228:231], a[144:147], v[24:27]
    v_exp_f32 v206, v206
    v_mfma_f32_16x16x32_bf16 v[56:59], v[232:235], a[144:147], v[56:59]
    buffer_store_dwordx4 v[96:99], v248, s[16:19], s55 offen offset:0 sc0 sc1
    v_mfma_f32_16x16x32_bf16 v[88:91], v[236:239], a[144:147], 0
    v_exp_f32 v207, v207
    v_mfma_f32_16x16x32_bf16 v[156:159], v[224:227], a[148:151], v[156:159]
    ds_read_b128 a[144:147], v240 offset:6144
    v_cvt_pk_bf16_f32 v224, v192, v193
    v_mfma_f32_16x16x32_bf16 v[28:31], v[228:231], a[148:151], v[28:31]
    v_exp_f32 v212, v212
    v_mfma_f32_16x16x32_bf16 v[60:63], v[232:235], a[148:151], v[60:63]
    v_cvt_pk_bf16_f32 v225, v194, v195
    v_cvt_pk_bf16_f32 v228, v200, v201
    v_mfma_f32_16x16x32_bf16 v[92:95], v[236:239], a[148:151], 0
    v_cvt_pk_bf16_f32 v229, v202, v203
    s_waitcnt vmcnt(9)
    v_mfma_f32_16x16x32_bf16 v[168:171], a[152:155], a[80:83], 0
    v_exp_f32 v213, v213
    v_mfma_f32_16x16x32_bf16 v[176:179], a[152:155], a[0:3], 0
    ds_read_b128 a[148:151], v240 offset:7168
    v_cvt_pk_bf16_f32 v226, v196, v197
    v_mfma_f32_16x16x32_bf16 v[184:187], a[152:155], a[16:19], 0
    v_exp_f32 v214, v214
    v_mfma_f32_16x16x32_bf16 v[160:163], a[152:155], a[32:35], 0
    v_cvt_pk_bf16_f32 v227, v198, v199
    s_waitcnt lgkmcnt(3)
    v_mfma_f32_16x16x32_bf16 v[168:171], a[156:159], a[84:87], v[168:171]
    v_exp_f32 v215, v215
    v_mfma_f32_16x16x32_bf16 v[176:179], a[156:159], a[4:7], v[176:179]
    ds_read_b128 a[152:155], v241 offset:57344
    v_cvt_pk_bf16_f32 v230, v204, v205
    v_mfma_f32_16x16x32_bf16 v[184:187], a[156:159], a[20:23], v[184:187]
    v_exp_f32 v220, v220
    v_mfma_f32_16x16x32_bf16 v[160:163], a[156:159], a[36:39], v[160:163]
    v_cvt_pk_bf16_f32 v231, v206, v207
    v_cvt_pk_bf16_f32 v232, v208, v209
    v_mfma_f32_16x16x32_bf16 v[168:171], a[128:131], a[88:91], v[168:171]
    v_exp_f32 v221, v221
    v_mfma_f32_16x16x32_bf16 v[176:179], a[128:131], a[8:11], v[176:179]
    ds_read_b128 a[156:159], v241 offset:58368
    v_cvt_pk_bf16_f32 v233, v210, v211
    v_mfma_f32_16x16x32_bf16 v[184:187], a[128:131], a[24:27], v[184:187]
    v_exp_f32 v222, v222
    v_mfma_f32_16x16x32_bf16 v[160:163], a[128:131], a[40:43], v[160:163]
    v_cvt_pk_bf16_f32 v236, v216, v217
    v_cvt_pk_bf16_f32 v237, v218, v219
    v_mfma_f32_16x16x32_bf16 v[168:171], a[132:135], a[92:95], v[168:171]
    v_exp_f32 v223, v223
    v_mfma_f32_16x16x32_bf16 v[176:179], a[132:135], a[12:15], v[176:179]
    ds_read_b128 a[128:131], v241 offset:59392
    v_cvt_pk_bf16_f32 v234, v212, v213
    v_mfma_f32_16x16x32_bf16 v[184:187], a[132:135], a[28:31], v[184:187]
    v_cvt_pk_bf16_f32 v235, v214, v215
    v_cvt_pk_bf16_f32 v238, v220, v221
    v_mfma_f32_16x16x32_bf16 v[160:163], a[132:135], a[44:47], v[160:163]
    v_cvt_pk_bf16_f32 v239, v222, v223
    v_mfma_f32_16x16x32_bf16 v[172:175], a[136:139], a[80:83], 0
    v_exp_f32 v168, v168
    v_mfma_f32_16x16x32_bf16 v[180:183], a[136:139], a[0:3], 0
    ds_read_b128 a[132:135], v241 offset:60416
    buffer_load_dwordx4 a[64:67], v243, s[12:15], s62 offen offset:0 nt
    v_mfma_f32_16x16x32_bf16 v[188:191], a[136:139], a[16:19], 0
    v_exp_f32 v169, v169
    v_mfma_f32_16x16x32_bf16 v[164:167], a[136:139], a[32:35], 0
    s_waitcnt lgkmcnt(3)
    v_mfma_f32_16x16x32_bf16 v[172:175], a[140:143], a[84:87], v[172:175]
    v_exp_f32 v170, v170
    v_mfma_f32_16x16x32_bf16 v[180:183], a[140:143], a[4:7], v[180:183]
    ds_read_b128 a[136:139], v241 offset:61440
    v_mfma_f32_16x16x32_bf16 v[188:191], a[140:143], a[20:23], v[188:191]
    v_exp_f32 v171, v171
    v_mfma_f32_16x16x32_bf16 v[164:167], a[140:143], a[36:39], v[164:167]
    v_exp_f32 v176, v176
    v_mfma_f32_16x16x32_bf16 v[172:175], a[144:147], a[88:91], v[172:175]
    ds_read_b128 a[140:143], v241 offset:62464
    v_mfma_f32_16x16x32_bf16 v[180:183], a[144:147], a[8:11], v[180:183]
    v_exp_f32 v177, v177
    v_mfma_f32_16x16x32_bf16 v[188:191], a[144:147], a[24:27], v[188:191]
    v_exp_f32 v178, v178
    v_mfma_f32_16x16x32_bf16 v[164:167], a[144:147], a[40:43], v[164:167]
    v_exp_f32 v179, v179
    v_mfma_f32_16x16x32_bf16 v[172:175], a[148:151], a[92:95], v[172:175]
    buffer_store_dwordx4 v[100:103], v248, s[16:19], s55 offen offset:256 sc0 sc1
    ds_read_b128 a[144:147], v241 offset:63488
    v_mfma_f32_16x16x32_bf16 v[180:183], a[148:151], a[12:15], v[180:183]
    v_exp_f32 v184, v184
    v_mfma_f32_16x16x32_bf16 v[188:191], a[148:151], a[28:31], v[188:191]
    v_exp_f32 v185, v185
    v_mfma_f32_16x16x32_bf16 v[164:167], a[148:151], a[44:47], v[164:167]
    v_exp_f32 v186, v186
    v_smfmac_f32_16x16x64_bf16 a[192:195], a[212:215], v[224:231], v247
    v_exp_f32 v187, v187
    v_smfmac_f32_16x16x64_bf16 a[196:199], a[212:215], v[232:239], v247
    v_exp_f32 v160, v160
    v_mfma_f32_16x16x32_bf16 v[128:131], v[224:227], a[152:155], v[128:131]
    ds_read_b128 a[148:151], v241 offset:64512
    v_mfma_f32_16x16x32_bf16 v[0:3], v[228:231], a[152:155], v[0:3]
    v_exp_f32 v161, v161
    v_mfma_f32_16x16x32_bf16 v[32:35], v[232:235], a[152:155], v[32:35]
    v_accvgpr_read_b32 v249, a192
    v_accvgpr_read_b32 v251, a193
    v_mfma_f32_16x16x32_bf16 v[64:67], v[236:239], a[152:155], v[64:67]
    v_add_f32 v249, v249, v251
    s_waitcnt lgkmcnt(3)
    v_mfma_f32_16x16x32_bf16 v[132:135], v[224:227], a[156:159], v[132:135]
    v_exp_f32 v162, v162
    v_mfma_f32_16x16x32_bf16 v[4:7], v[228:231], a[156:159], v[4:7]
    ds_read_b128 a[152:155], v240 offset:8192
    v_subrev_u32 v246, s48, v249
    v_mfma_f32_16x16x32_bf16 v[36:39], v[232:235], a[156:159], v[36:39]
    v_exp_f32 v163, v163
    v_mfma_f32_16x16x32_bf16 v[68:71], v[236:239], a[156:159], v[68:71]
    v_rcp_f32 v244, v249
    v_mfma_f32_16x16x32_bf16 v[136:139], v[224:227], a[128:131], v[136:139]
    v_exp_f32 v172, v172
    v_mfma_f32_16x16x32_bf16 v[8:11], v[228:231], a[128:131], v[8:11]
    ds_read_b128 a[156:159], v240 offset:9216
    v_max_u32 v253, v253, v246
    v_mfma_f32_16x16x32_bf16 v[40:43], v[232:235], a[128:131], v[40:43]
    v_exp_f32 v173, v173
    v_mfma_f32_16x16x32_bf16 v[72:75], v[236:239], a[128:131], v[72:75]
    ds_bpermute_b32 v244, v242, v244
    v_accvgpr_write_b32 a192, 0
    v_mfma_f32_16x16x32_bf16 v[140:143], v[224:227], a[132:135], v[140:143]
    v_exp_f32 v174, v174
    v_mfma_f32_16x16x32_bf16 v[12:15], v[228:231], a[132:135], v[12:15]
    ds_read_b128 a[128:131], v240 offset:10240
    v_accvgpr_write_b32 a193, 0
    v_mfma_f32_16x16x32_bf16 v[44:47], v[232:235], a[132:135], v[44:47]
    v_exp_f32 v175, v175
    v_mfma_f32_16x16x32_bf16 v[76:79], v[236:239], a[132:135], v[76:79]
    v_exp_f32 v180, v180
    v_mfma_f32_16x16x32_bf16 v[144:147], v[224:227], a[136:139], v[144:147]
    ds_read_b128 a[132:135], v240 offset:11264
    v_mfma_f32_16x16x32_bf16 v[16:19], v[228:231], a[136:139], v[16:19]
    v_exp_f32 v181, v181
    v_mfma_f32_16x16x32_bf16 v[48:51], v[232:235], a[136:139], v[48:51]
    buffer_load_dwordx4 a[68:71], v243, s[12:15], s62 offen offset:64 nt
    v_mfma_f32_16x16x32_bf16 v[80:83], v[236:239], a[136:139], v[80:83]
    s_waitcnt lgkmcnt(2)
    v_mul_f32_dpp v128, v244, v128 row_newbcast:0 row_mask:0xf bank_mask:0xf
    v_mfma_f32_16x16x32_bf16 v[148:151], v[224:227], a[140:143], v[148:151]
    v_exp_f32 v182, v182
    v_mfma_f32_16x16x32_bf16 v[20:23], v[228:231], a[140:143], v[20:23]
    ds_read_b128 a[136:139], v240 offset:12288
    v_mul_f32_dpp v129, v244, v129 row_newbcast:1 row_mask:0xf bank_mask:0xf
    v_mfma_f32_16x16x32_bf16 v[52:55], v[232:235], a[140:143], v[52:55]
    v_exp_f32 v183, v183
    v_mfma_f32_16x16x32_bf16 v[84:87], v[236:239], a[140:143], v[84:87]
    v_mul_f32_dpp v130, v244, v130 row_newbcast:2 row_mask:0xf bank_mask:0xf
    v_mul_f32_dpp v131, v244, v131 row_newbcast:3 row_mask:0xf bank_mask:0xf
    v_mfma_f32_16x16x32_bf16 v[152:155], v[224:227], a[144:147], v[152:155]
    v_exp_f32 v188, v188
    v_mfma_f32_16x16x32_bf16 v[24:27], v[228:231], a[144:147], v[24:27]
    ds_read_b128 a[140:143], v240 offset:13312
    v_mul_f32_dpp v132, v244, v132 row_newbcast:0 row_mask:0xf bank_mask:0xf
    v_mfma_f32_16x16x32_bf16 v[56:59], v[232:235], a[144:147], v[56:59]
    v_exp_f32 v189, v189
    v_mfma_f32_16x16x32_bf16 v[88:91], v[236:239], a[144:147], v[88:91]
    v_mul_f32_dpp v133, v244, v133 row_newbcast:1 row_mask:0xf bank_mask:0xf
    v_mul_f32_dpp v134, v244, v134 row_newbcast:2 row_mask:0xf bank_mask:0xf
    v_mfma_f32_16x16x32_bf16 v[156:159], v[224:227], a[148:151], v[156:159]
    v_exp_f32 v190, v190
    v_mfma_f32_16x16x32_bf16 v[28:31], v[228:231], a[148:151], v[28:31]
    ds_read_b128 a[144:147], v240 offset:14336
    v_cvt_pk_bf16_f32 v228, v168, v169
    v_mfma_f32_16x16x32_bf16 v[60:63], v[232:235], a[148:151], v[60:63]
    v_exp_f32 v191, v191
    v_mfma_f32_16x16x32_bf16 v[92:95], v[236:239], a[148:151], v[92:95]
    buffer_store_dwordx4 v[104:107], v248, s[16:19], s55 offen offset:512 sc0 sc1
    v_cvt_pk_bf16_f32 v229, v170, v171
    v_mfma_f32_16x16x32_bf16 v[200:203], a[152:155], a[80:83], 0
    v_exp_f32 v164, v164
    v_mfma_f32_16x16x32_bf16 v[208:211], a[152:155], a[0:3], 0
    ds_read_b128 a[148:151], v240 offset:15360
    v_cvt_pk_bf16_f32 v224, v160, v161
    v_mfma_f32_16x16x32_bf16 v[216:219], a[152:155], a[16:19], 0
    v_exp_f32 v165, v165
    v_mfma_f32_16x16x32_bf16 v[192:195], a[152:155], a[32:35], 0
    v_cvt_pk_bf16_f32 v225, v162, v163
    v_mfma_f32_16x16x32_bf16 v[200:203], a[156:159], a[84:87], v[200:203]
    v_exp_f32 v166, v166
    v_mfma_f32_16x16x32_bf16 v[208:211], a[156:159], a[4:7], v[208:211]
    ds_read_b128 a[152:155], v241 offset:0
    v_cvt_pk_bf16_f32 v230, v172, v173
    v_mfma_f32_16x16x32_bf16 v[216:219], a[156:159], a[20:23], v[216:219]
    v_exp_f32 v167, v167
    v_mfma_f32_16x16x32_bf16 v[192:195], a[156:159], a[36:39], v[192:195]
    v_cvt_pk_bf16_f32 v231, v174, v175
    v_cvt_pk_bf16_f32 v226, v164, v165
    s_waitcnt lgkmcnt(6)
    v_mfma_f32_16x16x32_bf16 v[200:203], a[128:131], a[88:91], v[200:203]
    ds_read_b128 a[156:159], v241 offset:1024
    v_cvt_pk_bf16_f32 v227, v166, v167
    v_mfma_f32_16x16x32_bf16 v[208:211], a[128:131], a[8:11], v[208:211]
    v_cvt_pk_bf16_f32 v232, v176, v177
    v_cvt_pk_bf16_f32 v233, v178, v179
    v_mfma_f32_16x16x32_bf16 v[216:219], a[128:131], a[24:27], v[216:219]
    v_cvt_pk_bf16_f32 v236, v184, v185
    v_cvt_pk_bf16_f32 v237, v186, v187
    v_mfma_f32_16x16x32_bf16 v[192:195], a[128:131], a[40:43], v[192:195]
    v_cvt_pk_bf16_f32 v234, v180, v181
    v_cvt_pk_bf16_f32 v235, v182, v183
    s_waitcnt lgkmcnt(6)
    v_mfma_f32_16x16x32_bf16 v[200:203], a[132:135], a[92:95], v[200:203]
    ds_read_b128 a[128:131], v241 offset:2048
    v_cvt_pk_bf16_f32 v238, v188, v189
    v_mfma_f32_16x16x32_bf16 v[208:211], a[132:135], a[12:15], v[208:211]
    v_cvt_pk_bf16_f32 v239, v190, v191
    v_mul_f32_dpp v135, v244, v135 row_newbcast:3 row_mask:0xf bank_mask:0xf
    v_mfma_f32_16x16x32_bf16 v[216:219], a[132:135], a[28:31], v[216:219]
    v_mul_f32_dpp v136, v244, v136 row_newbcast:0 row_mask:0xf bank_mask:0xf
    v_mul_f32_dpp v140, v244, v140 row_newbcast:0 row_mask:0xf bank_mask:0xf
    v_mfma_f32_16x16x32_bf16 v[192:195], a[132:135], a[44:47], v[192:195]
    v_mul_f32_dpp v144, v244, v144 row_newbcast:0 row_mask:0xf bank_mask:0xf
    v_mul_f32_dpp v148, v244, v148 row_newbcast:0 row_mask:0xf bank_mask:0xf
    s_waitcnt lgkmcnt(6)
    v_mfma_f32_16x16x32_bf16 v[204:207], a[136:139], a[80:83], 0
    v_exp_f32 v200, v200
    v_mfma_f32_16x16x32_bf16 v[212:215], a[136:139], a[0:3], 0
    ds_read_b128 a[132:135], v241 offset:3072
    v_mul_f32_dpp v152, v244, v152 row_newbcast:0 row_mask:0xf bank_mask:0xf
    v_mfma_f32_16x16x32_bf16 v[220:223], a[136:139], a[16:19], 0
    v_exp_f32 v201, v201
    v_mfma_f32_16x16x32_bf16 v[196:199], a[136:139], a[32:35], 0
    buffer_load_dwordx4 a[72:75], v243, s[12:15], s62 offen offset:128 nt
    s_waitcnt lgkmcnt(3)
    v_mfma_f32_16x16x32_bf16 v[204:207], a[140:143], a[84:87], v[204:207]
    v_exp_f32 v202, v202
    v_mfma_f32_16x16x32_bf16 v[212:215], a[140:143], a[4:7], v[212:215]
    ds_read_b128 a[136:139], v241 offset:4096
    v_mul_f32_dpp v156, v244, v156 row_newbcast:0 row_mask:0xf bank_mask:0xf
    v_mfma_f32_16x16x32_bf16 v[220:223], a[140:143], a[20:23], v[220:223]
    v_exp_f32 v203, v203
    v_mfma_f32_16x16x32_bf16 v[196:199], a[140:143], a[36:39], v[196:199]
    v_cvt_pk_bf16_f32 v128, v128, v132
    v_cvt_pk_bf16_f32 v132, v129, v133
    v_mfma_f32_16x16x32_bf16 v[204:207], a[144:147], a[88:91], v[204:207]
    v_exp_f32 v208, v208
    v_mfma_f32_16x16x32_bf16 v[212:215], a[144:147], a[8:11], v[212:215]
    ds_read_b128 a[140:143], v241 offset:5120
    v_cvt_pk_bf16_f32 v129, v136, v140
    v_mfma_f32_16x16x32_bf16 v[220:223], a[144:147], a[24:27], v[220:223]
    v_exp_f32 v209, v209
    v_mfma_f32_16x16x32_bf16 v[196:199], a[144:147], a[40:43], v[196:199]
    v_cvt_pk_bf16_f32 v136, v130, v134
    v_cvt_pk_bf16_f32 v140, v131, v135
    v_mfma_f32_16x16x32_bf16 v[204:207], a[148:151], a[92:95], v[204:207]
    v_exp_f32 v210, v210
    v_mfma_f32_16x16x32_bf16 v[212:215], a[148:151], a[12:15], v[212:215]
    ds_read_b128 a[144:147], v241 offset:6144
    v_cvt_pk_bf16_f32 v130, v144, v148
    v_mfma_f32_16x16x32_bf16 v[220:223], a[148:151], a[28:31], v[220:223]
    v_exp_f32 v211, v211
    v_mfma_f32_16x16x32_bf16 v[196:199], a[148:151], a[44:47], v[196:199]
    v_cvt_pk_bf16_f32 v131, v152, v156
    v_mul_f32_dpp v137, v244, v137 row_newbcast:1 row_mask:0xf bank_mask:0xf
    v_smfmac_f32_16x16x64_bf16 a[192:195], a[212:215], v[224:231], v247
    v_exp_f32 v216, v216
    v_smfmac_f32_16x16x64_bf16 a[196:199], a[212:215], v[232:239], v247
    buffer_store_dwordx4 v[108:111], v248, s[16:19], s55 offen offset:768 sc0 sc1
    v_mul_f32_dpp v141, v244, v141 row_newbcast:1 row_mask:0xf bank_mask:0xf
    v_mfma_f32_16x16x32_bf16 v[0:3], v[228:231], a[152:155], v[0:3]
    v_exp_f32 v217, v217
    v_mfma_f32_16x16x32_bf16 v[32:35], v[232:235], a[152:155], v[32:35]
    ds_read_b128 a[148:151], v241 offset:7168
    v_mul_f32_dpp v145, v244, v145 row_newbcast:1 row_mask:0xf bank_mask:0xf
    v_mfma_f32_16x16x32_bf16 v[64:67], v[236:239], a[152:155], v[64:67]
    v_exp_f32 v218, v218
    v_mfma_f32_16x16x32_bf16 v[96:99], v[224:227], a[152:155], 0
    v_mul_f32_dpp v149, v244, v149 row_newbcast:1 row_mask:0xf bank_mask:0xf
    s_waitcnt lgkmcnt(3)
    v_mfma_f32_16x16x32_bf16 v[4:7], v[228:231], a[156:159], v[4:7]
    v_exp_f32 v219, v219
    v_mfma_f32_16x16x32_bf16 v[36:39], v[232:235], a[156:159], v[36:39]
    ds_read_b128 a[152:155], v240 offset:16384
    v_mul_f32_dpp v153, v244, v153 row_newbcast:1 row_mask:0xf bank_mask:0xf
    v_mfma_f32_16x16x32_bf16 v[68:71], v[236:239], a[156:159], v[68:71]
    v_exp_f32 v192, v192
    v_mfma_f32_16x16x32_bf16 v[100:103], v[224:227], a[156:159], 0
    v_mul_f32_dpp v157, v244, v157 row_newbcast:1 row_mask:0xf bank_mask:0xf
    v_cvt_pk_bf16_f32 v133, v137, v141
    v_mfma_f32_16x16x32_bf16 v[8:11], v[228:231], a[128:131], v[8:11]
    v_exp_f32 v193, v193
    v_mfma_f32_16x16x32_bf16 v[40:43], v[232:235], a[128:131], v[40:43]
    ds_read_b128 a[156:159], v240 offset:17408
    v_cvt_pk_bf16_f32 v134, v145, v149
    v_mfma_f32_16x16x32_bf16 v[72:75], v[236:239], a[128:131], v[72:75]
    v_exp_f32 v194, v194
    v_mfma_f32_16x16x32_bf16 v[104:107], v[224:227], a[128:131], 0
    v_cvt_pk_bf16_f32 v135, v153, v157
    v_mul_f32_dpp v138, v244, v138 row_newbcast:2 row_mask:0xf bank_mask:0xf
    v_mfma_f32_16x16x32_bf16 v[12:15], v[228:231], a[132:135], v[12:15]
    v_exp_f32 v195, v195
    v_mfma_f32_16x16x32_bf16 v[44:47], v[232:235], a[132:135], v[44:47]
    ds_read_b128 a[128:131], v240 offset:18432
    v_mul_f32_dpp v139, v244, v139 row_newbcast:3 row_mask:0xf bank_mask:0xf
    v_mfma_f32_16x16x32_bf16 v[76:79], v[236:239], a[132:135], v[76:79]
    v_exp_f32 v204, v204
    v_mfma_f32_16x16x32_bf16 v[108:111], v[224:227], a[132:135], 0
    v_mul_f32_dpp v142, v244, v142 row_newbcast:2 row_mask:0xf bank_mask:0xf
    v_mul_f32_dpp v143, v244, v143 row_newbcast:3 row_mask:0xf bank_mask:0xf
    v_mfma_f32_16x16x32_bf16 v[16:19], v[228:231], a[136:139], v[16:19]
    v_exp_f32 v205, v205
    v_mfma_f32_16x16x32_bf16 v[48:51], v[232:235], a[136:139], v[48:51]
    ds_read_b128 a[132:135], v240 offset:19456
    v_mul_f32_dpp v146, v244, v146 row_newbcast:2 row_mask:0xf bank_mask:0xf
    v_mfma_f32_16x16x32_bf16 v[80:83], v[236:239], a[136:139], v[80:83]
    v_exp_f32 v206, v206
    v_mfma_f32_16x16x32_bf16 v[112:115], v[224:227], a[136:139], 0
    buffer_load_dwordx4 a[76:79], v243, s[12:15], s62 offen offset:192 nt
    s_waitcnt lgkmcnt(3)
    v_mfma_f32_16x16x32_bf16 v[20:23], v[228:231], a[140:143], v[20:23]
    v_exp_f32 v207, v207
    v_mfma_f32_16x16x32_bf16 v[52:55], v[232:235], a[140:143], v[52:55]
    ds_read_b128 a[136:139], v240 offset:20480
    v_mul_f32_dpp v150, v244, v150 row_newbcast:2 row_mask:0xf bank_mask:0xf
    v_mfma_f32_16x16x32_bf16 v[84:87], v[236:239], a[140:143], v[84:87]
    v_exp_f32 v212, v212
    v_mfma_f32_16x16x32_bf16 v[116:119], v[224:227], a[140:143], 0
    v_mul_f32_dpp v154, v244, v154 row_newbcast:2 row_mask:0xf bank_mask:0xf
    v_mul_f32_dpp v158, v244, v158 row_newbcast:2 row_mask:0xf bank_mask:0xf
    v_mfma_f32_16x16x32_bf16 v[24:27], v[228:231], a[144:147], v[24:27]
    v_exp_f32 v213, v213
    v_mfma_f32_16x16x32_bf16 v[56:59], v[232:235], a[144:147], v[56:59]
    ds_read_b128 a[140:143], v240 offset:21504
    buffer_store_dwordx4 v[128:131], v248, s[16:19], s56 offen offset:0 sc0 sc1
    v_mfma_f32_16x16x32_bf16 v[88:91], v[236:239], a[144:147], v[88:91]
    v_exp_f32 v214, v214
    v_mfma_f32_16x16x32_bf16 v[120:123], v[224:227], a[144:147], 0
    v_cvt_pk_bf16_f32 v137, v138, v142
    v_cvt_pk_bf16_f32 v138, v146, v150
    v_mfma_f32_16x16x32_bf16 v[28:31], v[228:231], a[148:151], v[28:31]
    v_exp_f32 v215, v215
    v_mfma_f32_16x16x32_bf16 v[60:63], v[232:235], a[148:151], v[60:63]
    ds_read_b128 a[144:147], v240 offset:22528
    v_cvt_pk_bf16_f32 v228, v200, v201
    v_mfma_f32_16x16x32_bf16 v[92:95], v[236:239], a[148:151], v[92:95]
    v_exp_f32 v220, v220
    v_mfma_f32_16x16x32_bf16 v[124:127], v[224:227], a[148:151], 0
    v_cvt_pk_bf16_f32 v229, v202, v203
    s_waitcnt vmcnt(9)
    v_mfma_f32_16x16x32_bf16 v[176:179], a[152:155], a[0:3], 0
    v_exp_f32 v221, v221
    v_mfma_f32_16x16x32_bf16 v[184:187], a[152:155], a[16:19], 0
    ds_read_b128 a[148:151], v240 offset:23552
    v_cvt_pk_bf16_f32 v224, v192, v193
    v_mfma_f32_16x16x32_bf16 v[160:163], a[152:155], a[32:35], 0
    v_exp_f32 v222, v222
    v_mfma_f32_16x16x32_bf16 v[168:171], a[152:155], a[48:51], 0
    v_cvt_pk_bf16_f32 v225, v194, v195
    s_waitcnt lgkmcnt(3)
    v_mfma_f32_16x16x32_bf16 v[176:179], a[156:159], a[4:7], v[176:179]
    v_exp_f32 v223, v223
    v_mfma_f32_16x16x32_bf16 v[184:187], a[156:159], a[20:23], v[184:187]
    ds_read_b128 a[152:155], v241 offset:8192
    v_cvt_pk_bf16_f32 v230, v204, v205
    v_mfma_f32_16x16x32_bf16 v[160:163], a[156:159], a[36:39], v[160:163]
    v_exp_f32 v196, v196
    v_mfma_f32_16x16x32_bf16 v[168:171], a[156:159], a[52:55], v[168:171]
    v_cvt_pk_bf16_f32 v231, v206, v207
    v_cvt_pk_bf16_f32 v232, v208, v209
    v_mfma_f32_16x16x32_bf16 v[176:179], a[128:131], a[8:11], v[176:179]
    v_exp_f32 v197, v197
    v_mfma_f32_16x16x32_bf16 v[184:187], a[128:131], a[24:27], v[184:187]
    ds_read_b128 a[156:159], v241 offset:9216
    v_cvt_pk_bf16_f32 v226, v196, v197
    v_mfma_f32_16x16x32_bf16 v[160:163], a[128:131], a[40:43], v[160:163]
    v_exp_f32 v198, v198
    v_mfma_f32_16x16x32_bf16 v[168:171], a[128:131], a[56:59], v[168:171]
    v_cvt_pk_bf16_f32 v233, v210, v211
    v_cvt_pk_bf16_f32 v236, v216, v217
    v_mfma_f32_16x16x32_bf16 v[176:179], a[132:135], a[12:15], v[176:179]
    v_exp_f32 v199, v199
    v_mfma_f32_16x16x32_bf16 v[184:187], a[132:135], a[28:31], v[184:187]
    ds_read_b128 a[128:131], v241 offset:10240
    v_cvt_pk_bf16_f32 v227, v198, v199
    v_mfma_f32_16x16x32_bf16 v[160:163], a[132:135], a[44:47], v[160:163]
    v_cvt_pk_bf16_f32 v237, v218, v219
    v_cvt_pk_bf16_f32 v234, v212, v213
    v_mfma_f32_16x16x32_bf16 v[168:171], a[132:135], a[60:63], v[168:171]
    v_cvt_pk_bf16_f32 v235, v214, v215
    v_cvt_pk_bf16_f32 v238, v220, v221
    v_mfma_f32_16x16x32_bf16 v[180:183], a[136:139], a[0:3], 0
    v_exp_f32 v176, v176
    v_mfma_f32_16x16x32_bf16 v[188:191], a[136:139], a[16:19], 0
    ds_read_b128 a[132:135], v241 offset:11264
    buffer_load_dwordx4 a[80:83], v243, s[12:15], s63 offen offset:0 nt
    v_mfma_f32_16x16x32_bf16 v[164:167], a[136:139], a[32:35], 0
    v_exp_f32 v177, v177
    v_mfma_f32_16x16x32_bf16 v[172:175], a[136:139], a[48:51], 0
    v_cvt_pk_bf16_f32 v239, v222, v223
    s_waitcnt lgkmcnt(3)
    v_mfma_f32_16x16x32_bf16 v[180:183], a[140:143], a[4:7], v[180:183]
    v_exp_f32 v178, v178
    v_mfma_f32_16x16x32_bf16 v[188:191], a[140:143], a[20:23], v[188:191]
    ds_read_b128 a[136:139], v241 offset:12288
    v_cvt_pk_bf16_f32 v141, v139, v143
    v_mfma_f32_16x16x32_bf16 v[164:167], a[140:143], a[36:39], v[164:167]
    v_exp_f32 v179, v179
    v_mfma_f32_16x16x32_bf16 v[172:175], a[140:143], a[52:55], v[172:175]
    v_cvt_pk_bf16_f32 v139, v154, v158
    v_mul_f32_dpp v147, v244, v147 row_newbcast:3 row_mask:0xf bank_mask:0xf
    v_mfma_f32_16x16x32_bf16 v[180:183], a[144:147], a[8:11], v[180:183]
    v_exp_f32 v184, v184
    v_mfma_f32_16x16x32_bf16 v[188:191], a[144:147], a[24:27], v[188:191]
    ds_read_b128 a[140:143], v241 offset:13312
    v_mul_f32_dpp v151, v244, v151 row_newbcast:3 row_mask:0xf bank_mask:0xf
    v_mfma_f32_16x16x32_bf16 v[164:167], a[144:147], a[40:43], v[164:167]
    v_exp_f32 v185, v185
    v_mfma_f32_16x16x32_bf16 v[172:175], a[144:147], a[56:59], v[172:175]
    v_mul_f32_dpp v155, v244, v155 row_newbcast:3 row_mask:0xf bank_mask:0xf
    v_mul_f32_dpp v159, v244, v159 row_newbcast:3 row_mask:0xf bank_mask:0xf
    v_mfma_f32_16x16x32_bf16 v[180:183], a[148:151], a[12:15], v[180:183]
    v_exp_f32 v186, v186
    v_mfma_f32_16x16x32_bf16 v[188:191], a[148:151], a[28:31], v[188:191]
    buffer_store_dwordx4 v[132:135], v248, s[16:19], s56 offen offset:256 sc0 sc1
    ds_read_b128 a[144:147], v241 offset:14336
    v_mfma_f32_16x16x32_bf16 v[164:167], a[148:151], a[44:47], v[164:167]
    v_exp_f32 v187, v187
    v_mfma_f32_16x16x32_bf16 v[172:175], a[148:151], a[60:63], v[172:175]
    v_cvt_pk_bf16_f32 v142, v147, v151
    v_cvt_pk_bf16_f32 v143, v155, v159
    v_smfmac_f32_16x16x64_bf16 a[192:195], a[212:215], v[224:231], v247
    v_exp_f32 v160, v160
    v_smfmac_f32_16x16x64_bf16 a[196:199], a[212:215], v[232:239], v247
    v_exp_f32 v161, v161
    v_mfma_f32_16x16x32_bf16 v[0:3], v[228:231], a[152:155], v[0:3]
    ds_read_b128 a[148:151], v241 offset:15360
    v_mfma_f32_16x16x32_bf16 v[32:35], v[232:235], a[152:155], v[32:35]
    v_exp_f32 v162, v162
    v_mfma_f32_16x16x32_bf16 v[64:67], v[236:239], a[152:155], v[64:67]
    v_accvgpr_read_b32 v250, a194
    v_accvgpr_read_b32 v251, a195
    v_mfma_f32_16x16x32_bf16 v[96:99], v[224:227], a[152:155], v[96:99]
    v_add_f32 v250, v250, v251
    s_waitcnt lgkmcnt(3)
    v_mfma_f32_16x16x32_bf16 v[4:7], v[228:231], a[156:159], v[4:7]
    v_exp_f32 v163, v163
    v_mfma_f32_16x16x32_bf16 v[36:39], v[232:235], a[156:159], v[36:39]
    ds_read_b128 a[152:155], v240 offset:24576
    v_subrev_u32 v246, s48, v250
    v_mfma_f32_16x16x32_bf16 v[68:71], v[236:239], a[156:159], v[68:71]
    v_exp_f32 v168, v168
    v_mfma_f32_16x16x32_bf16 v[100:103], v[224:227], a[156:159], v[100:103]
    v_rcp_f32 v245, v250
    v_mfma_f32_16x16x32_bf16 v[8:11], v[228:231], a[128:131], v[8:11]
    v_exp_f32 v169, v169
    v_mfma_f32_16x16x32_bf16 v[40:43], v[232:235], a[128:131], v[40:43]
    ds_read_b128 a[156:159], v240 offset:25600
    v_max_u32 v253, v253, v246
    v_mfma_f32_16x16x32_bf16 v[72:75], v[236:239], a[128:131], v[72:75]
    v_exp_f32 v170, v170
    v_mfma_f32_16x16x32_bf16 v[104:107], v[224:227], a[128:131], v[104:107]
    ds_bpermute_b32 v245, v242, v245
    v_accvgpr_write_b32 a194, 0
    v_mfma_f32_16x16x32_bf16 v[12:15], v[228:231], a[132:135], v[12:15]
    v_exp_f32 v171, v171
    v_mfma_f32_16x16x32_bf16 v[44:47], v[232:235], a[132:135], v[44:47]
    ds_read_b128 a[128:131], v240 offset:26624
    v_accvgpr_write_b32 a195, 0
    v_mfma_f32_16x16x32_bf16 v[76:79], v[236:239], a[132:135], v[76:79]
    v_exp_f32 v180, v180
    v_mfma_f32_16x16x32_bf16 v[108:111], v[224:227], a[132:135], v[108:111]
    v_exp_f32 v181, v181
    v_mfma_f32_16x16x32_bf16 v[16:19], v[228:231], a[136:139], v[16:19]
    ds_read_b128 a[132:135], v240 offset:27648
    v_mfma_f32_16x16x32_bf16 v[48:51], v[232:235], a[136:139], v[48:51]
    v_exp_f32 v182, v182
    v_mfma_f32_16x16x32_bf16 v[80:83], v[236:239], a[136:139], v[80:83]
    buffer_load_dwordx4 a[84:87], v243, s[12:15], s63 offen offset:64 nt
    v_mfma_f32_16x16x32_bf16 v[112:115], v[224:227], a[136:139], v[112:115]
    s_waitcnt lgkmcnt(2)
    v_mul_f32_dpp v0, v245, v0 row_newbcast:0 row_mask:0xf bank_mask:0xf
    v_mfma_f32_16x16x32_bf16 v[20:23], v[228:231], a[140:143], v[20:23]
    v_exp_f32 v183, v183
    v_mfma_f32_16x16x32_bf16 v[52:55], v[232:235], a[140:143], v[52:55]
    ds_read_b128 a[136:139], v240 offset:28672
    v_mul_f32_dpp v1, v245, v1 row_newbcast:1 row_mask:0xf bank_mask:0xf
    v_mfma_f32_16x16x32_bf16 v[84:87], v[236:239], a[140:143], v[84:87]
    v_exp_f32 v188, v188
    v_mfma_f32_16x16x32_bf16 v[116:119], v[224:227], a[140:143], v[116:119]
    v_mul_f32_dpp v2, v245, v2 row_newbcast:2 row_mask:0xf bank_mask:0xf
    v_mul_f32_dpp v3, v245, v3 row_newbcast:3 row_mask:0xf bank_mask:0xf
    v_mfma_f32_16x16x32_bf16 v[24:27], v[228:231], a[144:147], v[24:27]
    v_exp_f32 v189, v189
    v_mfma_f32_16x16x32_bf16 v[56:59], v[232:235], a[144:147], v[56:59]
    ds_read_b128 a[140:143], v240 offset:29696
    v_mul_f32_dpp v4, v245, v4 row_newbcast:0 row_mask:0xf bank_mask:0xf
    v_mfma_f32_16x16x32_bf16 v[88:91], v[236:239], a[144:147], v[88:91]
    v_exp_f32 v190, v190
    v_mfma_f32_16x16x32_bf16 v[120:123], v[224:227], a[144:147], v[120:123]
    v_mul_f32_dpp v5, v245, v5 row_newbcast:1 row_mask:0xf bank_mask:0xf
    v_mul_f32_dpp v6, v245, v6 row_newbcast:2 row_mask:0xf bank_mask:0xf
    v_mfma_f32_16x16x32_bf16 v[28:31], v[228:231], a[148:151], v[28:31]
    v_exp_f32 v191, v191
    v_mfma_f32_16x16x32_bf16 v[60:63], v[232:235], a[148:151], v[60:63]
    ds_read_b128 a[144:147], v240 offset:30720
    v_cvt_pk_bf16_f32 v232, v176, v177
    v_mfma_f32_16x16x32_bf16 v[92:95], v[236:239], a[148:151], v[92:95]
    v_exp_f32 v164, v164
    v_mfma_f32_16x16x32_bf16 v[124:127], v[224:227], a[148:151], v[124:127]
    buffer_store_dwordx4 v[136:139], v248, s[16:19], s56 offen offset:512 sc0 sc1
    v_cvt_pk_bf16_f32 v233, v178, v179
    v_mfma_f32_16x16x32_bf16 v[208:211], a[152:155], a[0:3], 0
    v_exp_f32 v165, v165
    v_mfma_f32_16x16x32_bf16 v[216:219], a[152:155], a[16:19], 0
    ds_read_b128 a[148:151], v240 offset:31744
    v_cvt_pk_bf16_f32 v236, v184, v185
    v_mfma_f32_16x16x32_bf16 v[192:195], a[152:155], a[32:35], 0
    v_exp_f32 v166, v166
    v_mfma_f32_16x16x32_bf16 v[200:203], a[152:155], a[48:51], 0
    v_cvt_pk_bf16_f32 v237, v186, v187
    v_mfma_f32_16x16x32_bf16 v[208:211], a[156:159], a[4:7], v[208:211]
    v_exp_f32 v167, v167
    v_mfma_f32_16x16x32_bf16 v[216:219], a[156:159], a[20:23], v[216:219]
    ds_read_b128 a[152:155], v241 offset:16384
    v_cvt_pk_bf16_f32 v234, v180, v181
    v_mfma_f32_16x16x32_bf16 v[192:195], a[156:159], a[36:39], v[192:195]
    v_exp_f32 v172, v172
    v_mfma_f32_16x16x32_bf16 v[200:203], a[156:159], a[52:55], v[200:203]
    v_cvt_pk_bf16_f32 v235, v182, v183
    v_cvt_pk_bf16_f32 v238, v188, v189
    s_waitcnt lgkmcnt(6)
    v_mfma_f32_16x16x32_bf16 v[208:211], a[128:131], a[8:11], v[208:211]
    v_exp_f32 v173, v173
    v_mfma_f32_16x16x32_bf16 v[216:219], a[128:131], a[24:27], v[216:219]
    ds_read_b128 a[156:159], v241 offset:17408
    v_cvt_pk_bf16_f32 v239, v190, v191
    v_mfma_f32_16x16x32_bf16 v[192:195], a[128:131], a[40:43], v[192:195]
    v_exp_f32 v174, v174
    v_mfma_f32_16x16x32_bf16 v[200:203], a[128:131], a[56:59], v[200:203]
    v_cvt_pk_bf16_f32 v224, v160, v161
    v_cvt_pk_bf16_f32 v225, v162, v163
    s_waitcnt lgkmcnt(6)
    v_mfma_f32_16x16x32_bf16 v[208:211], a[132:135], a[12:15], v[208:211]
    v_exp_f32 v175, v175
    v_mfma_f32_16x16x32_bf16 v[216:219], a[132:135], a[28:31], v[216:219]
    ds_read_b128 a[128:131], v241 offset:18432
    v_cvt_pk_bf16_f32 v228, v168, v169
    v_mfma_f32_16x16x32_bf16 v[192:195], a[132:135], a[44:47], v[192:195]
    v_cvt_pk_bf16_f32 v229, v170, v171
    v_cvt_pk_bf16_f32 v226, v164, v165
    v_mfma_f32_16x16x32_bf16 v[200:203], a[132:135], a[60:63], v[200:203]
    v_cvt_pk_bf16_f32 v227, v166, v167
    v_cvt_pk_bf16_f32 v230, v172, v173
    s_waitcnt lgkmcnt(6)
    v_mfma_f32_16x16x32_bf16 v[212:215], a[136:139], a[0:3], 0
    v_exp_f32 v208, v208
    v_mfma_f32_16x16x32_bf16 v[220:223], a[136:139], a[16:19], 0
    ds_read_b128 a[132:135], v241 offset:19456
    v_cvt_pk_bf16_f32 v231, v174, v175
    v_mfma_f32_16x16x32_bf16 v[196:199], a[136:139], a[32:35], 0
    v_exp_f32 v209, v209
    v_mfma_f32_16x16x32_bf16 v[204:207], a[136:139], a[48:51], 0
    buffer_load_dwordx4 a[88:91], v243, s[12:15], s63 offen offset:128 nt
    s_waitcnt lgkmcnt(3)
    v_mfma_f32_16x16x32_bf16 v[212:215], a[140:143], a[4:7], v[212:215]
    v_exp_f32 v210, v210
    v_mfma_f32_16x16x32_bf16 v[220:223], a[140:143], a[20:23], v[220:223]
    ds_read_b128 a[136:139], v241 offset:20480
    v_mul_f32_dpp v7, v245, v7 row_newbcast:3 row_mask:0xf bank_mask:0xf
    v_mfma_f32_16x16x32_bf16 v[196:199], a[140:143], a[36:39], v[196:199]
    v_exp_f32 v211, v211
    v_mfma_f32_16x16x32_bf16 v[204:207], a[140:143], a[52:55], v[204:207]
    v_mul_f32_dpp v8, v245, v8 row_newbcast:0 row_mask:0xf bank_mask:0xf
    v_mul_f32_dpp v12, v245, v12 row_newbcast:0 row_mask:0xf bank_mask:0xf
    v_mfma_f32_16x16x32_bf16 v[212:215], a[144:147], a[8:11], v[212:215]
    v_exp_f32 v216, v216
    v_mfma_f32_16x16x32_bf16 v[220:223], a[144:147], a[24:27], v[220:223]
    ds_read_b128 a[140:143], v241 offset:21504
    v_mul_f32_dpp v16, v245, v16 row_newbcast:0 row_mask:0xf bank_mask:0xf
    v_mfma_f32_16x16x32_bf16 v[196:199], a[144:147], a[40:43], v[196:199]
    v_exp_f32 v217, v217
    v_mfma_f32_16x16x32_bf16 v[204:207], a[144:147], a[56:59], v[204:207]
    v_mul_f32_dpp v20, v245, v20 row_newbcast:0 row_mask:0xf bank_mask:0xf
    v_mul_f32_dpp v24, v245, v24 row_newbcast:0 row_mask:0xf bank_mask:0xf
    v_mfma_f32_16x16x32_bf16 v[212:215], a[148:151], a[12:15], v[212:215]
    v_exp_f32 v218, v218
    v_mfma_f32_16x16x32_bf16 v[220:223], a[148:151], a[28:31], v[220:223]
    ds_read_b128 a[144:147], v241 offset:22528
    v_mul_f32_dpp v28, v245, v28 row_newbcast:0 row_mask:0xf bank_mask:0xf
    v_mfma_f32_16x16x32_bf16 v[196:199], a[148:151], a[44:47], v[196:199]
    v_exp_f32 v219, v219
    v_mfma_f32_16x16x32_bf16 v[204:207], a[148:151], a[60:63], v[204:207]
    v_cvt_pk_bf16_f32 v0, v0, v4
    v_cvt_pk_bf16_f32 v4, v1, v5
    v_smfmac_f32_16x16x64_bf16 a[196:199], a[212:215], v[232:239], v247
    v_exp_f32 v192, v192
    v_smfmac_f32_16x16x64_bf16 a[192:195], a[212:215], v[224:231], v247
    buffer_store_dwordx4 v[140:143], v248, s[16:19], s56 offen offset:768 sc0 sc1
    v_cvt_pk_bf16_f32 v1, v8, v12
    v_mfma_f32_16x16x32_bf16 v[32:35], v[232:235], a[152:155], v[32:35]
    v_exp_f32 v193, v193
    v_mfma_f32_16x16x32_bf16 v[64:67], v[236:239], a[152:155], v[64:67]
    ds_read_b128 a[148:151], v241 offset:23552
    v_cvt_pk_bf16_f32 v8, v2, v6
    v_mfma_f32_16x16x32_bf16 v[96:99], v[224:227], a[152:155], v[96:99]
    v_exp_f32 v194, v194
    v_mfma_f32_16x16x32_bf16 v[128:131], v[228:231], a[152:155], 0
    v_cvt_pk_bf16_f32 v12, v3, v7
    s_waitcnt lgkmcnt(3)
    v_mfma_f32_16x16x32_bf16 v[36:39], v[232:235], a[156:159], v[36:39]
    v_exp_f32 v195, v195
    v_mfma_f32_16x16x32_bf16 v[68:71], v[236:239], a[156:159], v[68:71]
    ds_read_b128 a[152:155], v240 offset:32768
    v_cvt_pk_bf16_f32 v2, v16, v20
    v_mfma_f32_16x16x32_bf16 v[100:103], v[224:227], a[156:159], v[100:103]
    v_exp_f32 v200, v200
    v_mfma_f32_16x16x32_bf16 v[132:135], v[228:231], a[156:159], 0
    v_cvt_pk_bf16_f32 v3, v24, v28
    v_mul_f32_dpp v9, v245, v9 row_newbcast:1 row_mask:0xf bank_mask:0xf
    v_mfma_f32_16x16x32_bf16 v[40:43], v[232:235], a[128:131], v[40:43]
    v_exp_f32 v201, v201
    v_mfma_f32_16x16x32_bf16 v[72:75], v[236:239], a[128:131], v[72:75]
    ds_read_b128 a[156:159], v240 offset:33792
    v_mul_f32_dpp v13, v245, v13 row_newbcast:1 row_mask:0xf bank_mask:0xf
    v_mfma_f32_16x16x32_bf16 v[104:107], v[224:227], a[128:131], v[104:107]
    v_exp_f32 v202, v202
    v_mfma_f32_16x16x32_bf16 v[136:139], v[228:231], a[128:131], 0
    v_mul_f32_dpp v17, v245, v17 row_newbcast:1 row_mask:0xf bank_mask:0xf
    v_mul_f32_dpp v21, v245, v21 row_newbcast:1 row_mask:0xf bank_mask:0xf
    v_mfma_f32_16x16x32_bf16 v[44:47], v[232:235], a[132:135], v[44:47]
    v_exp_f32 v203, v203
    v_mfma_f32_16x16x32_bf16 v[76:79], v[236:239], a[132:135], v[76:79]
    ds_read_b128 a[128:131], v240 offset:34816
    v_mul_f32_dpp v25, v245, v25 row_newbcast:1 row_mask:0xf bank_mask:0xf
    v_mfma_f32_16x16x32_bf16 v[108:111], v[224:227], a[132:135], v[108:111]
    v_exp_f32 v212, v212
    v_mfma_f32_16x16x32_bf16 v[140:143], v[228:231], a[132:135], 0
    v_mul_f32_dpp v29, v245, v29 row_newbcast:1 row_mask:0xf bank_mask:0xf
    v_cvt_pk_bf16_f32 v5, v9, v13
    v_mfma_f32_16x16x32_bf16 v[48:51], v[232:235], a[136:139], v[48:51]
    v_exp_f32 v213, v213
    v_mfma_f32_16x16x32_bf16 v[80:83], v[236:239], a[136:139], v[80:83]
    ds_read_b128 a[132:135], v241 offset:24576
    v_cvt_pk_bf16_f32 v6, v17, v21
    v_mfma_f32_16x16x32_bf16 v[112:115], v[224:227], a[136:139], v[112:115]
    v_exp_f32 v214, v214
    v_mfma_f32_16x16x32_bf16 v[144:147], v[228:231], a[136:139], 0
    buffer_load_dwordx4 a[92:95], v243, s[12:15], s63 offen offset:192 nt
    s_waitcnt lgkmcnt(3)
    v_mfma_f32_16x16x32_bf16 v[52:55], v[232:235], a[140:143], v[52:55]
    v_exp_f32 v215, v215
    v_mfma_f32_16x16x32_bf16 v[84:87], v[236:239], a[140:143], v[84:87]
    ds_read_b128 a[136:139], v241 offset:25600
    v_cvt_pk_bf16_f32 v7, v25, v29
    v_mfma_f32_16x16x32_bf16 v[116:119], v[224:227], a[140:143], v[116:119]
    v_exp_f32 v220, v220
    v_mfma_f32_16x16x32_bf16 v[148:151], v[228:231], a[140:143], 0
    v_mul_f32_dpp v10, v245, v10 row_newbcast:2 row_mask:0xf bank_mask:0xf
    v_mul_f32_dpp v11, v245, v11 row_newbcast:3 row_mask:0xf bank_mask:0xf
    v_mfma_f32_16x16x32_bf16 v[56:59], v[232:235], a[144:147], v[56:59]
    v_exp_f32 v221, v221
    v_mfma_f32_16x16x32_bf16 v[88:91], v[236:239], a[144:147], v[88:91]
    ds_read_b128 a[140:143], v241 offset:26624
    buffer_store_dwordx4 v[0:3], v248, s[16:19], s57 offen offset:0 sc0 sc1
    v_mfma_f32_16x16x32_bf16 v[120:123], v[224:227], a[144:147], v[120:123]
    v_exp_f32 v222, v222
    v_mfma_f32_16x16x32_bf16 v[152:155], v[228:231], a[144:147], 0
    v_mul_f32_dpp v14, v245, v14 row_newbcast:2 row_mask:0xf bank_mask:0xf
    v_mul_f32_dpp v15, v245, v15 row_newbcast:3 row_mask:0xf bank_mask:0xf
    v_mfma_f32_16x16x32_bf16 v[60:63], v[232:235], a[148:151], v[60:63]
    v_exp_f32 v223, v223
    v_mfma_f32_16x16x32_bf16 v[92:95], v[236:239], a[148:151], v[92:95]
    ds_read_b128 a[144:147], v241 offset:27648
    v_cvt_pk_bf16_f32 v232, v208, v209
    v_mfma_f32_16x16x32_bf16 v[124:127], v[224:227], a[148:151], v[124:127]
    v_exp_f32 v196, v196
    v_mfma_f32_16x16x32_bf16 v[156:159], v[228:231], a[148:151], 0
    v_cvt_pk_bf16_f32 v233, v210, v211
    s_waitcnt vmcnt(9)
    v_mfma_f32_16x16x32_bf16 v[184:187], a[152:155], a[16:19], 0
    v_exp_f32 v197, v197
    v_mfma_f32_16x16x32_bf16 v[160:163], a[152:155], a[32:35], 0
    ds_read_b128 a[148:151], v241 offset:28672
    v_cvt_pk_bf16_f32 v236, v216, v217
    v_mfma_f32_16x16x32_bf16 v[168:171], a[152:155], a[48:51], 0
    v_exp_f32 v198, v198
    v_mfma_f32_16x16x32_bf16 v[176:179], a[152:155], a[64:67], 0
    v_cvt_pk_bf16_f32 v237, v218, v219
    s_waitcnt lgkmcnt(3)
    v_mfma_f32_16x16x32_bf16 v[184:187], a[156:159], a[20:23], v[184:187]
    v_exp_f32 v199, v199
    v_mfma_f32_16x16x32_bf16 v[160:163], a[156:159], a[36:39], v[160:163]
    ds_read_b128 a[152:155], v241 offset:29696
    v_cvt_pk_bf16_f32 v234, v212, v213
    v_mfma_f32_16x16x32_bf16 v[168:171], a[156:159], a[52:55], v[168:171]
    v_exp_f32 v204, v204
    v_mfma_f32_16x16x32_bf16 v[176:179], a[156:159], a[68:71], v[176:179]
    v_cvt_pk_bf16_f32 v235, v214, v215
    v_cvt_pk_bf16_f32 v238, v220, v221
    v_mfma_f32_16x16x32_bf16 v[184:187], a[128:131], a[24:27], v[184:187]
    v_exp_f32 v205, v205
    v_mfma_f32_16x16x32_bf16 v[160:163], a[128:131], a[40:43], v[160:163]
    ds_read_b128 a[156:159], v241 offset:30720
    v_cvt_pk_bf16_f32 v239, v222, v223
    v_mfma_f32_16x16x32_bf16 v[168:171], a[128:131], a[56:59], v[168:171]
    v_exp_f32 v206, v206
    v_mfma_f32_16x16x32_bf16 v[176:179], a[128:131], a[72:75], v[176:179]
    v_cvt_pk_bf16_f32 v224, v192, v193
    v_cvt_pk_bf16_f32 v225, v194, v195
    v_mfma_f32_16x16x32_bf16 v[184:187], a[252:255], a[28:31], v[184:187]
    v_exp_f32 v207, v207
    v_mfma_f32_16x16x32_bf16 v[160:163], a[252:255], a[44:47], v[160:163]
    v_cvt_pk_bf16_f32 v228, v200, v201
    v_cvt_pk_bf16_f32 v229, v202, v203
    v_mfma_f32_16x16x32_bf16 v[168:171], a[252:255], a[60:63], v[168:171]
    v_cvt_pk_bf16_f32 v226, v196, v197
    v_cvt_pk_bf16_f32 v227, v198, v199
    v_mfma_f32_16x16x32_bf16 v[176:179], a[252:255], a[76:79], v[176:179]
    v_cvt_pk_bf16_f32 v230, v204, v205
    v_cvt_pk_bf16_f32 v231, v206, v207
    v_mfma_f32_16x16x32_bf16 v[188:191], a[248:251], a[16:19], 0
    v_exp_f32 v184, v184
    v_mfma_f32_16x16x32_bf16 v[164:167], a[248:251], a[32:35], 0
    buffer_load_dwordx4 a[0:3], v243, s[12:15], s64 offen offset:0 nt
    v_mul_f32_dpp v18, v245, v18 row_newbcast:2 row_mask:0xf bank_mask:0xf
    v_mfma_f32_16x16x32_bf16 v[172:175], a[248:251], a[48:51], 0
    v_exp_f32 v185, v185
    v_mfma_f32_16x16x32_bf16 v[180:183], a[248:251], a[64:67], 0
    v_mul_f32_dpp v22, v245, v22 row_newbcast:2 row_mask:0xf bank_mask:0xf
    v_mul_f32_dpp v26, v245, v26 row_newbcast:2 row_mask:0xf bank_mask:0xf
    v_mfma_f32_16x16x32_bf16 v[188:191], a[244:247], a[20:23], v[188:191]
    v_exp_f32 v186, v186
    v_mfma_f32_16x16x32_bf16 v[164:167], a[244:247], a[36:39], v[164:167]
    v_mul_f32_dpp v30, v245, v30 row_newbcast:2 row_mask:0xf bank_mask:0xf
    v_cvt_pk_bf16_f32 v9, v10, v14
    v_mfma_f32_16x16x32_bf16 v[172:175], a[244:247], a[52:55], v[172:175]
    v_exp_f32 v187, v187
    v_mfma_f32_16x16x32_bf16 v[180:183], a[244:247], a[68:71], v[180:183]
    v_cvt_pk_bf16_f32 v10, v18, v22
    v_cvt_pk_bf16_f32 v13, v11, v15
    v_mfma_f32_16x16x32_bf16 v[188:191], a[240:243], a[24:27], v[188:191]
    v_exp_f32 v160, v160
    v_mfma_f32_16x16x32_bf16 v[164:167], a[240:243], a[40:43], v[164:167]
    v_cvt_pk_bf16_f32 v11, v26, v30
    v_mul_f32_dpp v19, v245, v19 row_newbcast:3 row_mask:0xf bank_mask:0xf
    v_mfma_f32_16x16x32_bf16 v[172:175], a[240:243], a[56:59], v[172:175]
    v_exp_f32 v161, v161
    v_mfma_f32_16x16x32_bf16 v[180:183], a[240:243], a[72:75], v[180:183]
    v_mul_f32_dpp v23, v245, v23 row_newbcast:3 row_mask:0xf bank_mask:0xf
    v_mul_f32_dpp v27, v245, v27 row_newbcast:3 row_mask:0xf bank_mask:0xf
    v_mfma_f32_16x16x32_bf16 v[188:191], a[236:239], a[28:31], v[188:191]
    v_exp_f32 v162, v162
    v_mfma_f32_16x16x32_bf16 v[164:167], a[236:239], a[44:47], v[164:167]
    buffer_store_dwordx4 v[4:7], v248, s[16:19], s57 offen offset:256 sc0 sc1
    v_mul_f32_dpp v31, v245, v31 row_newbcast:3 row_mask:0xf bank_mask:0xf
    v_mfma_f32_16x16x32_bf16 v[172:175], a[236:239], a[60:63], v[172:175]
    v_exp_f32 v163, v163
    v_mfma_f32_16x16x32_bf16 v[180:183], a[236:239], a[76:79], v[180:183]
    v_cvt_pk_bf16_f32 v14, v19, v23
    v_cvt_pk_bf16_f32 v15, v27, v31
    v_smfmac_f32_16x16x64_bf16 a[196:199], a[212:215], v[232:239], v247
    v_exp_f32 v168, v168
    v_smfmac_f32_16x16x64_bf16 a[192:195], a[212:215], v[224:231], v247
    v_exp_f32 v169, v169
    v_mfma_f32_16x16x32_bf16 v[32:35], v[232:235], a[132:135], v[32:35]
    ds_read_b128 a[128:131], v241 offset:31744
    v_mfma_f32_16x16x32_bf16 v[64:67], v[236:239], a[132:135], v[64:67]
    v_exp_f32 v170, v170
    v_mfma_f32_16x16x32_bf16 v[96:99], v[224:227], a[132:135], v[96:99]
    v_accvgpr_read_b32 v249, a196
    v_accvgpr_read_b32 v251, a197
    v_mfma_f32_16x16x32_bf16 v[128:131], v[228:231], a[132:135], v[128:131]
    v_exp_f32 v171, v171
    v_mfma_f32_16x16x32_bf16 v[36:39], v[232:235], a[136:139], v[36:39]
    ds_read_b128 a[132:135], v240 offset:49152
    v_add_f32 v249, v249, v251
    v_mfma_f32_16x16x32_bf16 v[68:71], v[236:239], a[136:139], v[68:71]
    v_exp_f32 v176, v176
    v_mfma_f32_16x16x32_bf16 v[100:103], v[224:227], a[136:139], v[100:103]
    v_subrev_u32 v246, s48, v249
    v_accvgpr_write_b32 a196, 0
    v_mfma_f32_16x16x32_bf16 v[132:135], v[228:231], a[136:139], v[132:135]
    v_max_u32 v253, v253, v246
    s_waitcnt lgkmcnt(3)
    v_mfma_f32_16x16x32_bf16 v[40:43], v[232:235], a[140:143], v[40:43]
    v_exp_f32 v177, v177
    v_mfma_f32_16x16x32_bf16 v[72:75], v[236:239], a[140:143], v[72:75]
    ds_read_b128 a[136:139], v240 offset:50176
    v_accvgpr_write_b32 a197, 0
    v_mfma_f32_16x16x32_bf16 v[104:107], v[224:227], a[140:143], v[104:107]
    v_exp_f32 v178, v178
    v_mfma_f32_16x16x32_bf16 v[136:139], v[228:231], a[140:143], v[136:139]
    v_rcp_f32 v244, v249
    v_mfma_f32_16x16x32_bf16 v[44:47], v[232:235], a[144:147], v[44:47]
    v_exp_f32 v179, v179
    v_mfma_f32_16x16x32_bf16 v[76:79], v[236:239], a[144:147], v[76:79]
    ds_read_b128 a[140:143], v240 offset:51200
    ds_bpermute_b32 v244, v242, v244
    v_mfma_f32_16x16x32_bf16 v[108:111], v[224:227], a[144:147], v[108:111]
    v_exp_f32 v188, v188
    v_mfma_f32_16x16x32_bf16 v[140:143], v[228:231], a[144:147], v[140:143]
    v_exp_f32 v189, v189
    v_mfma_f32_16x16x32_bf16 v[48:51], v[232:235], a[148:151], v[48:51]
    ds_read_b128 a[144:147], v240 offset:52224
    v_mfma_f32_16x16x32_bf16 v[80:83], v[236:239], a[148:151], v[80:83]
    v_exp_f32 v190, v190
    v_mfma_f32_16x16x32_bf16 v[112:115], v[224:227], a[148:151], v[112:115]
    buffer_load_dwordx4 a[4:7], v243, s[12:15], s64 offen offset:64 nt
    v_mfma_f32_16x16x32_bf16 v[144:147], v[228:231], a[148:151], v[144:147]
    v_exp_f32 v191, v191
    v_mfma_f32_16x16x32_bf16 v[52:55], v[232:235], a[152:155], v[52:55]
    ds_read_b128 a[148:151], v240 offset:53248
    v_mfma_f32_16x16x32_bf16 v[84:87], v[236:239], a[152:155], v[84:87]
    v_exp_f32 v164, v164
    v_mfma_f32_16x16x32_bf16 v[116:119], v[224:227], a[152:155], v[116:119]
    s_waitcnt lgkmcnt(2)
    v_mul_f32_dpp v32, v244, v32 row_newbcast:0 row_mask:0xf bank_mask:0xf
    v_mul_f32_dpp v33, v244, v33 row_newbcast:1 row_mask:0xf bank_mask:0xf
    v_mfma_f32_16x16x32_bf16 v[148:151], v[228:231], a[152:155], v[148:151]
    v_mul_f32_dpp v34, v244, v34 row_newbcast:2 row_mask:0xf bank_mask:0xf
    v_mfma_f32_16x16x32_bf16 v[56:59], v[232:235], a[156:159], v[56:59]
    v_exp_f32 v165, v165
    v_mfma_f32_16x16x32_bf16 v[88:91], v[236:239], a[156:159], v[88:91]
    ds_read_b128 a[152:155], v240 offset:54272
    v_mul_f32_dpp v35, v244, v35 row_newbcast:3 row_mask:0xf bank_mask:0xf
    v_mfma_f32_16x16x32_bf16 v[120:123], v[224:227], a[156:159], v[120:123]
    v_exp_f32 v166, v166
    v_mfma_f32_16x16x32_bf16 v[152:155], v[228:231], a[156:159], v[152:155]
    v_mul_f32_dpp v36, v244, v36 row_newbcast:0 row_mask:0xf bank_mask:0xf
    v_mul_f32_dpp v37, v244, v37 row_newbcast:1 row_mask:0xf bank_mask:0xf
    v_mfma_f32_16x16x32_bf16 v[60:63], v[232:235], a[128:131], v[60:63]
    v_exp_f32 v167, v167
    v_mfma_f32_16x16x32_bf16 v[92:95], v[236:239], a[128:131], v[92:95]
    ds_read_b128 a[156:159], v240 offset:55296
    v_cvt_pk_bf16_f32 v236, v184, v185
    v_mfma_f32_16x16x32_bf16 v[124:127], v[224:227], a[128:131], v[124:127]
    v_exp_f32 v172, v172
    v_mfma_f32_16x16x32_bf16 v[156:159], v[228:231], a[128:131], v[156:159]
    buffer_store_dwordx4 v[8:11], v248, s[16:19], s57 offen offset:512 sc0 sc1
    v_cvt_pk_bf16_f32 v237, v186, v187
    v_mfma_f32_16x16x32_bf16 v[216:219], a[232:235], a[16:19], 0
    v_exp_f32 v173, v173
    v_mfma_f32_16x16x32_bf16 v[192:195], a[232:235], a[32:35], 0
    v_cvt_pk_bf16_f32 v232, v176, v177
    v_cvt_pk_bf16_f32 v233, v178, v179
    v_mfma_f32_16x16x32_bf16 v[200:203], a[232:235], a[48:51], 0
    v_exp_f32 v174, v174
    v_mfma_f32_16x16x32_bf16 v[208:211], a[232:235], a[64:67], 0
    v_cvt_pk_bf16_f32 v238, v188, v189
    v_cvt_pk_bf16_f32 v239, v190, v191
    v_mfma_f32_16x16x32_bf16 v[216:219], a[228:231], a[20:23], v[216:219]
    v_exp_f32 v175, v175
    v_mfma_f32_16x16x32_bf16 v[192:195], a[228:231], a[36:39], v[192:195]
    v_cvt_pk_bf16_f32 v224, v160, v161
    v_cvt_pk_bf16_f32 v225, v162, v163
    v_mfma_f32_16x16x32_bf16 v[200:203], a[228:231], a[52:55], v[200:203]
    v_exp_f32 v180, v180
    v_mfma_f32_16x16x32_bf16 v[208:211], a[228:231], a[68:71], v[208:211]
    v_cvt_pk_bf16_f32 v228, v168, v169
    v_cvt_pk_bf16_f32 v229, v170, v171
    v_mfma_f32_16x16x32_bf16 v[216:219], a[224:227], a[24:27], v[216:219]
    v_exp_f32 v181, v181
    v_mfma_f32_16x16x32_bf16 v[192:195], a[224:227], a[40:43], v[192:195]
    v_cvt_pk_bf16_f32 v234, v180, v181
    v_cvt_pk_bf16_f32 v226, v164, v165
    v_mfma_f32_16x16x32_bf16 v[200:203], a[224:227], a[56:59], v[200:203]
    v_exp_f32 v182, v182
    v_mfma_f32_16x16x32_bf16 v[208:211], a[224:227], a[72:75], v[208:211]
    v_cvt_pk_bf16_f32 v227, v166, v167
    v_cvt_pk_bf16_f32 v230, v172, v173
    v_mfma_f32_16x16x32_bf16 v[216:219], a[220:223], a[28:31], v[216:219]
    v_exp_f32 v183, v183
    v_mfma_f32_16x16x32_bf16 v[192:195], a[220:223], a[44:47], v[192:195]
    v_cvt_pk_bf16_f32 v235, v182, v183
    v_cvt_pk_bf16_f32 v231, v174, v175
    v_mfma_f32_16x16x32_bf16 v[200:203], a[220:223], a[60:63], v[200:203]
    v_mul_f32_dpp v38, v244, v38 row_newbcast:2 row_mask:0xf bank_mask:0xf
    v_mul_f32_dpp v39, v244, v39 row_newbcast:3 row_mask:0xf bank_mask:0xf
    v_mfma_f32_16x16x32_bf16 v[208:211], a[220:223], a[76:79], v[208:211]
    v_mul_f32_dpp v40, v244, v40 row_newbcast:0 row_mask:0xf bank_mask:0xf
    v_mul_f32_dpp v44, v244, v44 row_newbcast:0 row_mask:0xf bank_mask:0xf
    v_mfma_f32_16x16x32_bf16 v[220:223], a[216:219], a[16:19], 0
    v_exp_f32 v216, v216
    v_mfma_f32_16x16x32_bf16 v[196:199], a[216:219], a[32:35], 0
    v_mul_f32_dpp v48, v244, v48 row_newbcast:0 row_mask:0xf bank_mask:0xf
    v_mul_f32_dpp v52, v244, v52 row_newbcast:0 row_mask:0xf bank_mask:0xf
    v_mfma_f32_16x16x32_bf16 v[204:207], a[216:219], a[48:51], 0
    v_exp_f32 v217, v217
    v_mfma_f32_16x16x32_bf16 v[212:215], a[216:219], a[64:67], 0
    buffer_load_dwordx4 a[8:11], v243, s[12:15], s64 offen offset:128 nt
    v_mul_f32_dpp v56, v244, v56 row_newbcast:0 row_mask:0xf bank_mask:0xf
    v_mfma_f32_16x16x32_bf16 v[220:223], a[208:211], a[20:23], v[220:223]
    v_exp_f32 v218, v218
    v_mfma_f32_16x16x32_bf16 v[196:199], a[208:211], a[36:39], v[196:199]
    v_mul_f32_dpp v60, v244, v60 row_newbcast:0 row_mask:0xf bank_mask:0xf
    v_cvt_pk_bf16_f32 v32, v32, v36
    v_mfma_f32_16x16x32_bf16 v[204:207], a[208:211], a[52:55], v[204:207]
    v_exp_f32 v219, v219
    v_mfma_f32_16x16x32_bf16 v[212:215], a[208:211], a[68:71], v[212:215]
    v_cvt_pk_bf16_f32 v36, v33, v37
    v_cvt_pk_bf16_f32 v33, v40, v44
    v_mfma_f32_16x16x32_bf16 v[220:223], a[204:207], a[24:27], v[220:223]
    v_exp_f32 v192, v192
    v_mfma_f32_16x16x32_bf16 v[196:199], a[204:207], a[40:43], v[196:199]
    v_cvt_pk_bf16_f32 v40, v34, v38
    v_cvt_pk_bf16_f32 v44, v35, v39
    v_mfma_f32_16x16x32_bf16 v[204:207], a[204:207], a[56:59], v[204:207]
    v_exp_f32 v193, v193
    v_mfma_f32_16x16x32_bf16 v[212:215], a[204:207], a[72:75], v[212:215]
    v_cvt_pk_bf16_f32 v34, v48, v52
    v_cvt_pk_bf16_f32 v35, v56, v60
    v_mfma_f32_16x16x32_bf16 v[220:223], a[200:203], a[28:31], v[220:223]
    v_exp_f32 v194, v194
    v_mfma_f32_16x16x32_bf16 v[196:199], a[200:203], a[44:47], v[196:199]
    v_mul_f32_dpp v41, v244, v41 row_newbcast:1 row_mask:0xf bank_mask:0xf
    v_mul_f32_dpp v45, v244, v45 row_newbcast:1 row_mask:0xf bank_mask:0xf
    v_mfma_f32_16x16x32_bf16 v[204:207], a[200:203], a[60:63], v[204:207]
    v_exp_f32 v195, v195
    v_mfma_f32_16x16x32_bf16 v[212:215], a[200:203], a[76:79], v[212:215]
    v_mul_f32_dpp v49, v244, v49 row_newbcast:1 row_mask:0xf bank_mask:0xf
    v_mul_f32_dpp v53, v244, v53 row_newbcast:1 row_mask:0xf bank_mask:0xf
    v_smfmac_f32_16x16x64_bf16 a[196:199], a[212:215], v[232:239], v247
    v_exp_f32 v200, v200
    v_smfmac_f32_16x16x64_bf16 a[192:195], a[212:215], v[224:231], v247
    buffer_store_dwordx4 v[12:15], v248, s[16:19], s57 offen offset:768 sc0 sc1
    v_mul_f32_dpp v57, v244, v57 row_newbcast:1 row_mask:0xf bank_mask:0xf
    v_mfma_f32_16x16x32_bf16 v[64:67], v[236:239], a[188:191], v[64:67]
    v_exp_f32 v201, v201
    v_mfma_f32_16x16x32_bf16 v[96:99], v[224:227], a[188:191], v[96:99]
    v_mul_f32_dpp v61, v244, v61 row_newbcast:1 row_mask:0xf bank_mask:0xf
    v_cvt_pk_bf16_f32 v37, v41, v45
    v_mfma_f32_16x16x32_bf16 v[128:131], v[228:231], a[188:191], v[128:131]
    v_exp_f32 v202, v202
    v_mfma_f32_16x16x32_bf16 v[0:3], v[232:235], a[188:191], 0
    v_cvt_pk_bf16_f32 v38, v49, v53
    v_cvt_pk_bf16_f32 v39, v57, v61
    v_mfma_f32_16x16x32_bf16 v[68:71], v[236:239], a[184:187], v[68:71]
    v_exp_f32 v203, v203
    v_mfma_f32_16x16x32_bf16 v[100:103], v[224:227], a[184:187], v[100:103]
    v_mul_f32_dpp v42, v244, v42 row_newbcast:2 row_mask:0xf bank_mask:0xf
    v_mul_f32_dpp v43, v244, v43 row_newbcast:3 row_mask:0xf bank_mask:0xf
    v_mfma_f32_16x16x32_bf16 v[132:135], v[228:231], a[184:187], v[132:135]
    v_exp_f32 v208, v208
    v_mfma_f32_16x16x32_bf16 v[4:7], v[232:235], a[184:187], 0
    v_mul_f32_dpp v46, v244, v46 row_newbcast:2 row_mask:0xf bank_mask:0xf
    v_mul_f32_dpp v47, v244, v47 row_newbcast:3 row_mask:0xf bank_mask:0xf
    v_mfma_f32_16x16x32_bf16 v[72:75], v[236:239], a[180:183], v[72:75]
    v_exp_f32 v209, v209
    v_mfma_f32_16x16x32_bf16 v[104:107], v[224:227], a[180:183], v[104:107]
    v_mul_f32_dpp v50, v244, v50 row_newbcast:2 row_mask:0xf bank_mask:0xf
    v_mul_f32_dpp v54, v244, v54 row_newbcast:2 row_mask:0xf bank_mask:0xf
    v_mfma_f32_16x16x32_bf16 v[136:139], v[228:231], a[180:183], v[136:139]
    v_exp_f32 v210, v210
    v_mfma_f32_16x16x32_bf16 v[8:11], v[232:235], a[180:183], 0
    v_mul_f32_dpp v58, v244, v58 row_newbcast:2 row_mask:0xf bank_mask:0xf
    v_mul_f32_dpp v62, v244, v62 row_newbcast:2 row_mask:0xf bank_mask:0xf
    v_mfma_f32_16x16x32_bf16 v[76:79], v[236:239], a[176:179], v[76:79]
    v_exp_f32 v211, v211
    v_mfma_f32_16x16x32_bf16 v[108:111], v[224:227], a[176:179], v[108:111]
    v_cvt_pk_bf16_f32 v41, v42, v46
    v_cvt_pk_bf16_f32 v42, v50, v54
    v_mfma_f32_16x16x32_bf16 v[140:143], v[228:231], a[176:179], v[140:143]
    v_exp_f32 v220, v220
    v_mfma_f32_16x16x32_bf16 v[12:15], v[232:235], a[176:179], 0
    v_cvt_pk_bf16_f32 v45, v43, v47
    v_cvt_pk_bf16_f32 v43, v58, v62
    v_mfma_f32_16x16x32_bf16 v[80:83], v[236:239], a[172:175], v[80:83]
    v_exp_f32 v221, v221
    v_mfma_f32_16x16x32_bf16 v[112:115], v[224:227], a[172:175], v[112:115]
    v_mul_f32_dpp v51, v244, v51 row_newbcast:3 row_mask:0xf bank_mask:0xf
    v_mul_f32_dpp v55, v244, v55 row_newbcast:3 row_mask:0xf bank_mask:0xf
    v_mfma_f32_16x16x32_bf16 v[144:147], v[228:231], a[172:175], v[144:147]
    v_exp_f32 v222, v222
    v_mfma_f32_16x16x32_bf16 v[16:19], v[232:235], a[172:175], 0
    buffer_load_dwordx4 a[12:15], v243, s[12:15], s64 offen offset:192 nt
    v_mul_f32_dpp v59, v244, v59 row_newbcast:3 row_mask:0xf bank_mask:0xf
    v_mfma_f32_16x16x32_bf16 v[84:87], v[236:239], a[168:171], v[84:87]
    v_exp_f32 v223, v223
    v_mfma_f32_16x16x32_bf16 v[116:119], v[224:227], a[168:171], v[116:119]
    v_mul_f32_dpp v63, v244, v63 row_newbcast:3 row_mask:0xf bank_mask:0xf
    v_cvt_pk_bf16_f32 v46, v51, v55
    v_mfma_f32_16x16x32_bf16 v[148:151], v[228:231], a[168:171], v[148:151]
    v_exp_f32 v196, v196
    v_mfma_f32_16x16x32_bf16 v[20:23], v[232:235], a[168:171], 0
    v_cvt_pk_bf16_f32 v47, v59, v63
    v_mfma_f32_16x16x32_bf16 v[88:91], v[236:239], a[164:167], v[88:91]
    v_exp_f32 v197, v197
    v_mfma_f32_16x16x32_bf16 v[120:123], v[224:227], a[164:167], v[120:123]
    buffer_store_dwordx4 v[32:35], v248, s[16:19], s58 offen offset:0 sc0 sc1
    v_mfma_f32_16x16x32_bf16 v[152:155], v[228:231], a[164:167], v[152:155]
    v_exp_f32 v198, v198
    v_mfma_f32_16x16x32_bf16 v[24:27], v[232:235], a[164:167], 0
    v_exp_f32 v199, v199
    v_mfma_f32_16x16x32_bf16 v[92:95], v[236:239], a[160:163], v[92:95]
    v_cvt_pk_bf16_f32 v236, v216, v217
    v_cvt_pk_bf16_f32 v237, v218, v219
    v_mfma_f32_16x16x32_bf16 v[124:127], v[224:227], a[160:163], v[124:127]
    v_exp_f32 v204, v204
    v_mfma_f32_16x16x32_bf16 v[156:159], v[228:231], a[160:163], v[156:159]
    v_cvt_pk_bf16_f32 v238, v220, v221
    v_cvt_pk_bf16_f32 v239, v222, v223
    v_mfma_f32_16x16x32_bf16 v[28:31], v[232:235], a[160:163], 0
    v_cvt_pk_bf16_f32 v232, v208, v209
    s_waitcnt vmcnt(9)
    v_mfma_f32_16x16x32_bf16 v[160:163], a[132:135], a[32:35], 0
    v_exp_f32 v205, v205
    v_mfma_f32_16x16x32_bf16 v[168:171], a[132:135], a[48:51], 0
    ds_read_b128 a[128:131], v240 offset:56320
    v_cvt_pk_bf16_f32 v233, v210, v211
    v_mfma_f32_16x16x32_bf16 v[176:179], a[132:135], a[64:67], 0
    v_exp_f32 v206, v206
    v_mfma_f32_16x16x32_bf16 v[184:187], a[132:135], a[80:83], 0
    v_cvt_pk_bf16_f32 v224, v192, v193
    v_cvt_pk_bf16_f32 v225, v194, v195
    v_mfma_f32_16x16x32_bf16 v[160:163], a[136:139], a[36:39], v[160:163]
    v_exp_f32 v207, v207
    v_mfma_f32_16x16x32_bf16 v[168:171], a[136:139], a[52:55], v[168:171]
    ds_read_b128 a[132:135], v240 offset:57344
    v_cvt_pk_bf16_f32 v228, v200, v201
    v_mfma_f32_16x16x32_bf16 v[176:179], a[136:139], a[68:71], v[176:179]
    v_exp_f32 v212, v212
    v_mfma_f32_16x16x32_bf16 v[184:187], a[136:139], a[84:87], v[184:187]
    v_cvt_pk_bf16_f32 v229, v202, v203
    v_mfma_f32_16x16x32_bf16 v[160:163], a[140:143], a[40:43], v[160:163]
    v_exp_f32 v213, v213
    v_mfma_f32_16x16x32_bf16 v[168:171], a[140:143], a[56:59], v[168:171]
    ds_read_b128 a[136:139], v240 offset:58368
    v_cvt_pk_bf16_f32 v234, v212, v213
    v_mfma_f32_16x16x32_bf16 v[176:179], a[140:143], a[72:75], v[176:179]
    v_exp_f32 v214, v214
    v_mfma_f32_16x16x32_bf16 v[184:187], a[140:143], a[88:91], v[184:187]
    v_cvt_pk_bf16_f32 v226, v196, v197
    v_cvt_pk_bf16_f32 v227, v198, v199
    s_waitcnt lgkmcnt(6)
    v_mfma_f32_16x16x32_bf16 v[160:163], a[144:147], a[44:47], v[160:163]
    v_exp_f32 v215, v215
    v_mfma_f32_16x16x32_bf16 v[168:171], a[144:147], a[60:63], v[168:171]
    ds_read_b128 a[140:143], v240 offset:59392
    v_cvt_pk_bf16_f32 v235, v214, v215
    v_mfma_f32_16x16x32_bf16 v[176:179], a[144:147], a[76:79], v[176:179]
    v_cvt_pk_bf16_f32 v230, v204, v205
    v_cvt_pk_bf16_f32 v231, v206, v207
    v_mfma_f32_16x16x32_bf16 v[184:187], a[144:147], a[92:95], v[184:187]
    s_waitcnt lgkmcnt(6)
    v_mfma_f32_16x16x32_bf16 v[164:167], a[148:151], a[32:35], 0
    v_exp_f32 v160, v160
    v_mfma_f32_16x16x32_bf16 v[172:175], a[148:151], a[48:51], 0
    ds_read_b128 a[144:147], v240 offset:60416
    buffer_load_dwordx4 a[16:19], v243, s[12:15], s65 offen offset:0 nt
    v_mfma_f32_16x16x32_bf16 v[180:183], a[148:151], a[64:67], 0
    v_exp_f32 v161, v161
    v_mfma_f32_16x16x32_bf16 v[188:191], a[148:151], a[80:83], 0
    v_exp_f32 v162, v162
    s_waitcnt lgkmcnt(6)
    v_mfma_f32_16x16x32_bf16 v[164:167], a[152:155], a[36:39], v[164:167]
    ds_read_b128 a[148:151], v240 offset:61440
    v_mfma_f32_16x16x32_bf16 v[172:175], a[152:155], a[52:55], v[172:175]
    v_exp_f32 v163, v163
    v_mfma_f32_16x16x32_bf16 v[180:183], a[152:155], a[68:71], v[180:183]
    v_exp_f32 v168, v168
    v_mfma_f32_16x16x32_bf16 v[188:191], a[152:155], a[84:87], v[188:191]
    s_waitcnt lgkmcnt(3)
    v_mfma_f32_16x16x32_bf16 v[164:167], a[156:159], a[40:43], v[164:167]
    v_exp_f32 v169, v169
    v_mfma_f32_16x16x32_bf16 v[172:175], a[156:159], a[56:59], v[172:175]
    ds_read_b128 a[152:155], v240 offset:62464
    v_mfma_f32_16x16x32_bf16 v[180:183], a[156:159], a[72:75], v[180:183]
    v_exp_f32 v170, v170
    v_mfma_f32_16x16x32_bf16 v[188:191], a[156:159], a[88:91], v[188:191]
    v_exp_f32 v171, v171
    v_mfma_f32_16x16x32_bf16 v[164:167], a[128:131], a[44:47], v[164:167]
    buffer_store_dwordx4 v[36:39], v248, s[16:19], s58 offen offset:256 sc0 sc1
    ds_read_b128 a[156:159], v240 offset:63488
    v_mfma_f32_16x16x32_bf16 v[172:175], a[128:131], a[60:63], v[172:175]
    v_exp_f32 v176, v176
    v_mfma_f32_16x16x32_bf16 v[180:183], a[128:131], a[76:79], v[180:183]
    v_exp_f32 v177, v177
    v_mfma_f32_16x16x32_bf16 v[188:191], a[128:131], a[92:95], v[188:191]
    v_exp_f32 v178, v178
    v_smfmac_f32_16x16x64_bf16 a[196:199], a[212:215], v[232:239], v247
    v_exp_f32 v179, v179
    v_smfmac_f32_16x16x64_bf16 a[192:195], a[212:215], v[224:231], v247
    v_exp_f32 v184, v184
    v_mfma_f32_16x16x32_bf16 v[64:67], v[236:239], a[124:127], v[64:67]
    v_exp_f32 v185, v185
    v_mfma_f32_16x16x32_bf16 v[96:99], v[224:227], a[124:127], v[96:99]
    v_exp_f32 v186, v186
    v_mfma_f32_16x16x32_bf16 v[128:131], v[228:231], a[124:127], v[128:131]
    v_accvgpr_read_b32 v250, a198
    v_accvgpr_read_b32 v251, a199
    v_mfma_f32_16x16x32_bf16 v[0:3], v[232:235], a[124:127], v[0:3]
    v_exp_f32 v187, v187
    v_mfma_f32_16x16x32_bf16 v[68:71], v[236:239], a[120:123], v[68:71]
    v_add_f32 v250, v250, v251
    v_accvgpr_write_b32 a198, 0
    v_mfma_f32_16x16x32_bf16 v[100:103], v[224:227], a[120:123], v[100:103]
    v_exp_f32 v164, v164
    v_mfma_f32_16x16x32_bf16 v[132:135], v[228:231], a[120:123], v[132:135]
    v_subrev_u32 v246, s48, v250
    v_accvgpr_write_b32 a199, 0
    v_mfma_f32_16x16x32_bf16 v[4:7], v[232:235], a[120:123], v[4:7]
    v_exp_f32 v165, v165
    v_mfma_f32_16x16x32_bf16 v[72:75], v[236:239], a[116:119], v[72:75]
    v_rcp_f32 v245, v250
    v_mfma_f32_16x16x32_bf16 v[104:107], v[224:227], a[116:119], v[104:107]
    v_exp_f32 v166, v166
    v_mfma_f32_16x16x32_bf16 v[136:139], v[228:231], a[116:119], v[136:139]
    v_max_u32 v253, v253, v246
    ds_bpermute_b32 v245, v242, v245
    v_mfma_f32_16x16x32_bf16 v[8:11], v[232:235], a[116:119], v[8:11]
    v_exp_f32 v167, v167
    v_mfma_f32_16x16x32_bf16 v[76:79], v[236:239], a[112:115], v[76:79]
    v_exp_f32 v172, v172
    v_mfma_f32_16x16x32_bf16 v[108:111], v[224:227], a[112:115], v[108:111]
    v_exp_f32 v173, v173
    v_mfma_f32_16x16x32_bf16 v[140:143], v[228:231], a[112:115], v[140:143]
    v_exp_f32 v174, v174
    v_mfma_f32_16x16x32_bf16 v[12:15], v[232:235], a[112:115], v[12:15]
    v_exp_f32 v175, v175
    v_mfma_f32_16x16x32_bf16 v[80:83], v[236:239], a[108:111], v[80:83]
    v_exp_f32 v180, v180
    v_mfma_f32_16x16x32_bf16 v[112:115], v[224:227], a[108:111], v[112:115]
    buffer_load_dwordx4 a[20:23], v243, s[12:15], s65 offen offset:64 nt
    v_mfma_f32_16x16x32_bf16 v[144:147], v[228:231], a[108:111], v[144:147]
    v_exp_f32 v181, v181
    v_mfma_f32_16x16x32_bf16 v[16:19], v[232:235], a[108:111], v[16:19]
    s_waitcnt lgkmcnt(0)
    v_mul_f32_dpp v64, v245, v64 row_newbcast:0 row_mask:0xf bank_mask:0xf
    v_mul_f32_dpp v65, v245, v65 row_newbcast:1 row_mask:0xf bank_mask:0xf
    v_mfma_f32_16x16x32_bf16 v[84:87], v[236:239], a[104:107], v[84:87]
    v_exp_f32 v182, v182
    v_mfma_f32_16x16x32_bf16 v[116:119], v[224:227], a[104:107], v[116:119]
    v_mul_f32_dpp v66, v245, v66 row_newbcast:2 row_mask:0xf bank_mask:0xf
    v_mul_f32_dpp v67, v245, v67 row_newbcast:3 row_mask:0xf bank_mask:0xf
    v_mfma_f32_16x16x32_bf16 v[148:151], v[228:231], a[104:107], v[148:151]
    v_exp_f32 v183, v183
    v_mfma_f32_16x16x32_bf16 v[20:23], v[232:235], a[104:107], v[20:23]
    v_mul_f32_dpp v68, v245, v68 row_newbcast:0 row_mask:0xf bank_mask:0xf
    v_mul_f32_dpp v69, v245, v69 row_newbcast:1 row_mask:0xf bank_mask:0xf
    v_mfma_f32_16x16x32_bf16 v[88:91], v[236:239], a[100:103], v[88:91]
    v_exp_f32 v188, v188
    v_mfma_f32_16x16x32_bf16 v[120:123], v[224:227], a[100:103], v[120:123]
    v_mul_f32_dpp v70, v245, v70 row_newbcast:2 row_mask:0xf bank_mask:0xf
    v_mul_f32_dpp v71, v245, v71 row_newbcast:3 row_mask:0xf bank_mask:0xf
    v_mfma_f32_16x16x32_bf16 v[152:155], v[228:231], a[100:103], v[152:155]
    v_exp_f32 v189, v189
    v_mfma_f32_16x16x32_bf16 v[24:27], v[232:235], a[100:103], v[24:27]
    v_mul_f32_dpp v72, v245, v72 row_newbcast:0 row_mask:0xf bank_mask:0xf
    v_mul_f32_dpp v76, v245, v76 row_newbcast:0 row_mask:0xf bank_mask:0xf
    v_mfma_f32_16x16x32_bf16 v[92:95], v[236:239], a[96:99], v[92:95]
    v_exp_f32 v190, v190
    v_mfma_f32_16x16x32_bf16 v[124:127], v[224:227], a[96:99], v[124:127]
    v_cvt_pk_bf16_f32 v224, v160, v161
    v_cvt_pk_bf16_f32 v225, v162, v163
    v_mfma_f32_16x16x32_bf16 v[156:159], v[228:231], a[96:99], v[156:159]
    v_exp_f32 v191, v191
    v_mfma_f32_16x16x32_bf16 v[28:31], v[232:235], a[96:99], v[28:31]
    buffer_store_dwordx4 v[40:43], v248, s[16:19], s58 offen offset:512 sc0 sc1
    v_cvt_pk_bf16_f32 v228, v168, v169
    v_mfma_f32_16x16x32_bf16 v[192:195], a[132:135], a[32:35], 0
    ds_read_b128 a[128:131], v240 offset:64512
    v_cvt_pk_bf16_f32 v229, v170, v171
    v_mfma_f32_16x16x32_bf16 v[200:203], a[132:135], a[48:51], 0
    v_cvt_pk_bf16_f32 v226, v164, v165
    v_cvt_pk_bf16_f32 v227, v166, v167
    v_mfma_f32_16x16x32_bf16 v[208:211], a[132:135], a[64:67], 0
    v_cvt_pk_bf16_f32 v230, v172, v173
    v_cvt_pk_bf16_f32 v231, v174, v175
    v_mfma_f32_16x16x32_bf16 v[216:219], a[132:135], a[80:83], 0
    v_cvt_pk_bf16_f32 v232, v176, v177
    v_cvt_pk_bf16_f32 v233, v178, v179
    v_mfma_f32_16x16x32_bf16 v[192:195], a[136:139], a[36:39], v[192:195]
    ds_read_b128 a[132:135], v241 offset:49152
    v_cvt_pk_bf16_f32 v236, v184, v185
    v_mfma_f32_16x16x32_bf16 v[200:203], a[136:139], a[52:55], v[200:203]
    v_cvt_pk_bf16_f32 v237, v186, v187
    v_cvt_pk_bf16_f32 v234, v180, v181
    v_mfma_f32_16x16x32_bf16 v[208:211], a[136:139], a[68:71], v[208:211]
    v_cvt_pk_bf16_f32 v235, v182, v183
    v_cvt_pk_bf16_f32 v238, v188, v189
    v_mfma_f32_16x16x32_bf16 v[216:219], a[136:139], a[84:87], v[216:219]
    v_cvt_pk_bf16_f32 v239, v190, v191
    v_mfma_f32_16x16x32_bf16 v[192:195], a[140:143], a[40:43], v[192:195]
    ds_read_b128 a[136:139], v241 offset:50176
    v_mul_f32_dpp v80, v245, v80 row_newbcast:0 row_mask:0xf bank_mask:0xf
    v_mfma_f32_16x16x32_bf16 v[200:203], a[140:143], a[56:59], v[200:203]
    v_mul_f32_dpp v84, v245, v84 row_newbcast:0 row_mask:0xf bank_mask:0xf
    v_mul_f32_dpp v88, v245, v88 row_newbcast:0 row_mask:0xf bank_mask:0xf
    v_mfma_f32_16x16x32_bf16 v[208:211], a[140:143], a[72:75], v[208:211]
    v_mul_f32_dpp v92, v245, v92 row_newbcast:0 row_mask:0xf bank_mask:0xf
    v_cvt_pk_bf16_f32 v64, v64, v68
    v_mfma_f32_16x16x32_bf16 v[216:219], a[140:143], a[88:91], v[216:219]
    v_cvt_pk_bf16_f32 v68, v65, v69
    v_cvt_pk_bf16_f32 v65, v72, v76
    v_mfma_f32_16x16x32_bf16 v[192:195], a[144:147], a[44:47], v[192:195]
    ds_read_b128 a[140:143], v241 offset:51200
    v_cvt_pk_bf16_f32 v72, v66, v70
    v_mfma_f32_16x16x32_bf16 v[200:203], a[144:147], a[60:63], v[200:203]
    v_cvt_pk_bf16_f32 v76, v67, v71
    v_cvt_pk_bf16_f32 v66, v80, v84
    v_mfma_f32_16x16x32_bf16 v[208:211], a[144:147], a[76:79], v[208:211]
    v_cvt_pk_bf16_f32 v67, v88, v92
    v_mul_f32_dpp v73, v245, v73 row_newbcast:1 row_mask:0xf bank_mask:0xf
    v_mfma_f32_16x16x32_bf16 v[216:219], a[144:147], a[92:95], v[216:219]
    v_mul_f32_dpp v77, v245, v77 row_newbcast:1 row_mask:0xf bank_mask:0xf
    v_mul_f32_dpp v81, v245, v81 row_newbcast:1 row_mask:0xf bank_mask:0xf
    v_mfma_f32_16x16x32_bf16 v[196:199], a[148:151], a[32:35], 0
    v_exp_f32 v192, v192
    v_mfma_f32_16x16x32_bf16 v[204:207], a[148:151], a[48:51], 0
    ds_read_b128 a[144:147], v241 offset:52224
    v_mul_f32_dpp v85, v245, v85 row_newbcast:1 row_mask:0xf bank_mask:0xf
    v_mfma_f32_16x16x32_bf16 v[212:215], a[148:151], a[64:67], 0
    v_exp_f32 v193, v193
    v_mfma_f32_16x16x32_bf16 v[220:223], a[148:151], a[80:83], 0
    buffer_load_dwordx4 a[24:27], v243, s[12:15], s65 offen offset:128 nt
    v_mul_f32_dpp v89, v245, v89 row_newbcast:1 row_mask:0xf bank_mask:0xf
    v_mfma_f32_16x16x32_bf16 v[196:199], a[152:155], a[36:39], v[196:199]
    v_exp_f32 v194, v194
    v_mfma_f32_16x16x32_bf16 v[204:207], a[152:155], a[52:55], v[204:207]
    ds_read_b128 a[148:151], v241 offset:53248
    v_mul_f32_dpp v93, v245, v93 row_newbcast:1 row_mask:0xf bank_mask:0xf
    v_mfma_f32_16x16x32_bf16 v[212:215], a[152:155], a[68:71], v[212:215]
    v_exp_f32 v195, v195
    v_mfma_f32_16x16x32_bf16 v[220:223], a[152:155], a[84:87], v[220:223]
    v_cvt_pk_bf16_f32 v69, v73, v77
    v_mfma_f32_16x16x32_bf16 v[196:199], a[156:159], a[40:43], v[196:199]
    v_exp_f32 v200, v200
    v_mfma_f32_16x16x32_bf16 v[204:207], a[156:159], a[56:59], v[204:207]
    ds_read_b128 a[152:155], v241 offset:54272
    v_cvt_pk_bf16_f32 v70, v81, v85
    v_mfma_f32_16x16x32_bf16 v[212:215], a[156:159], a[72:75], v[212:215]
    v_exp_f32 v201, v201
    v_mfma_f32_16x16x32_bf16 v[220:223], a[156:159], a[88:91], v[220:223]
    v_cvt_pk_bf16_f32 v71, v89, v93
    v_mul_f32_dpp v74, v245, v74 row_newbcast:2 row_mask:0xf bank_mask:0xf
    s_waitcnt lgkmcnt(6)
    v_mfma_f32_16x16x32_bf16 v[196:199], a[128:131], a[44:47], v[196:199]
    v_exp_f32 v202, v202
    v_mfma_f32_16x16x32_bf16 v[204:207], a[128:131], a[60:63], v[204:207]
    ds_read_b128 a[156:159], v241 offset:55296
    v_mul_f32_dpp v75, v245, v75 row_newbcast:3 row_mask:0xf bank_mask:0xf
    v_mfma_f32_16x16x32_bf16 v[212:215], a[128:131], a[76:79], v[212:215]
    v_exp_f32 v203, v203
    v_mfma_f32_16x16x32_bf16 v[220:223], a[128:131], a[92:95], v[220:223]
    v_mul_f32_dpp v78, v245, v78 row_newbcast:2 row_mask:0xf bank_mask:0xf
    v_mul_f32_dpp v79, v245, v79 row_newbcast:3 row_mask:0xf bank_mask:0xf
    v_smfmac_f32_16x16x64_bf16 a[192:195], a[212:215], v[224:231], v247
    v_exp_f32 v208, v208
    v_smfmac_f32_16x16x64_bf16 a[196:199], a[212:215], v[232:239], v247
    buffer_store_dwordx4 v[44:47], v248, s[16:19], s58 offen offset:768 sc0 sc1
    v_mul_f32_dpp v82, v245, v82 row_newbcast:2 row_mask:0xf bank_mask:0xf
    s_waitcnt lgkmcnt(6)
    v_mfma_f32_16x16x32_bf16 v[96:99], v[224:227], a[132:135], v[96:99]
    v_exp_f32 v209, v209
    v_mfma_f32_16x16x32_bf16 v[128:131], v[228:231], a[132:135], v[128:131]
    ds_read_b128 a[128:131], v241 offset:56320
    v_mul_f32_dpp v86, v245, v86 row_newbcast:2 row_mask:0xf bank_mask:0xf
    v_mfma_f32_16x16x32_bf16 v[0:3], v[232:235], a[132:135], v[0:3]
    v_exp_f32 v210, v210
    v_mfma_f32_16x16x32_bf16 v[32:35], v[236:239], a[132:135], 0
    v_mul_f32_dpp v90, v245, v90 row_newbcast:2 row_mask:0xf bank_mask:0xf
    v_mul_f32_dpp v94, v245, v94 row_newbcast:2 row_mask:0xf bank_mask:0xf
    s_waitcnt lgkmcnt(6)
    v_mfma_f32_16x16x32_bf16 v[100:103], v[224:227], a[136:139], v[100:103]
    v_exp_f32 v211, v211
    v_mfma_f32_16x16x32_bf16 v[132:135], v[228:231], a[136:139], v[132:135]
    ds_read_b128 a[132:135], v240 offset:0
    v_cvt_pk_bf16_f32 v73, v74, v78
    v_mfma_f32_16x16x32_bf16 v[4:7], v[232:235], a[136:139], v[4:7]
    v_exp_f32 v216, v216
    v_mfma_f32_16x16x32_bf16 v[36:39], v[236:239], a[136:139], 0
    v_cvt_pk_bf16_f32 v74, v82, v86
    s_waitcnt lgkmcnt(3)
    v_mfma_f32_16x16x32_bf16 v[104:107], v[224:227], a[140:143], v[104:107]
    v_exp_f32 v217, v217
    v_mfma_f32_16x16x32_bf16 v[136:139], v[228:231], a[140:143], v[136:139]
    ds_read_b128 a[136:139], v240 offset:1024
    v_cvt_pk_bf16_f32 v77, v75, v79
    v_mfma_f32_16x16x32_bf16 v[8:11], v[232:235], a[140:143], v[8:11]
    v_exp_f32 v218, v218
    v_mfma_f32_16x16x32_bf16 v[40:43], v[236:239], a[140:143], 0
    v_cvt_pk_bf16_f32 v75, v90, v94
    v_mul_f32_dpp v83, v245, v83 row_newbcast:3 row_mask:0xf bank_mask:0xf
    v_mfma_f32_16x16x32_bf16 v[108:111], v[224:227], a[144:147], v[108:111]
    v_exp_f32 v219, v219
    v_mfma_f32_16x16x32_bf16 v[140:143], v[228:231], a[144:147], v[140:143]
    ds_read_b128 a[140:143], v240 offset:2048
    v_mul_f32_dpp v87, v245, v87 row_newbcast:3 row_mask:0xf bank_mask:0xf
    v_mfma_f32_16x16x32_bf16 v[12:15], v[232:235], a[144:147], v[12:15]
    v_exp_f32 v196, v196
    v_mfma_f32_16x16x32_bf16 v[44:47], v[236:239], a[144:147], 0
    v_mul_f32_dpp v91, v245, v91 row_newbcast:3 row_mask:0xf bank_mask:0xf
    v_mul_f32_dpp v95, v245, v95 row_newbcast:3 row_mask:0xf bank_mask:0xf
    v_mfma_f32_16x16x32_bf16 v[112:115], v[224:227], a[148:151], v[112:115]
    v_exp_f32 v197, v197
    v_mfma_f32_16x16x32_bf16 v[144:147], v[228:231], a[148:151], v[144:147]
    ds_read_b128 a[144:147], v240 offset:3072
    v_cvt_pk_bf16_f32 v78, v83, v87
    v_mfma_f32_16x16x32_bf16 v[16:19], v[232:235], a[148:151], v[16:19]
    v_exp_f32 v198, v198
    v_mfma_f32_16x16x32_bf16 v[48:51], v[236:239], a[148:151], 0
    buffer_load_dwordx4 a[28:31], v243, s[12:15], s65 offen offset:192 nt
    v_cvt_pk_bf16_f32 v79, v91, v95
    v_mfma_f32_16x16x32_bf16 v[116:119], v[224:227], a[152:155], v[116:119]
    v_exp_f32 v199, v199
    v_mfma_f32_16x16x32_bf16 v[148:151], v[228:231], a[152:155], v[148:151]
    ds_read_b128 a[148:151], v240 offset:4096
    v_mfma_f32_16x16x32_bf16 v[20:23], v[232:235], a[152:155], v[20:23]
    v_exp_f32 v204, v204
    v_mfma_f32_16x16x32_bf16 v[52:55], v[236:239], a[152:155], 0
    s_waitcnt lgkmcnt(3)
    v_mfma_f32_16x16x32_bf16 v[120:123], v[224:227], a[156:159], v[120:123]
    v_exp_f32 v205, v205
    v_mfma_f32_16x16x32_bf16 v[152:155], v[228:231], a[156:159], v[152:155]
    ds_read_b128 a[152:155], v240 offset:5120
    buffer_store_dwordx4 v[64:67], v248, s[16:19], s59 offen offset:0 sc0 sc1
    v_mfma_f32_16x16x32_bf16 v[24:27], v[232:235], a[156:159], v[24:27]
    v_exp_f32 v206, v206
    v_mfma_f32_16x16x32_bf16 v[56:59], v[236:239], a[156:159], 0
    v_exp_f32 v207, v207
    v_mfma_f32_16x16x32_bf16 v[124:127], v[224:227], a[128:131], v[124:127]
    ds_read_b128 a[156:159], v240 offset:6144
    v_cvt_pk_bf16_f32 v224, v192, v193
    v_mfma_f32_16x16x32_bf16 v[156:159], v[228:231], a[128:131], v[156:159]
    v_exp_f32 v212, v212
    v_mfma_f32_16x16x32_bf16 v[28:31], v[232:235], a[128:131], v[28:31]
    v_cvt_pk_bf16_f32 v225, v194, v195
    v_cvt_pk_bf16_f32 v228, v200, v201
    v_mfma_f32_16x16x32_bf16 v[60:63], v[236:239], a[128:131], 0
    v_cvt_pk_bf16_f32 v229, v202, v203
    s_waitcnt vmcnt(9)
    v_mfma_f32_16x16x32_bf16 v[168:171], a[132:135], a[48:51], 0
    v_exp_f32 v213, v213
    v_mfma_f32_16x16x32_bf16 v[176:179], a[132:135], a[64:67], 0
    ds_read_b128 a[128:131], v240 offset:7168
    v_cvt_pk_bf16_f32 v226, v196, v197
    v_mfma_f32_16x16x32_bf16 v[184:187], a[132:135], a[80:83], 0
    v_exp_f32 v214, v214
    v_mfma_f32_16x16x32_bf16 v[160:163], a[132:135], a[0:3], 0
    v_cvt_pk_bf16_f32 v227, v198, v199
    v_cvt_pk_bf16_f32 v230, v204, v205
    v_mfma_f32_16x16x32_bf16 v[168:171], a[136:139], a[52:55], v[168:171]
    v_exp_f32 v215, v215
    v_mfma_f32_16x16x32_bf16 v[176:179], a[136:139], a[68:71], v[176:179]
    ds_read_b128 a[132:135], v241 offset:57344
    v_cvt_pk_bf16_f32 v231, v206, v207
    v_mfma_f32_16x16x32_bf16 v[184:187], a[136:139], a[84:87], v[184:187]
    v_exp_f32 v220, v220
    v_mfma_f32_16x16x32_bf16 v[160:163], a[136:139], a[4:7], v[160:163]
    v_cvt_pk_bf16_f32 v232, v208, v209
    s_waitcnt lgkmcnt(3)
    v_mfma_f32_16x16x32_bf16 v[168:171], a[140:143], a[56:59], v[168:171]
    v_exp_f32 v221, v221
    v_mfma_f32_16x16x32_bf16 v[176:179], a[140:143], a[72:75], v[176:179]
    ds_read_b128 a[136:139], v241 offset:58368
    v_cvt_pk_bf16_f32 v233, v210, v211
    v_mfma_f32_16x16x32_bf16 v[184:187], a[140:143], a[88:91], v[184:187]
    v_exp_f32 v222, v222
    v_mfma_f32_16x16x32_bf16 v[160:163], a[140:143], a[8:11], v[160:163]
    v_cvt_pk_bf16_f32 v236, v216, v217
    v_cvt_pk_bf16_f32 v237, v218, v219
    v_mfma_f32_16x16x32_bf16 v[168:171], a[144:147], a[60:63], v[168:171]
    v_exp_f32 v223, v223
    v_mfma_f32_16x16x32_bf16 v[176:179], a[144:147], a[76:79], v[176:179]
    ds_read_b128 a[140:143], v241 offset:59392
    v_cvt_pk_bf16_f32 v234, v212, v213
    v_mfma_f32_16x16x32_bf16 v[184:187], a[144:147], a[92:95], v[184:187]
    v_cvt_pk_bf16_f32 v235, v214, v215
    v_cvt_pk_bf16_f32 v238, v220, v221
    v_mfma_f32_16x16x32_bf16 v[160:163], a[144:147], a[12:15], v[160:163]
    v_cvt_pk_bf16_f32 v239, v222, v223
    v_mfma_f32_16x16x32_bf16 v[172:175], a[148:151], a[48:51], 0
    v_exp_f32 v168, v168
    v_mfma_f32_16x16x32_bf16 v[180:183], a[148:151], a[64:67], 0
    ds_read_b128 a[144:147], v241 offset:60416
    buffer_load_dwordx4 a[32:35], v243, s[12:15], s66 offen offset:0 nt
    v_mfma_f32_16x16x32_bf16 v[188:191], a[148:151], a[80:83], 0
    v_exp_f32 v169, v169
    v_mfma_f32_16x16x32_bf16 v[164:167], a[148:151], a[0:3], 0
    v_exp_f32 v170, v170
    v_mfma_f32_16x16x32_bf16 v[172:175], a[152:155], a[52:55], v[172:175]
    ds_read_b128 a[148:151], v241 offset:61440
    v_mfma_f32_16x16x32_bf16 v[180:183], a[152:155], a[68:71], v[180:183]
    v_exp_f32 v171, v171
    v_mfma_f32_16x16x32_bf16 v[188:191], a[152:155], a[84:87], v[188:191]
    v_exp_f32 v176, v176
    v_mfma_f32_16x16x32_bf16 v[164:167], a[152:155], a[4:7], v[164:167]
    s_waitcnt lgkmcnt(3)
    v_mfma_f32_16x16x32_bf16 v[172:175], a[156:159], a[56:59], v[172:175]
    v_exp_f32 v177, v177
    v_mfma_f32_16x16x32_bf16 v[180:183], a[156:159], a[72:75], v[180:183]
    ds_read_b128 a[152:155], v241 offset:62464
    v_mfma_f32_16x16x32_bf16 v[188:191], a[156:159], a[88:91], v[188:191]
    v_exp_f32 v178, v178
    v_mfma_f32_16x16x32_bf16 v[164:167], a[156:159], a[8:11], v[164:167]
    v_exp_f32 v179, v179
    v_mfma_f32_16x16x32_bf16 v[172:175], a[128:131], a[60:63], v[172:175]
    buffer_store_dwordx4 v[68:71], v248, s[16:19], s59 offen offset:256 sc0 sc1
    ds_read_b128 a[156:159], v241 offset:63488
    v_mfma_f32_16x16x32_bf16 v[180:183], a[128:131], a[76:79], v[180:183]
    v_exp_f32 v184, v184
    v_mfma_f32_16x16x32_bf16 v[188:191], a[128:131], a[92:95], v[188:191]
    v_exp_f32 v185, v185
    v_mfma_f32_16x16x32_bf16 v[164:167], a[128:131], a[12:15], v[164:167]
    v_exp_f32 v186, v186
    v_smfmac_f32_16x16x64_bf16 a[192:195], a[212:215], v[224:231], v247
    v_exp_f32 v187, v187
    v_smfmac_f32_16x16x64_bf16 a[196:199], a[212:215], v[232:239], v247
    v_exp_f32 v160, v160
    v_mfma_f32_16x16x32_bf16 v[96:99], v[224:227], a[132:135], v[96:99]
    ds_read_b128 a[128:131], v241 offset:64512
    v_mfma_f32_16x16x32_bf16 v[128:131], v[228:231], a[132:135], v[128:131]
    v_exp_f32 v161, v161
    v_mfma_f32_16x16x32_bf16 v[0:3], v[232:235], a[132:135], v[0:3]
    v_accvgpr_read_b32 v249, a192
    v_accvgpr_read_b32 v251, a193
    v_mfma_f32_16x16x32_bf16 v[32:35], v[236:239], a[132:135], v[32:35]
    v_exp_f32 v162, v162
    v_mfma_f32_16x16x32_bf16 v[100:103], v[224:227], a[136:139], v[100:103]
    ds_read_b128 a[132:135], v240 offset:8192
    v_add_f32 v249, v249, v251
    v_mfma_f32_16x16x32_bf16 v[132:135], v[228:231], a[136:139], v[132:135]
    v_exp_f32 v163, v163
    v_mfma_f32_16x16x32_bf16 v[4:7], v[232:235], a[136:139], v[4:7]
    v_subrev_u32 v246, s48, v249
    v_accvgpr_write_b32 a192, 0
    v_mfma_f32_16x16x32_bf16 v[36:39], v[236:239], a[136:139], v[36:39]
    v_max_u32 v253, v253, v246
    s_waitcnt lgkmcnt(3)
    v_mfma_f32_16x16x32_bf16 v[104:107], v[224:227], a[140:143], v[104:107]
    v_exp_f32 v172, v172
    v_mfma_f32_16x16x32_bf16 v[136:139], v[228:231], a[140:143], v[136:139]
    ds_read_b128 a[136:139], v240 offset:9216
    v_accvgpr_write_b32 a193, 0
    v_mfma_f32_16x16x32_bf16 v[8:11], v[232:235], a[140:143], v[8:11]
    v_exp_f32 v173, v173
    v_mfma_f32_16x16x32_bf16 v[40:43], v[236:239], a[140:143], v[40:43]
    v_rcp_f32 v244, v249
    v_mfma_f32_16x16x32_bf16 v[108:111], v[224:227], a[144:147], v[108:111]
    v_exp_f32 v174, v174
    v_mfma_f32_16x16x32_bf16 v[140:143], v[228:231], a[144:147], v[140:143]
    ds_read_b128 a[140:143], v240 offset:10240
    ds_bpermute_b32 v244, v242, v244
    v_mfma_f32_16x16x32_bf16 v[12:15], v[232:235], a[144:147], v[12:15]
    v_exp_f32 v175, v175
    v_mfma_f32_16x16x32_bf16 v[44:47], v[236:239], a[144:147], v[44:47]
    v_exp_f32 v180, v180
    v_mfma_f32_16x16x32_bf16 v[112:115], v[224:227], a[148:151], v[112:115]
    ds_read_b128 a[144:147], v240 offset:11264
    v_mfma_f32_16x16x32_bf16 v[144:147], v[228:231], a[148:151], v[144:147]
    v_exp_f32 v181, v181
    v_mfma_f32_16x16x32_bf16 v[16:19], v[232:235], a[148:151], v[16:19]
    buffer_load_dwordx4 a[36:39], v243, s[12:15], s66 offen offset:64 nt
    v_mfma_f32_16x16x32_bf16 v[48:51], v[236:239], a[148:151], v[48:51]
    v_exp_f32 v182, v182
    v_mfma_f32_16x16x32_bf16 v[116:119], v[224:227], a[152:155], v[116:119]
    ds_read_b128 a[148:151], v240 offset:12288
    v_mfma_f32_16x16x32_bf16 v[148:151], v[228:231], a[152:155], v[148:151]
    v_exp_f32 v183, v183
    v_mfma_f32_16x16x32_bf16 v[20:23], v[232:235], a[152:155], v[20:23]
    s_waitcnt lgkmcnt(2)
    v_mul_f32_dpp v96, v244, v96 row_newbcast:0 row_mask:0xf bank_mask:0xf
    v_mul_f32_dpp v97, v244, v97 row_newbcast:1 row_mask:0xf bank_mask:0xf
    v_mfma_f32_16x16x32_bf16 v[52:55], v[236:239], a[152:155], v[52:55]
    v_mul_f32_dpp v98, v244, v98 row_newbcast:2 row_mask:0xf bank_mask:0xf
    v_mfma_f32_16x16x32_bf16 v[120:123], v[224:227], a[156:159], v[120:123]
    v_exp_f32 v188, v188
    v_mfma_f32_16x16x32_bf16 v[152:155], v[228:231], a[156:159], v[152:155]
    ds_read_b128 a[152:155], v240 offset:13312
    v_mul_f32_dpp v99, v244, v99 row_newbcast:3 row_mask:0xf bank_mask:0xf
    v_mfma_f32_16x16x32_bf16 v[24:27], v[232:235], a[156:159], v[24:27]
    v_exp_f32 v189, v189
    v_mfma_f32_16x16x32_bf16 v[56:59], v[236:239], a[156:159], v[56:59]
    v_mul_f32_dpp v100, v244, v100 row_newbcast:0 row_mask:0xf bank_mask:0xf
    v_mul_f32_dpp v101, v244, v101 row_newbcast:1 row_mask:0xf bank_mask:0xf
    v_mfma_f32_16x16x32_bf16 v[124:127], v[224:227], a[128:131], v[124:127]
    v_exp_f32 v190, v190
    v_mfma_f32_16x16x32_bf16 v[156:159], v[228:231], a[128:131], v[156:159]
    ds_read_b128 a[156:159], v240 offset:14336
    v_cvt_pk_bf16_f32 v228, v168, v169
    v_mfma_f32_16x16x32_bf16 v[28:31], v[232:235], a[128:131], v[28:31]
    v_exp_f32 v191, v191
    v_mfma_f32_16x16x32_bf16 v[60:63], v[236:239], a[128:131], v[60:63]
    buffer_store_dwordx4 v[72:75], v248, s[16:19], s59 offen offset:512 sc0 sc1
    v_cvt_pk_bf16_f32 v229, v170, v171
    v_mfma_f32_16x16x32_bf16 v[200:203], a[132:135], a[48:51], 0
    v_exp_f32 v164, v164
    v_mfma_f32_16x16x32_bf16 v[208:211], a[132:135], a[64:67], 0
    ds_read_b128 a[128:131], v240 offset:15360
    v_cvt_pk_bf16_f32 v224, v160, v161
    v_mfma_f32_16x16x32_bf16 v[216:219], a[132:135], a[80:83], 0
    v_exp_f32 v165, v165
    v_mfma_f32_16x16x32_bf16 v[192:195], a[132:135], a[0:3], 0
    v_cvt_pk_bf16_f32 v225, v162, v163
    v_cvt_pk_bf16_f32 v230, v172, v173
    v_mfma_f32_16x16x32_bf16 v[200:203], a[136:139], a[52:55], v[200:203]
    v_exp_f32 v166, v166
    v_mfma_f32_16x16x32_bf16 v[208:211], a[136:139], a[68:71], v[208:211]
    ds_read_b128 a[132:135], v241 offset:0
    v_cvt_pk_bf16_f32 v231, v174, v175
    v_mfma_f32_16x16x32_bf16 v[216:219], a[136:139], a[84:87], v[216:219]
    v_exp_f32 v167, v167
    v_mfma_f32_16x16x32_bf16 v[192:195], a[136:139], a[4:7], v[192:195]
    v_cvt_pk_bf16_f32 v226, v164, v165
    v_mfma_f32_16x16x32_bf16 v[200:203], a[140:143], a[56:59], v[200:203]
    ds_read_b128 a[136:139], v241 offset:1024
    v_cvt_pk_bf16_f32 v227, v166, v167
    v_mfma_f32_16x16x32_bf16 v[208:211], a[140:143], a[72:75], v[208:211]
    v_cvt_pk_bf16_f32 v232, v176, v177
    v_cvt_pk_bf16_f32 v233, v178, v179
    v_mfma_f32_16x16x32_bf16 v[216:219], a[140:143], a[88:91], v[216:219]
    v_cvt_pk_bf16_f32 v236, v184, v185
    v_cvt_pk_bf16_f32 v237, v186, v187
    v_mfma_f32_16x16x32_bf16 v[192:195], a[140:143], a[8:11], v[192:195]
    v_cvt_pk_bf16_f32 v234, v180, v181
    v_cvt_pk_bf16_f32 v235, v182, v183
    s_waitcnt lgkmcnt(6)
    v_mfma_f32_16x16x32_bf16 v[200:203], a[144:147], a[60:63], v[200:203]
    ds_read_b128 a[140:143], v241 offset:2048
    v_cvt_pk_bf16_f32 v238, v188, v189
    v_mfma_f32_16x16x32_bf16 v[208:211], a[144:147], a[76:79], v[208:211]
    v_cvt_pk_bf16_f32 v239, v190, v191
    v_mul_f32_dpp v102, v244, v102 row_newbcast:2 row_mask:0xf bank_mask:0xf
    v_mfma_f32_16x16x32_bf16 v[216:219], a[144:147], a[92:95], v[216:219]
    v_mul_f32_dpp v103, v244, v103 row_newbcast:3 row_mask:0xf bank_mask:0xf
    v_mul_f32_dpp v104, v244, v104 row_newbcast:0 row_mask:0xf bank_mask:0xf
    v_mfma_f32_16x16x32_bf16 v[192:195], a[144:147], a[12:15], v[192:195]
    v_mul_f32_dpp v108, v244, v108 row_newbcast:0 row_mask:0xf bank_mask:0xf
    v_mul_f32_dpp v112, v244, v112 row_newbcast:0 row_mask:0xf bank_mask:0xf
    s_waitcnt lgkmcnt(6)
    v_mfma_f32_16x16x32_bf16 v[204:207], a[148:151], a[48:51], 0
    v_exp_f32 v200, v200
    v_mfma_f32_16x16x32_bf16 v[212:215], a[148:151], a[64:67], 0
    ds_read_b128 a[144:147], v241 offset:3072
    v_mul_f32_dpp v116, v244, v116 row_newbcast:0 row_mask:0xf bank_mask:0xf
    v_mfma_f32_16x16x32_bf16 v[220:223], a[148:151], a[80:83], 0
    v_exp_f32 v201, v201
    v_mfma_f32_16x16x32_bf16 v[196:199], a[148:151], a[0:3], 0
    buffer_load_dwordx4 a[40:43], v243, s[12:15], s66 offen offset:128 nt
    v_mul_f32_dpp v120, v244, v120 row_newbcast:0 row_mask:0xf bank_mask:0xf
    s_waitcnt lgkmcnt(6)
    v_mfma_f32_16x16x32_bf16 v[204:207], a[152:155], a[52:55], v[204:207]
    v_exp_f32 v202, v202
    v_mfma_f32_16x16x32_bf16 v[212:215], a[152:155], a[68:71], v[212:215]
    ds_read_b128 a[148:151], v241 offset:4096
    v_mul_f32_dpp v124, v244, v124 row_newbcast:0 row_mask:0xf bank_mask:0xf
    v_mfma_f32_16x16x32_bf16 v[220:223], a[152:155], a[84:87], v[220:223]
    v_exp_f32 v203, v203
    v_mfma_f32_16x16x32_bf16 v[196:199], a[152:155], a[4:7], v[196:199]
    v_cvt_pk_bf16_f32 v96, v96, v100
    s_waitcnt lgkmcnt(3)
    v_mfma_f32_16x16x32_bf16 v[204:207], a[156:159], a[56:59], v[204:207]
    v_exp_f32 v208, v208
    v_mfma_f32_16x16x32_bf16 v[212:215], a[156:159], a[72:75], v[212:215]
    ds_read_b128 a[152:155], v241 offset:5120
    v_cvt_pk_bf16_f32 v100, v97, v101
    v_mfma_f32_16x16x32_bf16 v[220:223], a[156:159], a[88:91], v[220:223]
    v_exp_f32 v209, v209
    v_mfma_f32_16x16x32_bf16 v[196:199], a[156:159], a[8:11], v[196:199]
    v_cvt_pk_bf16_f32 v97, v104, v108
    v_cvt_pk_bf16_f32 v104, v98, v102
    v_mfma_f32_16x16x32_bf16 v[204:207], a[128:131], a[60:63], v[204:207]
    v_exp_f32 v210, v210
    v_mfma_f32_16x16x32_bf16 v[212:215], a[128:131], a[76:79], v[212:215]
    ds_read_b128 a[156:159], v241 offset:6144
    v_cvt_pk_bf16_f32 v108, v99, v103
    v_mfma_f32_16x16x32_bf16 v[220:223], a[128:131], a[92:95], v[220:223]
    v_exp_f32 v211, v211
    v_mfma_f32_16x16x32_bf16 v[196:199], a[128:131], a[12:15], v[196:199]
    v_cvt_pk_bf16_f32 v98, v112, v116
    v_cvt_pk_bf16_f32 v99, v120, v124
    v_smfmac_f32_16x16x64_bf16 a[192:195], a[212:215], v[224:231], v247
    v_exp_f32 v216, v216
    v_smfmac_f32_16x16x64_bf16 a[196:199], a[212:215], v[232:239], v247
    buffer_store_dwordx4 v[76:79], v248, s[16:19], s59 offen offset:768 sc0 sc1
    v_mul_f32_dpp v105, v244, v105 row_newbcast:1 row_mask:0xf bank_mask:0xf
    v_mfma_f32_16x16x32_bf16 v[128:131], v[228:231], a[132:135], v[128:131]
    v_exp_f32 v217, v217
    v_mfma_f32_16x16x32_bf16 v[0:3], v[232:235], a[132:135], v[0:3]
    ds_read_b128 a[128:131], v241 offset:7168
    v_mul_f32_dpp v109, v244, v109 row_newbcast:1 row_mask:0xf bank_mask:0xf
    v_mfma_f32_16x16x32_bf16 v[32:35], v[236:239], a[132:135], v[32:35]
    v_exp_f32 v218, v218
    v_mfma_f32_16x16x32_bf16 v[64:67], v[224:227], a[132:135], 0
    v_mul_f32_dpp v113, v244, v113 row_newbcast:1 row_mask:0xf bank_mask:0xf
    v_mul_f32_dpp v117, v244, v117 row_newbcast:1 row_mask:0xf bank_mask:0xf
    v_mfma_f32_16x16x32_bf16 v[132:135], v[228:231], a[136:139], v[132:135]
    v_exp_f32 v219, v219
    v_mfma_f32_16x16x32_bf16 v[4:7], v[232:235], a[136:139], v[4:7]
    ds_read_b128 a[132:135], v240 offset:16384
    v_mul_f32_dpp v121, v244, v121 row_newbcast:1 row_mask:0xf bank_mask:0xf
    v_mfma_f32_16x16x32_bf16 v[36:39], v[236:239], a[136:139], v[36:39]
    v_exp_f32 v192, v192
    v_mfma_f32_16x16x32_bf16 v[68:71], v[224:227], a[136:139], 0
    v_mul_f32_dpp v125, v244, v125 row_newbcast:1 row_mask:0xf bank_mask:0xf
    s_waitcnt lgkmcnt(3)
    v_mfma_f32_16x16x32_bf16 v[136:139], v[228:231], a[140:143], v[136:139]
    v_exp_f32 v193, v193
    v_mfma_f32_16x16x32_bf16 v[8:11], v[232:235], a[140:143], v[8:11]
    ds_read_b128 a[136:139], v240 offset:17408
    v_cvt_pk_bf16_f32 v101, v105, v109
    v_mfma_f32_16x16x32_bf16 v[40:43], v[236:239], a[140:143], v[40:43]
    v_exp_f32 v194, v194
    v_mfma_f32_16x16x32_bf16 v[72:75], v[224:227], a[140:143], 0
    v_cvt_pk_bf16_f32 v102, v113, v117
    v_cvt_pk_bf16_f32 v103, v121, v125
    v_mfma_f32_16x16x32_bf16 v[140:143], v[228:231], a[144:147], v[140:143]
    v_exp_f32 v195, v195
    v_mfma_f32_16x16x32_bf16 v[12:15], v[232:235], a[144:147], v[12:15]
    ds_read_b128 a[140:143], v240 offset:18432
    v_mul_f32_dpp v106, v244, v106 row_newbcast:2 row_mask:0xf bank_mask:0xf
    v_mfma_f32_16x16x32_bf16 v[44:47], v[236:239], a[144:147], v[44:47]
    v_exp_f32 v204, v204
    v_mfma_f32_16x16x32_bf16 v[76:79], v[224:227], a[144:147], 0
    v_mul_f32_dpp v107, v244, v107 row_newbcast:3 row_mask:0xf bank_mask:0xf
    v_mul_f32_dpp v110, v244, v110 row_newbcast:2 row_mask:0xf bank_mask:0xf
    v_mfma_f32_16x16x32_bf16 v[144:147], v[228:231], a[148:151], v[144:147]
    v_exp_f32 v205, v205
    v_mfma_f32_16x16x32_bf16 v[16:19], v[232:235], a[148:151], v[16:19]
    ds_read_b128 a[144:147], v240 offset:19456
    v_mul_f32_dpp v111, v244, v111 row_newbcast:3 row_mask:0xf bank_mask:0xf
    v_mfma_f32_16x16x32_bf16 v[48:51], v[236:239], a[148:151], v[48:51]
    v_exp_f32 v206, v206
    v_mfma_f32_16x16x32_bf16 v[80:83], v[224:227], a[148:151], 0
    buffer_load_dwordx4 a[44:47], v243, s[12:15], s66 offen offset:192 nt
    v_mul_f32_dpp v114, v244, v114 row_newbcast:2 row_mask:0xf bank_mask:0xf
    v_mfma_f32_16x16x32_bf16 v[148:151], v[228:231], a[152:155], v[148:151]
    v_exp_f32 v207, v207
    v_mfma_f32_16x16x32_bf16 v[20:23], v[232:235], a[152:155], v[20:23]
    ds_read_b128 a[148:151], v240 offset:20480
    v_mul_f32_dpp v118, v244, v118 row_newbcast:2 row_mask:0xf bank_mask:0xf
    v_mfma_f32_16x16x32_bf16 v[52:55], v[236:239], a[152:155], v[52:55]
    v_exp_f32 v212, v212
    v_mfma_f32_16x16x32_bf16 v[84:87], v[224:227], a[152:155], 0
    v_mul_f32_dpp v122, v244, v122 row_newbcast:2 row_mask:0xf bank_mask:0xf
    s_waitcnt lgkmcnt(3)
    v_mfma_f32_16x16x32_bf16 v[152:155], v[228:231], a[156:159], v[152:155]
    v_exp_f32 v213, v213
    v_mfma_f32_16x16x32_bf16 v[24:27], v[232:235], a[156:159], v[24:27]
    ds_read_b128 a[152:155], v240 offset:21504
    buffer_store_dwordx4 v[96:99], v248, s[16:19], s60 offen offset:0 sc0 sc1
    v_mfma_f32_16x16x32_bf16 v[56:59], v[236:239], a[156:159], v[56:59]
    v_exp_f32 v214, v214
    v_mfma_f32_16x16x32_bf16 v[88:91], v[224:227], a[156:159], 0
    v_mul_f32_dpp v126, v244, v126 row_newbcast:2 row_mask:0xf bank_mask:0xf
    v_cvt_pk_bf16_f32 v105, v106, v110
    v_mfma_f32_16x16x32_bf16 v[156:159], v[228:231], a[128:131], v[156:159]
    v_exp_f32 v215, v215
    v_mfma_f32_16x16x32_bf16 v[28:31], v[232:235], a[128:131], v[28:31]
    ds_read_b128 a[156:159], v240 offset:22528
    v_cvt_pk_bf16_f32 v228, v200, v201
    v_mfma_f32_16x16x32_bf16 v[60:63], v[236:239], a[128:131], v[60:63]
    v_exp_f32 v220, v220
    v_mfma_f32_16x16x32_bf16 v[92:95], v[224:227], a[128:131], 0
    v_cvt_pk_bf16_f32 v229, v202, v203
    s_waitcnt vmcnt(9)
    v_mfma_f32_16x16x32_bf16 v[176:179], a[132:135], a[64:67], 0
    v_exp_f32 v221, v221
    v_mfma_f32_16x16x32_bf16 v[184:187], a[132:135], a[80:83], 0
    ds_read_b128 a[128:131], v240 offset:23552
    v_cvt_pk_bf16_f32 v224, v192, v193
    v_mfma_f32_16x16x32_bf16 v[160:163], a[132:135], a[0:3], 0
    v_exp_f32 v222, v222
    v_mfma_f32_16x16x32_bf16 v[168:171], a[132:135], a[16:19], 0
    v_cvt_pk_bf16_f32 v225, v194, v195
    v_cvt_pk_bf16_f32 v230, v204, v205
    v_mfma_f32_16x16x32_bf16 v[176:179], a[136:139], a[68:71], v[176:179]
    v_exp_f32 v223, v223
    v_mfma_f32_16x16x32_bf16 v[184:187], a[136:139], a[84:87], v[184:187]
    ds_read_b128 a[132:135], v241 offset:8192
    v_cvt_pk_bf16_f32 v231, v206, v207
    v_mfma_f32_16x16x32_bf16 v[160:163], a[136:139], a[4:7], v[160:163]
    v_exp_f32 v196, v196
    v_mfma_f32_16x16x32_bf16 v[168:171], a[136:139], a[20:23], v[168:171]
    v_cvt_pk_bf16_f32 v232, v208, v209
    s_waitcnt lgkmcnt(3)
    v_mfma_f32_16x16x32_bf16 v[176:179], a[140:143], a[72:75], v[176:179]
    v_exp_f32 v197, v197
    v_mfma_f32_16x16x32_bf16 v[184:187], a[140:143], a[88:91], v[184:187]
    ds_read_b128 a[136:139], v241 offset:9216
    v_cvt_pk_bf16_f32 v226, v196, v197
    v_mfma_f32_16x16x32_bf16 v[160:163], a[140:143], a[8:11], v[160:163]
    v_exp_f32 v198, v198
    v_mfma_f32_16x16x32_bf16 v[168:171], a[140:143], a[24:27], v[168:171]
    v_cvt_pk_bf16_f32 v233, v210, v211
    v_cvt_pk_bf16_f32 v236, v216, v217
    v_mfma_f32_16x16x32_bf16 v[176:179], a[144:147], a[76:79], v[176:179]
    v_exp_f32 v199, v199
    v_mfma_f32_16x16x32_bf16 v[184:187], a[144:147], a[92:95], v[184:187]
    ds_read_b128 a[140:143], v241 offset:10240
    v_cvt_pk_bf16_f32 v227, v198, v199
    v_mfma_f32_16x16x32_bf16 v[160:163], a[144:147], a[12:15], v[160:163]
    v_cvt_pk_bf16_f32 v237, v218, v219
    v_cvt_pk_bf16_f32 v234, v212, v213
    v_mfma_f32_16x16x32_bf16 v[168:171], a[144:147], a[28:31], v[168:171]
    v_cvt_pk_bf16_f32 v235, v214, v215
    v_cvt_pk_bf16_f32 v238, v220, v221
    v_mfma_f32_16x16x32_bf16 v[180:183], a[148:151], a[64:67], 0
    v_exp_f32 v176, v176
    v_mfma_f32_16x16x32_bf16 v[188:191], a[148:151], a[80:83], 0
    ds_read_b128 a[144:147], v241 offset:11264
    buffer_load_dwordx4 a[48:51], v243, s[12:15], s67 offen offset:0 nt
    v_mfma_f32_16x16x32_bf16 v[164:167], a[148:151], a[0:3], 0
    v_exp_f32 v177, v177
    v_mfma_f32_16x16x32_bf16 v[172:175], a[148:151], a[16:19], 0
    v_cvt_pk_bf16_f32 v239, v222, v223
    v_cvt_pk_bf16_f32 v106, v114, v118
    v_mfma_f32_16x16x32_bf16 v[180:183], a[152:155], a[68:71], v[180:183]
    v_exp_f32 v178, v178
    v_mfma_f32_16x16x32_bf16 v[188:191], a[152:155], a[84:87], v[188:191]
    ds_read_b128 a[148:151], v241 offset:12288
    v_cvt_pk_bf16_f32 v109, v107, v111
    v_mfma_f32_16x16x32_bf16 v[164:167], a[152:155], a[4:7], v[164:167]
    v_exp_f32 v179, v179
    v_mfma_f32_16x16x32_bf16 v[172:175], a[152:155], a[20:23], v[172:175]
    v_cvt_pk_bf16_f32 v107, v122, v126
    s_waitcnt lgkmcnt(3)
    v_mfma_f32_16x16x32_bf16 v[180:183], a[156:159], a[72:75], v[180:183]
    v_exp_f32 v184, v184
    v_mfma_f32_16x16x32_bf16 v[188:191], a[156:159], a[88:91], v[188:191]
    ds_read_b128 a[152:155], v241 offset:13312
    v_mul_f32_dpp v115, v244, v115 row_newbcast:3 row_mask:0xf bank_mask:0xf
    v_mfma_f32_16x16x32_bf16 v[164:167], a[156:159], a[8:11], v[164:167]
    v_exp_f32 v185, v185
    v_mfma_f32_16x16x32_bf16 v[172:175], a[156:159], a[24:27], v[172:175]
    v_mul_f32_dpp v119, v244, v119 row_newbcast:3 row_mask:0xf bank_mask:0xf
    v_mul_f32_dpp v123, v244, v123 row_newbcast:3 row_mask:0xf bank_mask:0xf
    v_mfma_f32_16x16x32_bf16 v[180:183], a[128:131], a[76:79], v[180:183]
    v_exp_f32 v186, v186
    v_mfma_f32_16x16x32_bf16 v[188:191], a[128:131], a[92:95], v[188:191]
    buffer_store_dwordx4 v[100:103], v248, s[16:19], s60 offen offset:256 sc0 sc1
    ds_read_b128 a[156:159], v241 offset:14336
    v_mfma_f32_16x16x32_bf16 v[164:167], a[128:131], a[12:15], v[164:167]
    v_exp_f32 v187, v187
    v_mfma_f32_16x16x32_bf16 v[172:175], a[128:131], a[28:31], v[172:175]
    v_mul_f32_dpp v127, v244, v127 row_newbcast:3 row_mask:0xf bank_mask:0xf
    v_cvt_pk_bf16_f32 v110, v115, v119
    v_smfmac_f32_16x16x64_bf16 a[192:195], a[212:215], v[224:231], v247
    v_exp_f32 v160, v160
    v_smfmac_f32_16x16x64_bf16 a[196:199], a[212:215], v[232:239], v247
    v_cvt_pk_bf16_f32 v111, v123, v127
    v_mfma_f32_16x16x32_bf16 v[128:131], v[228:231], a[132:135], v[128:131]
    v_exp_f32 v161, v161
    v_mfma_f32_16x16x32_bf16 v[0:3], v[232:235], a[132:135], v[0:3]
    ds_read_b128 a[128:131], v241 offset:15360
    v_mfma_f32_16x16x32_bf16 v[32:35], v[236:239], a[132:135], v[32:35]
    v_exp_f32 v162, v162
    v_mfma_f32_16x16x32_bf16 v[64:67], v[224:227], a[132:135], v[64:67]
    v_accvgpr_read_b32 v250, a194
    v_accvgpr_read_b32 v251, a195
    v_mfma_f32_16x16x32_bf16 v[132:135], v[228:231], a[136:139], v[132:135]
    v_exp_f32 v163, v163
    v_mfma_f32_16x16x32_bf16 v[4:7], v[232:235], a[136:139], v[4:7]
    ds_read_b128 a[132:135], v240 offset:24576
    v_add_f32 v250, v250, v251
    v_mfma_f32_16x16x32_bf16 v[36:39], v[236:239], a[136:139], v[36:39]
    v_exp_f32 v168, v168
    v_mfma_f32_16x16x32_bf16 v[68:71], v[224:227], a[136:139], v[68:71]
    v_subrev_u32 v246, s48, v250
    s_waitcnt lgkmcnt(3)
    v_mfma_f32_16x16x32_bf16 v[136:139], v[228:231], a[140:143], v[136:139]
    v_exp_f32 v169, v169
    v_mfma_f32_16x16x32_bf16 v[8:11], v[232:235], a[140:143], v[8:11]
    ds_read_b128 a[136:139], v240 offset:25600
    v_max_u32 v253, v253, v246
    v_mfma_f32_16x16x32_bf16 v[40:43], v[236:239], a[140:143], v[40:43]
    v_exp_f32 v170, v170
    v_mfma_f32_16x16x32_bf16 v[72:75], v[224:227], a[140:143], v[72:75]
    v_rcp_f32 v245, v250
    v_mfma_f32_16x16x32_bf16 v[140:143], v[228:231], a[144:147], v[140:143]
    v_exp_f32 v171, v171
    v_mfma_f32_16x16x32_bf16 v[12:15], v[232:235], a[144:147], v[12:15]
    ds_read_b128 a[140:143], v240 offset:26624
    ds_bpermute_b32 v245, v242, v245
    v_mfma_f32_16x16x32_bf16 v[44:47], v[236:239], a[144:147], v[44:47]
    v_exp_f32 v180, v180
    v_mfma_f32_16x16x32_bf16 v[76:79], v[224:227], a[144:147], v[76:79]
    v_accvgpr_write_b32 a194, 0
    v_accvgpr_write_b32 a195, 0
    v_mfma_f32_16x16x32_bf16 v[144:147], v[228:231], a[148:151], v[144:147]
    v_exp_f32 v181, v181
    v_mfma_f32_16x16x32_bf16 v[16:19], v[232:235], a[148:151], v[16:19]
    ds_read_b128 a[144:147], v240 offset:27648
    buffer_load_dwordx4 a[52:55], v243, s[12:15], s67 offen offset:64 nt
    v_mfma_f32_16x16x32_bf16 v[48:51], v[236:239], a[148:151], v[48:51]
    v_exp_f32 v182, v182
    v_mfma_f32_16x16x32_bf16 v[80:83], v[224:227], a[148:151], v[80:83]
    v_exp_f32 v183, v183
    v_mfma_f32_16x16x32_bf16 v[148:151], v[228:231], a[152:155], v[148:151]
    ds_read_b128 a[148:151], v240 offset:28672
    v_mfma_f32_16x16x32_bf16 v[20:23], v[232:235], a[152:155], v[20:23]
    v_exp_f32 v188, v188
    v_mfma_f32_16x16x32_bf16 v[52:55], v[236:239], a[152:155], v[52:55]
    s_waitcnt lgkmcnt(2)
    v_mul_f32_dpp v128, v245, v128 row_newbcast:0 row_mask:0xf bank_mask:0xf
    v_mul_f32_dpp v129, v245, v129 row_newbcast:1 row_mask:0xf bank_mask:0xf
    v_mfma_f32_16x16x32_bf16 v[84:87], v[224:227], a[152:155], v[84:87]
    v_mul_f32_dpp v130, v245, v130 row_newbcast:2 row_mask:0xf bank_mask:0xf
    v_mfma_f32_16x16x32_bf16 v[152:155], v[228:231], a[156:159], v[152:155]
    v_exp_f32 v189, v189
    v_mfma_f32_16x16x32_bf16 v[24:27], v[232:235], a[156:159], v[24:27]
    ds_read_b128 a[152:155], v240 offset:29696
    v_mul_f32_dpp v131, v245, v131 row_newbcast:3 row_mask:0xf bank_mask:0xf
    v_mfma_f32_16x16x32_bf16 v[56:59], v[236:239], a[156:159], v[56:59]
    v_exp_f32 v190, v190
    v_mfma_f32_16x16x32_bf16 v[88:91], v[224:227], a[156:159], v[88:91]
    v_mul_f32_dpp v132, v245, v132 row_newbcast:0 row_mask:0xf bank_mask:0xf
    v_mul_f32_dpp v133, v245, v133 row_newbcast:1 row_mask:0xf bank_mask:0xf
    v_mfma_f32_16x16x32_bf16 v[156:159], v[228:231], a[128:131], v[156:159]
    v_exp_f32 v191, v191
    v_mfma_f32_16x16x32_bf16 v[28:31], v[232:235], a[128:131], v[28:31]
    ds_read_b128 a[156:159], v240 offset:30720
    v_cvt_pk_bf16_f32 v232, v176, v177
    v_mfma_f32_16x16x32_bf16 v[60:63], v[236:239], a[128:131], v[60:63]
    v_exp_f32 v164, v164
    v_mfma_f32_16x16x32_bf16 v[92:95], v[224:227], a[128:131], v[92:95]
    buffer_store_dwordx4 v[104:107], v248, s[16:19], s60 offen offset:512 sc0 sc1
    v_cvt_pk_bf16_f32 v233, v178, v179
    v_mfma_f32_16x16x32_bf16 v[208:211], a[132:135], a[64:67], 0
    v_exp_f32 v165, v165
    v_mfma_f32_16x16x32_bf16 v[216:219], a[132:135], a[80:83], 0
    ds_read_b128 a[128:131], v240 offset:31744
    v_cvt_pk_bf16_f32 v236, v184, v185
    v_mfma_f32_16x16x32_bf16 v[192:195], a[132:135], a[0:3], 0
    v_exp_f32 v166, v166
    v_mfma_f32_16x16x32_bf16 v[200:203], a[132:135], a[16:19], 0
    v_cvt_pk_bf16_f32 v237, v186, v187
    v_cvt_pk_bf16_f32 v234, v180, v181
    v_mfma_f32_16x16x32_bf16 v[208:211], a[136:139], a[68:71], v[208:211]
    v_exp_f32 v167, v167
    v_mfma_f32_16x16x32_bf16 v[216:219], a[136:139], a[84:87], v[216:219]
    ds_read_b128 a[132:135], v241 offset:16384
    v_cvt_pk_bf16_f32 v235, v182, v183
    v_mfma_f32_16x16x32_bf16 v[192:195], a[136:139], a[4:7], v[192:195]
    v_exp_f32 v172, v172
    v_mfma_f32_16x16x32_bf16 v[200:203], a[136:139], a[20:23], v[200:203]
    v_cvt_pk_bf16_f32 v238, v188, v189
    v_mfma_f32_16x16x32_bf16 v[208:211], a[140:143], a[72:75], v[208:211]
    v_exp_f32 v173, v173
    v_mfma_f32_16x16x32_bf16 v[216:219], a[140:143], a[88:91], v[216:219]
    ds_read_b128 a[136:139], v241 offset:17408
    v_cvt_pk_bf16_f32 v239, v190, v191
    v_mfma_f32_16x16x32_bf16 v[192:195], a[140:143], a[8:11], v[192:195]
    v_exp_f32 v174, v174
    v_mfma_f32_16x16x32_bf16 v[200:203], a[140:143], a[24:27], v[200:203]
    v_cvt_pk_bf16_f32 v224, v160, v161
    v_cvt_pk_bf16_f32 v225, v162, v163
    s_waitcnt lgkmcnt(6)
    v_mfma_f32_16x16x32_bf16 v[208:211], a[144:147], a[76:79], v[208:211]
    v_exp_f32 v175, v175
    v_mfma_f32_16x16x32_bf16 v[216:219], a[144:147], a[92:95], v[216:219]
    ds_read_b128 a[140:143], v241 offset:18432
    v_cvt_pk_bf16_f32 v228, v168, v169
    v_mfma_f32_16x16x32_bf16 v[192:195], a[144:147], a[12:15], v[192:195]
    v_cvt_pk_bf16_f32 v229, v170, v171
    v_cvt_pk_bf16_f32 v226, v164, v165
    v_mfma_f32_16x16x32_bf16 v[200:203], a[144:147], a[28:31], v[200:203]
    v_cvt_pk_bf16_f32 v227, v166, v167
    v_cvt_pk_bf16_f32 v230, v172, v173
    s_waitcnt lgkmcnt(6)
    v_mfma_f32_16x16x32_bf16 v[212:215], a[148:151], a[64:67], 0
    v_exp_f32 v208, v208
    v_mfma_f32_16x16x32_bf16 v[220:223], a[148:151], a[80:83], 0
    ds_read_b128 a[144:147], v241 offset:19456
    v_cvt_pk_bf16_f32 v231, v174, v175
    v_mfma_f32_16x16x32_bf16 v[196:199], a[148:151], a[0:3], 0
    v_exp_f32 v209, v209
    v_mfma_f32_16x16x32_bf16 v[204:207], a[148:151], a[16:19], 0
    buffer_load_dwordx4 a[56:59], v243, s[12:15], s67 offen offset:128 nt
    v_mul_f32_dpp v134, v245, v134 row_newbcast:2 row_mask:0xf bank_mask:0xf
    s_waitcnt lgkmcnt(6)
    v_mfma_f32_16x16x32_bf16 v[212:215], a[152:155], a[68:71], v[212:215]
    v_exp_f32 v210, v210
    v_mfma_f32_16x16x32_bf16 v[220:223], a[152:155], a[84:87], v[220:223]
    ds_read_b128 a[148:151], v241 offset:20480
    v_mul_f32_dpp v135, v245, v135 row_newbcast:3 row_mask:0xf bank_mask:0xf
    v_mfma_f32_16x16x32_bf16 v[196:199], a[152:155], a[4:7], v[196:199]
    v_exp_f32 v211, v211
    v_mfma_f32_16x16x32_bf16 v[204:207], a[152:155], a[20:23], v[204:207]
    v_mul_f32_dpp v136, v245, v136 row_newbcast:0 row_mask:0xf bank_mask:0xf
    s_waitcnt lgkmcnt(3)
    v_mfma_f32_16x16x32_bf16 v[212:215], a[156:159], a[72:75], v[212:215]
    v_exp_f32 v216, v216
    v_mfma_f32_16x16x32_bf16 v[220:223], a[156:159], a[88:91], v[220:223]
    ds_read_b128 a[152:155], v241 offset:21504
    v_mul_f32_dpp v140, v245, v140 row_newbcast:0 row_mask:0xf bank_mask:0xf
    v_mfma_f32_16x16x32_bf16 v[196:199], a[156:159], a[8:11], v[196:199]
    v_exp_f32 v217, v217
    v_mfma_f32_16x16x32_bf16 v[204:207], a[156:159], a[24:27], v[204:207]
    v_mul_f32_dpp v144, v245, v144 row_newbcast:0 row_mask:0xf bank_mask:0xf
    v_mul_f32_dpp v148, v245, v148 row_newbcast:0 row_mask:0xf bank_mask:0xf
    v_mfma_f32_16x16x32_bf16 v[212:215], a[128:131], a[76:79], v[212:215]
    v_exp_f32 v218, v218
    v_mfma_f32_16x16x32_bf16 v[220:223], a[128:131], a[92:95], v[220:223]
    ds_read_b128 a[156:159], v241 offset:22528
    v_mul_f32_dpp v152, v245, v152 row_newbcast:0 row_mask:0xf bank_mask:0xf
    v_mfma_f32_16x16x32_bf16 v[196:199], a[128:131], a[12:15], v[196:199]
    v_exp_f32 v219, v219
    v_mfma_f32_16x16x32_bf16 v[204:207], a[128:131], a[28:31], v[204:207]
    v_mul_f32_dpp v156, v245, v156 row_newbcast:0 row_mask:0xf bank_mask:0xf
    v_cvt_pk_bf16_f32 v128, v128, v132
    v_smfmac_f32_16x16x64_bf16 a[196:199], a[212:215], v[232:239], v247
    v_exp_f32 v192, v192
    v_smfmac_f32_16x16x64_bf16 a[192:195], a[212:215], v[224:231], v247
    buffer_store_dwordx4 v[108:111], v248, s[16:19], s60 offen offset:768 sc0 sc1
    v_cvt_pk_bf16_f32 v132, v129, v133
    v_mfma_f32_16x16x32_bf16 v[0:3], v[232:235], a[132:135], v[0:3]
    v_exp_f32 v193, v193
    v_mfma_f32_16x16x32_bf16 v[32:35], v[236:239], a[132:135], v[32:35]
    ds_read_b128 a[128:131], v241 offset:23552
    v_cvt_pk_bf16_f32 v129, v136, v140
    v_mfma_f32_16x16x32_bf16 v[64:67], v[224:227], a[132:135], v[64:67]
    v_exp_f32 v194, v194
    v_mfma_f32_16x16x32_bf16 v[96:99], v[228:231], a[132:135], 0
    v_cvt_pk_bf16_f32 v136, v130, v134
    v_cvt_pk_bf16_f32 v140, v131, v135
    v_mfma_f32_16x16x32_bf16 v[4:7], v[232:235], a[136:139], v[4:7]
    v_exp_f32 v195, v195
    v_mfma_f32_16x16x32_bf16 v[36:39], v[236:239], a[136:139], v[36:39]
    ds_read_b128 a[132:135], v240 offset:32768
    v_cvt_pk_bf16_f32 v130, v144, v148
    v_mfma_f32_16x16x32_bf16 v[68:71], v[224:227], a[136:139], v[68:71]
    v_exp_f32 v200, v200
    v_mfma_f32_16x16x32_bf16 v[100:103], v[228:231], a[136:139], 0
    v_cvt_pk_bf16_f32 v131, v152, v156
    s_waitcnt lgkmcnt(3)
    v_mfma_f32_16x16x32_bf16 v[8:11], v[232:235], a[140:143], v[8:11]
    v_exp_f32 v201, v201
    v_mfma_f32_16x16x32_bf16 v[40:43], v[236:239], a[140:143], v[40:43]
    ds_read_b128 a[136:139], v240 offset:33792
    v_mul_f32_dpp v137, v245, v137 row_newbcast:1 row_mask:0xf bank_mask:0xf
    v_mfma_f32_16x16x32_bf16 v[72:75], v[224:227], a[140:143], v[72:75]
    v_exp_f32 v202, v202
    v_mfma_f32_16x16x32_bf16 v[104:107], v[228:231], a[140:143], 0
    v_mul_f32_dpp v141, v245, v141 row_newbcast:1 row_mask:0xf bank_mask:0xf
    v_mul_f32_dpp v145, v245, v145 row_newbcast:1 row_mask:0xf bank_mask:0xf
    v_mfma_f32_16x16x32_bf16 v[12:15], v[232:235], a[144:147], v[12:15]
    v_exp_f32 v203, v203
    v_mfma_f32_16x16x32_bf16 v[44:47], v[236:239], a[144:147], v[44:47]
    ds_read_b128 a[140:143], v240 offset:34816
    v_mul_f32_dpp v149, v245, v149 row_newbcast:1 row_mask:0xf bank_mask:0xf
    v_mfma_f32_16x16x32_bf16 v[76:79], v[224:227], a[144:147], v[76:79]
    v_exp_f32 v212, v212
    v_mfma_f32_16x16x32_bf16 v[108:111], v[228:231], a[144:147], 0
    v_mul_f32_dpp v153, v245, v153 row_newbcast:1 row_mask:0xf bank_mask:0xf
    v_mul_f32_dpp v157, v245, v157 row_newbcast:1 row_mask:0xf bank_mask:0xf
    v_mfma_f32_16x16x32_bf16 v[16:19], v[232:235], a[148:151], v[16:19]
    v_exp_f32 v213, v213
    v_mfma_f32_16x16x32_bf16 v[48:51], v[236:239], a[148:151], v[48:51]
    ds_read_b128 a[144:147], v241 offset:24576
    v_cvt_pk_bf16_f32 v133, v137, v141
    v_mfma_f32_16x16x32_bf16 v[80:83], v[224:227], a[148:151], v[80:83]
    v_exp_f32 v214, v214
    v_mfma_f32_16x16x32_bf16 v[112:115], v[228:231], a[148:151], 0
    buffer_load_dwordx4 a[60:63], v243, s[12:15], s67 offen offset:192 nt
    v_cvt_pk_bf16_f32 v134, v145, v149
    v_mfma_f32_16x16x32_bf16 v[20:23], v[232:235], a[152:155], v[20:23]
    v_exp_f32 v215, v215
    v_mfma_f32_16x16x32_bf16 v[52:55], v[236:239], a[152:155], v[52:55]
    ds_read_b128 a[148:151], v241 offset:25600
    v_cvt_pk_bf16_f32 v135, v153, v157
    v_mfma_f32_16x16x32_bf16 v[84:87], v[224:227], a[152:155], v[84:87]
    v_exp_f32 v220, v220
    v_mfma_f32_16x16x32_bf16 v[116:119], v[228:231], a[152:155], 0
    v_mul_f32_dpp v138, v245, v138 row_newbcast:2 row_mask:0xf bank_mask:0xf
    s_waitcnt lgkmcnt(3)
    v_mfma_f32_16x16x32_bf16 v[24:27], v[232:235], a[156:159], v[24:27]
    v_exp_f32 v221, v221
    v_mfma_f32_16x16x32_bf16 v[56:59], v[236:239], a[156:159], v[56:59]
    ds_read_b128 a[152:155], v241 offset:26624
    buffer_store_dwordx4 v[128:131], v248, s[16:19], s61 offen offset:0 sc0 sc1
    v_mfma_f32_16x16x32_bf16 v[88:91], v[224:227], a[156:159], v[88:91]
    v_exp_f32 v222, v222
    v_mfma_f32_16x16x32_bf16 v[120:123], v[228:231], a[156:159], 0
    v_mul_f32_dpp v139, v245, v139 row_newbcast:3 row_mask:0xf bank_mask:0xf
    v_mul_f32_dpp v142, v245, v142 row_newbcast:2 row_mask:0xf bank_mask:0xf
    v_mfma_f32_16x16x32_bf16 v[28:31], v[232:235], a[128:131], v[28:31]
    v_exp_f32 v223, v223
    v_mfma_f32_16x16x32_bf16 v[60:63], v[236:239], a[128:131], v[60:63]
    ds_read_b128 a[156:159], v241 offset:27648
    v_cvt_pk_bf16_f32 v232, v208, v209
    v_mfma_f32_16x16x32_bf16 v[92:95], v[224:227], a[128:131], v[92:95]
    v_exp_f32 v196, v196
    v_mfma_f32_16x16x32_bf16 v[124:127], v[228:231], a[128:131], 0
    v_cvt_pk_bf16_f32 v233, v210, v211
    s_waitcnt vmcnt(9)
    v_mfma_f32_16x16x32_bf16 v[184:187], a[132:135], a[80:83], 0
    v_exp_f32 v197, v197
    v_mfma_f32_16x16x32_bf16 v[160:163], a[132:135], a[0:3], 0
    ds_read_b128 a[128:131], v241 offset:28672
    v_cvt_pk_bf16_f32 v236, v216, v217
    v_mfma_f32_16x16x32_bf16 v[168:171], a[132:135], a[16:19], 0
    v_exp_f32 v198, v198
    v_mfma_f32_16x16x32_bf16 v[176:179], a[132:135], a[32:35], 0
    v_cvt_pk_bf16_f32 v237, v218, v219
    v_cvt_pk_bf16_f32 v234, v212, v213
    v_mfma_f32_16x16x32_bf16 v[184:187], a[136:139], a[84:87], v[184:187]
    v_exp_f32 v199, v199
    v_mfma_f32_16x16x32_bf16 v[160:163], a[136:139], a[4:7], v[160:163]
    ds_read_b128 a[132:135], v241 offset:29696
    v_cvt_pk_bf16_f32 v235, v214, v215
    v_mfma_f32_16x16x32_bf16 v[168:171], a[136:139], a[20:23], v[168:171]
    v_exp_f32 v204, v204
    v_mfma_f32_16x16x32_bf16 v[176:179], a[136:139], a[36:39], v[176:179]
    v_cvt_pk_bf16_f32 v238, v220, v221
    s_waitcnt lgkmcnt(3)
    v_mfma_f32_16x16x32_bf16 v[184:187], a[140:143], a[88:91], v[184:187]
    v_exp_f32 v205, v205
    v_mfma_f32_16x16x32_bf16 v[160:163], a[140:143], a[8:11], v[160:163]
    ds_read_b128 a[136:139], v241 offset:30720
    v_cvt_pk_bf16_f32 v239, v222, v223
    v_mfma_f32_16x16x32_bf16 v[168:171], a[140:143], a[24:27], v[168:171]
    v_exp_f32 v206, v206
    v_mfma_f32_16x16x32_bf16 v[176:179], a[140:143], a[40:43], v[176:179]
    v_cvt_pk_bf16_f32 v224, v192, v193
    v_cvt_pk_bf16_f32 v225, v194, v195
    v_mfma_f32_16x16x32_bf16 v[184:187], a[252:255], a[92:95], v[184:187]
    v_exp_f32 v207, v207
    v_mfma_f32_16x16x32_bf16 v[160:163], a[252:255], a[12:15], v[160:163]
    v_cvt_pk_bf16_f32 v228, v200, v201
    v_cvt_pk_bf16_f32 v229, v202, v203
    v_mfma_f32_16x16x32_bf16 v[168:171], a[252:255], a[28:31], v[168:171]
    v_cvt_pk_bf16_f32 v226, v196, v197
    v_cvt_pk_bf16_f32 v227, v198, v199
    v_mfma_f32_16x16x32_bf16 v[176:179], a[252:255], a[44:47], v[176:179]
    v_cvt_pk_bf16_f32 v230, v204, v205
    v_cvt_pk_bf16_f32 v231, v206, v207
    v_mfma_f32_16x16x32_bf16 v[188:191], a[248:251], a[80:83], 0
    v_exp_f32 v184, v184
    v_mfma_f32_16x16x32_bf16 v[164:167], a[248:251], a[0:3], 0
    v_mul_f32_dpp v143, v245, v143 row_newbcast:3 row_mask:0xf bank_mask:0xf
    v_mul_f32_dpp v146, v245, v146 row_newbcast:2 row_mask:0xf bank_mask:0xf
    v_mfma_f32_16x16x32_bf16 v[172:175], a[248:251], a[16:19], 0
    v_exp_f32 v185, v185
    v_mfma_f32_16x16x32_bf16 v[180:183], a[248:251], a[32:35], 0
    v_mul_f32_dpp v150, v245, v150 row_newbcast:2 row_mask:0xf bank_mask:0xf
    v_mul_f32_dpp v154, v245, v154 row_newbcast:2 row_mask:0xf bank_mask:0xf
    v_mfma_f32_16x16x32_bf16 v[188:191], a[244:247], a[84:87], v[188:191]
    v_exp_f32 v186, v186
    v_mfma_f32_16x16x32_bf16 v[164:167], a[244:247], a[4:7], v[164:167]
    v_mul_f32_dpp v158, v245, v158 row_newbcast:2 row_mask:0xf bank_mask:0xf
    v_cvt_pk_bf16_f32 v137, v138, v142
    v_mfma_f32_16x16x32_bf16 v[172:175], a[244:247], a[20:23], v[172:175]
    v_exp_f32 v187, v187
    v_mfma_f32_16x16x32_bf16 v[180:183], a[244:247], a[36:39], v[180:183]
    v_cvt_pk_bf16_f32 v138, v146, v150
    v_cvt_pk_bf16_f32 v141, v139, v143
    v_mfma_f32_16x16x32_bf16 v[188:191], a[240:243], a[88:91], v[188:191]
    v_exp_f32 v160, v160
    v_mfma_f32_16x16x32_bf16 v[164:167], a[240:243], a[8:11], v[164:167]
    v_cvt_pk_bf16_f32 v139, v154, v158
    v_mul_f32_dpp v147, v245, v147 row_newbcast:3 row_mask:0xf bank_mask:0xf
    v_mfma_f32_16x16x32_bf16 v[172:175], a[240:243], a[24:27], v[172:175]
    v_exp_f32 v161, v161
    v_mfma_f32_16x16x32_bf16 v[180:183], a[240:243], a[40:43], v[180:183]
    v_mul_f32_dpp v151, v245, v151 row_newbcast:3 row_mask:0xf bank_mask:0xf
    v_mul_f32_dpp v155, v245, v155 row_newbcast:3 row_mask:0xf bank_mask:0xf
    v_mfma_f32_16x16x32_bf16 v[188:191], a[236:239], a[92:95], v[188:191]
    v_exp_f32 v162, v162
    v_mfma_f32_16x16x32_bf16 v[164:167], a[236:239], a[12:15], v[164:167]
    buffer_store_dwordx4 v[132:135], v248, s[16:19], s61 offen offset:256 sc0 sc1
    v_mul_f32_dpp v159, v245, v159 row_newbcast:3 row_mask:0xf bank_mask:0xf
    v_mfma_f32_16x16x32_bf16 v[172:175], a[236:239], a[28:31], v[172:175]
    v_exp_f32 v163, v163
    v_mfma_f32_16x16x32_bf16 v[180:183], a[236:239], a[44:47], v[180:183]
    v_cvt_pk_bf16_f32 v142, v147, v151
    v_cvt_pk_bf16_f32 v143, v155, v159
    v_smfmac_f32_16x16x64_bf16 a[196:199], a[212:215], v[232:239], v247
    v_exp_f32 v168, v168
    v_smfmac_f32_16x16x64_bf16 a[192:195], a[212:215], v[224:231], v247
    v_exp_f32 v169, v169
    v_mfma_f32_16x16x32_bf16 v[0:3], v[232:235], a[144:147], v[0:3]
    ds_read_b128 a[140:143], v241 offset:31744
    v_mfma_f32_16x16x32_bf16 v[32:35], v[236:239], a[144:147], v[32:35]
    v_exp_f32 v170, v170
    v_mfma_f32_16x16x32_bf16 v[64:67], v[224:227], a[144:147], v[64:67]
    v_accvgpr_read_b32 v249, a196
    v_accvgpr_read_b32 v251, a197
    v_mfma_f32_16x16x32_bf16 v[96:99], v[228:231], a[144:147], v[96:99]
    v_exp_f32 v171, v171
    v_mfma_f32_16x16x32_bf16 v[4:7], v[232:235], a[148:151], v[4:7]
    ds_read_b128 a[144:147], v240 offset:49152
    v_add_f32 v249, v249, v251
    v_mfma_f32_16x16x32_bf16 v[36:39], v[236:239], a[148:151], v[36:39]
    v_exp_f32 v176, v176
    v_mfma_f32_16x16x32_bf16 v[68:71], v[224:227], a[148:151], v[68:71]
    v_subrev_u32 v246, s48, v249
    v_accvgpr_write_b32 a196, 0
    v_mfma_f32_16x16x32_bf16 v[100:103], v[228:231], a[148:151], v[100:103]
    v_exp_f32 v177, v177
    v_mfma_f32_16x16x32_bf16 v[8:11], v[232:235], a[152:155], v[8:11]
    ds_read_b128 a[148:151], v240 offset:50176
    v_max_u32 v253, v253, v246
    v_mfma_f32_16x16x32_bf16 v[40:43], v[236:239], a[152:155], v[40:43]
    v_exp_f32 v178, v178
    v_mfma_f32_16x16x32_bf16 v[72:75], v[224:227], a[152:155], v[72:75]
    v_rcp_f32 v244, v249
    v_mfma_f32_16x16x32_bf16 v[104:107], v[228:231], a[152:155], v[104:107]
    ds_bpermute_b32 v244, v242, v244
    s_waitcnt lgkmcnt(4)
    v_mfma_f32_16x16x32_bf16 v[12:15], v[232:235], a[156:159], v[12:15]
    v_exp_f32 v179, v179
    v_mfma_f32_16x16x32_bf16 v[44:47], v[236:239], a[156:159], v[44:47]
    ds_read_b128 a[152:155], v240 offset:51200
    v_accvgpr_write_b32 a197, 0
    v_mfma_f32_16x16x32_bf16 v[76:79], v[224:227], a[156:159], v[76:79]
    v_exp_f32 v188, v188
    v_mfma_f32_16x16x32_bf16 v[108:111], v[228:231], a[156:159], v[108:111]
    v_exp_f32 v189, v189
    v_mfma_f32_16x16x32_bf16 v[16:19], v[232:235], a[128:131], v[16:19]
    ds_read_b128 a[156:159], v240 offset:52224
    v_mfma_f32_16x16x32_bf16 v[48:51], v[236:239], a[128:131], v[48:51]
    v_exp_f32 v190, v190
    v_mfma_f32_16x16x32_bf16 v[80:83], v[224:227], a[128:131], v[80:83]
    v_exp_f32 v191, v191
    v_mfma_f32_16x16x32_bf16 v[112:115], v[228:231], a[128:131], v[112:115]
    s_waitcnt lgkmcnt(2)
    v_mul_f32_dpp v0, v244, v0 row_newbcast:0 row_mask:0xf bank_mask:0xf
    v_mul_f32_dpp v1, v244, v1 row_newbcast:1 row_mask:0xf bank_mask:0xf
    v_mfma_f32_16x16x32_bf16 v[20:23], v[232:235], a[132:135], v[20:23]
    v_exp_f32 v164, v164
    v_mfma_f32_16x16x32_bf16 v[52:55], v[236:239], a[132:135], v[52:55]
    ds_read_b128 a[128:131], v240 offset:53248
    v_mul_f32_dpp v2, v244, v2 row_newbcast:2 row_mask:0xf bank_mask:0xf
    v_mfma_f32_16x16x32_bf16 v[84:87], v[224:227], a[132:135], v[84:87]
    v_exp_f32 v165, v165
    v_mfma_f32_16x16x32_bf16 v[116:119], v[228:231], a[132:135], v[116:119]
    v_mul_f32_dpp v3, v244, v3 row_newbcast:3 row_mask:0xf bank_mask:0xf
    v_mul_f32_dpp v4, v244, v4 row_newbcast:0 row_mask:0xf bank_mask:0xf
    v_mfma_f32_16x16x32_bf16 v[24:27], v[232:235], a[136:139], v[24:27]
    v_exp_f32 v166, v166
    v_mfma_f32_16x16x32_bf16 v[56:59], v[236:239], a[136:139], v[56:59]
    ds_read_b128 a[132:135], v240 offset:54272
    v_mul_f32_dpp v5, v244, v5 row_newbcast:1 row_mask:0xf bank_mask:0xf
    v_mfma_f32_16x16x32_bf16 v[88:91], v[224:227], a[136:139], v[88:91]
    v_exp_f32 v167, v167
    v_mfma_f32_16x16x32_bf16 v[120:123], v[228:231], a[136:139], v[120:123]
    v_mul_f32_dpp v6, v244, v6 row_newbcast:2 row_mask:0xf bank_mask:0xf
    v_mfma_f32_16x16x32_bf16 v[28:31], v[232:235], a[140:143], v[28:31]
    v_exp_f32 v172, v172
    v_mfma_f32_16x16x32_bf16 v[60:63], v[236:239], a[140:143], v[60:63]
    ds_read_b128 a[136:139], v240 offset:55296
    v_cvt_pk_bf16_f32 v236, v184, v185
    v_mfma_f32_16x16x32_bf16 v[92:95], v[224:227], a[140:143], v[92:95]
    v_exp_f32 v173, v173
    v_mfma_f32_16x16x32_bf16 v[124:127], v[228:231], a[140:143], v[124:127]
    buffer_store_dwordx4 v[136:139], v248, s[16:19], s61 offen offset:512 sc0 sc1
    v_cvt_pk_bf16_f32 v237, v186, v187
    v_mfma_f32_16x16x32_bf16 v[216:219], a[232:235], a[80:83], 0
    v_exp_f32 v174, v174
    v_mfma_f32_16x16x32_bf16 v[192:195], a[232:235], a[0:3], 0
    v_cvt_pk_bf16_f32 v232, v176, v177
    v_cvt_pk_bf16_f32 v233, v178, v179
    v_mfma_f32_16x16x32_bf16 v[200:203], a[232:235], a[16:19], 0
    v_exp_f32 v175, v175
    v_mfma_f32_16x16x32_bf16 v[208:211], a[232:235], a[32:35], 0
    v_cvt_pk_bf16_f32 v238, v188, v189
    v_cvt_pk_bf16_f32 v239, v190, v191
    v_mfma_f32_16x16x32_bf16 v[216:219], a[228:231], a[84:87], v[216:219]
    v_exp_f32 v180, v180
    v_mfma_f32_16x16x32_bf16 v[192:195], a[228:231], a[4:7], v[192:195]
    v_cvt_pk_bf16_f32 v224, v160, v161
    v_cvt_pk_bf16_f32 v225, v162, v163
    v_mfma_f32_16x16x32_bf16 v[200:203], a[228:231], a[20:23], v[200:203]
    v_exp_f32 v181, v181
    v_mfma_f32_16x16x32_bf16 v[208:211], a[228:231], a[36:39], v[208:211]
    v_cvt_pk_bf16_f32 v234, v180, v181
    v_cvt_pk_bf16_f32 v228, v168, v169
    v_mfma_f32_16x16x32_bf16 v[216:219], a[224:227], a[88:91], v[216:219]
    v_exp_f32 v182, v182
    v_mfma_f32_16x16x32_bf16 v[192:195], a[224:227], a[8:11], v[192:195]
    v_cvt_pk_bf16_f32 v229, v170, v171
    v_cvt_pk_bf16_f32 v226, v164, v165
    v_mfma_f32_16x16x32_bf16 v[200:203], a[224:227], a[24:27], v[200:203]
    v_exp_f32 v183, v183
    v_mfma_f32_16x16x32_bf16 v[208:211], a[224:227], a[40:43], v[208:211]
    v_cvt_pk_bf16_f32 v235, v182, v183
    v_cvt_pk_bf16_f32 v227, v166, v167
    v_mfma_f32_16x16x32_bf16 v[216:219], a[220:223], a[92:95], v[216:219]
    v_cvt_pk_bf16_f32 v230, v172, v173
    v_cvt_pk_bf16_f32 v231, v174, v175
    v_mfma_f32_16x16x32_bf16 v[192:195], a[220:223], a[12:15], v[192:195]
    v_mul_f32_dpp v7, v244, v7 row_newbcast:3 row_mask:0xf bank_mask:0xf
    v_mul_f32_dpp v8, v244, v8 row_newbcast:0 row_mask:0xf bank_mask:0xf
    v_mfma_f32_16x16x32_bf16 v[200:203], a[220:223], a[28:31], v[200:203]
    v_mul_f32_dpp v12, v244, v12 row_newbcast:0 row_mask:0xf bank_mask:0xf
    v_mul_f32_dpp v16, v244, v16 row_newbcast:0 row_mask:0xf bank_mask:0xf
    v_mfma_f32_16x16x32_bf16 v[208:211], a[220:223], a[44:47], v[208:211]
    v_mul_f32_dpp v20, v244, v20 row_newbcast:0 row_mask:0xf bank_mask:0xf
    v_mul_f32_dpp v24, v244, v24 row_newbcast:0 row_mask:0xf bank_mask:0xf
    v_mfma_f32_16x16x32_bf16 v[220:223], a[216:219], a[80:83], 0
    v_exp_f32 v216, v216
    v_mfma_f32_16x16x32_bf16 v[196:199], a[216:219], a[0:3], 0
    v_mul_f32_dpp v28, v244, v28 row_newbcast:0 row_mask:0xf bank_mask:0xf
    v_cvt_pk_bf16_f32 v0, v0, v4
    v_mfma_f32_16x16x32_bf16 v[204:207], a[216:219], a[16:19], 0
    v_exp_f32 v217, v217
    v_mfma_f32_16x16x32_bf16 v[212:215], a[216:219], a[32:35], 0
    v_cvt_pk_bf16_f32 v4, v1, v5
    v_cvt_pk_bf16_f32 v1, v8, v12
    v_mfma_f32_16x16x32_bf16 v[220:223], a[208:211], a[84:87], v[220:223]
    v_exp_f32 v218, v218
    v_mfma_f32_16x16x32_bf16 v[196:199], a[208:211], a[4:7], v[196:199]
    v_cvt_pk_bf16_f32 v8, v2, v6
    v_cvt_pk_bf16_f32 v12, v3, v7
    v_mfma_f32_16x16x32_bf16 v[204:207], a[208:211], a[20:23], v[204:207]
    v_exp_f32 v219, v219
    v_mfma_f32_16x16x32_bf16 v[212:215], a[208:211], a[36:39], v[212:215]
    v_cvt_pk_bf16_f32 v2, v16, v20
    v_cvt_pk_bf16_f32 v3, v24, v28
    v_mfma_f32_16x16x32_bf16 v[220:223], a[204:207], a[88:91], v[220:223]
    v_exp_f32 v192, v192
    v_mfma_f32_16x16x32_bf16 v[196:199], a[204:207], a[8:11], v[196:199]
    v_mul_f32_dpp v9, v244, v9 row_newbcast:1 row_mask:0xf bank_mask:0xf
    v_mul_f32_dpp v13, v244, v13 row_newbcast:1 row_mask:0xf bank_mask:0xf
    v_mfma_f32_16x16x32_bf16 v[204:207], a[204:207], a[24:27], v[204:207]
    v_exp_f32 v193, v193
    v_mfma_f32_16x16x32_bf16 v[212:215], a[204:207], a[40:43], v[212:215]
    v_mul_f32_dpp v17, v244, v17 row_newbcast:1 row_mask:0xf bank_mask:0xf
    v_mul_f32_dpp v21, v244, v21 row_newbcast:1 row_mask:0xf bank_mask:0xf
    v_mfma_f32_16x16x32_bf16 v[220:223], a[200:203], a[92:95], v[220:223]
    v_exp_f32 v194, v194
    v_mfma_f32_16x16x32_bf16 v[196:199], a[200:203], a[12:15], v[196:199]
    v_mul_f32_dpp v25, v244, v25 row_newbcast:1 row_mask:0xf bank_mask:0xf
    v_mul_f32_dpp v29, v244, v29 row_newbcast:1 row_mask:0xf bank_mask:0xf
    v_mfma_f32_16x16x32_bf16 v[204:207], a[200:203], a[28:31], v[204:207]
    v_exp_f32 v195, v195
    v_mfma_f32_16x16x32_bf16 v[212:215], a[200:203], a[44:47], v[212:215]
    v_cvt_pk_bf16_f32 v5, v9, v13
    v_cvt_pk_bf16_f32 v6, v17, v21
    v_smfmac_f32_16x16x64_bf16 a[196:199], a[212:215], v[232:239], v247
    v_exp_f32 v200, v200
    v_smfmac_f32_16x16x64_bf16 a[192:195], a[212:215], v[224:231], v247
    buffer_store_dwordx4 v[140:143], v248, s[16:19], s61 offen offset:768 sc0 sc1
    v_cvt_pk_bf16_f32 v7, v25, v29
    v_mfma_f32_16x16x32_bf16 v[32:35], v[236:239], a[188:191], v[32:35]
    v_exp_f32 v201, v201
    v_mfma_f32_16x16x32_bf16 v[64:67], v[224:227], a[188:191], v[64:67]
    v_mul_f32_dpp v10, v244, v10 row_newbcast:2 row_mask:0xf bank_mask:0xf
    v_mul_f32_dpp v11, v244, v11 row_newbcast:3 row_mask:0xf bank_mask:0xf
    v_mfma_f32_16x16x32_bf16 v[96:99], v[228:231], a[188:191], v[96:99]
    v_exp_f32 v202, v202
    v_mfma_f32_16x16x32_bf16 v[128:131], v[232:235], a[188:191], 0
    v_mul_f32_dpp v14, v244, v14 row_newbcast:2 row_mask:0xf bank_mask:0xf
    v_mul_f32_dpp v15, v244, v15 row_newbcast:3 row_mask:0xf bank_mask:0xf
    v_mfma_f32_16x16x32_bf16 v[36:39], v[236:239], a[184:187], v[36:39]
    v_exp_f32 v203, v203
    v_mfma_f32_16x16x32_bf16 v[68:71], v[224:227], a[184:187], v[68:71]
    v_mul_f32_dpp v18, v244, v18 row_newbcast:2 row_mask:0xf bank_mask:0xf
    v_mul_f32_dpp v22, v244, v22 row_newbcast:2 row_mask:0xf bank_mask:0xf
    v_mfma_f32_16x16x32_bf16 v[100:103], v[228:231], a[184:187], v[100:103]
    v_exp_f32 v208, v208
    v_mfma_f32_16x16x32_bf16 v[132:135], v[232:235], a[184:187], 0
    v_mul_f32_dpp v26, v244, v26 row_newbcast:2 row_mask:0xf bank_mask:0xf
    v_mul_f32_dpp v30, v244, v30 row_newbcast:2 row_mask:0xf bank_mask:0xf
    v_mfma_f32_16x16x32_bf16 v[40:43], v[236:239], a[180:183], v[40:43]
    v_exp_f32 v209, v209
    v_mfma_f32_16x16x32_bf16 v[72:75], v[224:227], a[180:183], v[72:75]
    v_cvt_pk_bf16_f32 v9, v10, v14
    v_cvt_pk_bf16_f32 v10, v18, v22
    v_mfma_f32_16x16x32_bf16 v[104:107], v[228:231], a[180:183], v[104:107]
    v_exp_f32 v210, v210
    v_mfma_f32_16x16x32_bf16 v[136:139], v[232:235], a[180:183], 0
    v_cvt_pk_bf16_f32 v13, v11, v15
    v_cvt_pk_bf16_f32 v11, v26, v30
    v_mfma_f32_16x16x32_bf16 v[44:47], v[236:239], a[176:179], v[44:47]
    v_exp_f32 v211, v211
    v_mfma_f32_16x16x32_bf16 v[76:79], v[224:227], a[176:179], v[76:79]
    v_mul_f32_dpp v19, v244, v19 row_newbcast:3 row_mask:0xf bank_mask:0xf
    v_mul_f32_dpp v23, v244, v23 row_newbcast:3 row_mask:0xf bank_mask:0xf
    v_mfma_f32_16x16x32_bf16 v[108:111], v[228:231], a[176:179], v[108:111]
    v_exp_f32 v220, v220
    v_mfma_f32_16x16x32_bf16 v[140:143], v[232:235], a[176:179], 0
    v_mul_f32_dpp v27, v244, v27 row_newbcast:3 row_mask:0xf bank_mask:0xf
    v_mul_f32_dpp v31, v244, v31 row_newbcast:3 row_mask:0xf bank_mask:0xf
    v_mfma_f32_16x16x32_bf16 v[48:51], v[236:239], a[172:175], v[48:51]
    v_exp_f32 v221, v221
    v_mfma_f32_16x16x32_bf16 v[80:83], v[224:227], a[172:175], v[80:83]
    v_cvt_pk_bf16_f32 v14, v19, v23
    v_cvt_pk_bf16_f32 v15, v27, v31
    v_mfma_f32_16x16x32_bf16 v[112:115], v[228:231], a[172:175], v[112:115]
    v_exp_f32 v222, v222
    v_mfma_f32_16x16x32_bf16 v[144:147], v[232:235], a[172:175], 0
    v_exp_f32 v223, v223
    v_mfma_f32_16x16x32_bf16 v[52:55], v[236:239], a[168:171], v[52:55]
    v_exp_f32 v196, v196
    v_mfma_f32_16x16x32_bf16 v[84:87], v[224:227], a[168:171], v[84:87]
    v_exp_f32 v197, v197
    v_mfma_f32_16x16x32_bf16 v[116:119], v[228:231], a[168:171], v[116:119]
    v_exp_f32 v198, v198
    v_mfma_f32_16x16x32_bf16 v[148:151], v[232:235], a[168:171], 0
    v_exp_f32 v199, v199
    v_mfma_f32_16x16x32_bf16 v[56:59], v[236:239], a[164:167], v[56:59]
    v_exp_f32 v204, v204
    v_mfma_f32_16x16x32_bf16 v[88:91], v[224:227], a[164:167], v[88:91]
    buffer_store_dwordx4 v[0:3], v248, s[16:19], s62 offen offset:0 sc0 sc1
    v_mfma_f32_16x16x32_bf16 v[120:123], v[228:231], a[164:167], v[120:123]
    v_exp_f32 v205, v205
    v_mfma_f32_16x16x32_bf16 v[152:155], v[232:235], a[164:167], 0
    v_exp_f32 v206, v206
    v_mfma_f32_16x16x32_bf16 v[60:63], v[236:239], a[160:163], v[60:63]
    v_cvt_pk_bf16_f32 v236, v216, v217
    v_cvt_pk_bf16_f32 v237, v218, v219
    v_mfma_f32_16x16x32_bf16 v[92:95], v[224:227], a[160:163], v[92:95]
    v_exp_f32 v207, v207
    v_mfma_f32_16x16x32_bf16 v[124:127], v[228:231], a[160:163], v[124:127]
    v_cvt_pk_bf16_f32 v238, v220, v221
    v_cvt_pk_bf16_f32 v239, v222, v223
    v_mfma_f32_16x16x32_bf16 v[156:159], v[232:235], a[160:163], 0
    v_cvt_pk_bf16_f32 v232, v208, v209
    s_waitcnt vmcnt(5)
    v_mfma_f32_16x16x32_bf16 v[160:163], a[144:147], a[0:3], 0
    v_exp_f32 v212, v212
    v_mfma_f32_16x16x32_bf16 v[168:171], a[144:147], a[16:19], 0
    ds_read_b128 a[140:143], v240 offset:56320
    v_cvt_pk_bf16_f32 v233, v210, v211
    v_mfma_f32_16x16x32_bf16 v[176:179], a[144:147], a[32:35], 0
    v_exp_f32 v213, v213
    v_mfma_f32_16x16x32_bf16 v[184:187], a[144:147], a[48:51], 0
    v_cvt_pk_bf16_f32 v234, v212, v213
    v_cvt_pk_bf16_f32 v224, v192, v193
    v_mfma_f32_16x16x32_bf16 v[160:163], a[148:151], a[4:7], v[160:163]
    v_exp_f32 v214, v214
    v_mfma_f32_16x16x32_bf16 v[168:171], a[148:151], a[20:23], v[168:171]
    ds_read_b128 a[144:147], v240 offset:57344
    v_cvt_pk_bf16_f32 v225, v194, v195
    v_mfma_f32_16x16x32_bf16 v[176:179], a[148:151], a[36:39], v[176:179]
    v_exp_f32 v215, v215
    v_mfma_f32_16x16x32_bf16 v[184:187], a[148:151], a[52:55], v[184:187]
    v_cvt_pk_bf16_f32 v235, v214, v215
    v_cvt_pk_bf16_f32 v228, v200, v201
    s_waitcnt lgkmcnt(6)
    v_mfma_f32_16x16x32_bf16 v[160:163], a[152:155], a[8:11], v[160:163]
    ds_read_b128 a[148:151], v240 offset:58368
    v_cvt_pk_bf16_f32 v229, v202, v203
    v_mfma_f32_16x16x32_bf16 v[168:171], a[152:155], a[24:27], v[168:171]
    v_cvt_pk_bf16_f32 v226, v196, v197
    v_cvt_pk_bf16_f32 v227, v198, v199
    v_mfma_f32_16x16x32_bf16 v[176:179], a[152:155], a[40:43], v[176:179]
    v_cvt_pk_bf16_f32 v230, v204, v205
    v_cvt_pk_bf16_f32 v231, v206, v207
    v_mfma_f32_16x16x32_bf16 v[184:187], a[152:155], a[56:59], v[184:187]
    s_waitcnt lgkmcnt(3)
    v_mfma_f32_16x16x32_bf16 v[160:163], a[156:159], a[12:15], v[160:163]
    ds_read_b128 a[152:155], v240 offset:59392
    v_mfma_f32_16x16x32_bf16 v[168:171], a[156:159], a[28:31], v[168:171]
    v_mfma_f32_16x16x32_bf16 v[176:179], a[156:159], a[44:47], v[176:179]
    v_mfma_f32_16x16x32_bf16 v[184:187], a[156:159], a[60:63], v[184:187]
    v_mfma_f32_16x16x32_bf16 v[164:167], a[128:131], a[0:3], 0
    s_nop 2
    v_exp_f32 v160, v160
    v_mfma_f32_16x16x32_bf16 v[172:175], a[128:131], a[16:19], 0
    ds_read_b128 a[156:159], v240 offset:60416
    v_mfma_f32_16x16x32_bf16 v[180:183], a[128:131], a[32:35], 0
    v_exp_f32 v161, v161
    v_mfma_f32_16x16x32_bf16 v[188:191], a[128:131], a[48:51], 0
    v_exp_f32 v162, v162
    v_mfma_f32_16x16x32_bf16 v[164:167], a[132:135], a[4:7], v[164:167]
    ds_read_b128 a[128:131], v240 offset:61440
    v_mfma_f32_16x16x32_bf16 v[172:175], a[132:135], a[20:23], v[172:175]
    v_exp_f32 v163, v163
    v_mfma_f32_16x16x32_bf16 v[180:183], a[132:135], a[36:39], v[180:183]
    v_exp_f32 v168, v168
    v_mfma_f32_16x16x32_bf16 v[188:191], a[132:135], a[52:55], v[188:191]
    v_exp_f32 v169, v169
    v_mfma_f32_16x16x32_bf16 v[164:167], a[136:139], a[8:11], v[164:167]
    ds_read_b128 a[132:135], v240 offset:62464
    v_mfma_f32_16x16x32_bf16 v[172:175], a[136:139], a[24:27], v[172:175]
    v_exp_f32 v170, v170
    v_mfma_f32_16x16x32_bf16 v[180:183], a[136:139], a[40:43], v[180:183]
    v_exp_f32 v171, v171
    v_mfma_f32_16x16x32_bf16 v[188:191], a[136:139], a[56:59], v[188:191]
    s_waitcnt lgkmcnt(3)
    v_mfma_f32_16x16x32_bf16 v[164:167], a[140:143], a[12:15], v[164:167]
    v_exp_f32 v176, v176
    v_mfma_f32_16x16x32_bf16 v[172:175], a[140:143], a[28:31], v[172:175]
    buffer_store_dwordx4 v[4:7], v248, s[16:19], s62 offen offset:256 sc0 sc1
    ds_read_b128 a[136:139], v240 offset:63488
    v_mfma_f32_16x16x32_bf16 v[180:183], a[140:143], a[44:47], v[180:183]
    v_exp_f32 v177, v177
    v_mfma_f32_16x16x32_bf16 v[188:191], a[140:143], a[60:63], v[188:191]
    v_exp_f32 v178, v178
    v_smfmac_f32_16x16x64_bf16 a[196:199], a[212:215], v[232:239], v247
    v_exp_f32 v179, v179
    v_smfmac_f32_16x16x64_bf16 a[192:195], a[212:215], v[224:231], v247
    v_exp_f32 v184, v184
    v_mfma_f32_16x16x32_bf16 v[32:35], v[236:239], a[124:127], v[32:35]
    v_exp_f32 v185, v185
    v_mfma_f32_16x16x32_bf16 v[64:67], v[224:227], a[124:127], v[64:67]
    v_exp_f32 v186, v186
    v_mfma_f32_16x16x32_bf16 v[96:99], v[228:231], a[124:127], v[96:99]
    v_accvgpr_read_b32 v250, a198
    v_accvgpr_read_b32 v251, a199
    v_mfma_f32_16x16x32_bf16 v[128:131], v[232:235], a[124:127], v[128:131]
    v_exp_f32 v187, v187
    v_mfma_f32_16x16x32_bf16 v[36:39], v[236:239], a[120:123], v[36:39]
    v_add_f32 v250, v250, v251
    v_accvgpr_write_b32 a198, 0
    v_mfma_f32_16x16x32_bf16 v[68:71], v[224:227], a[120:123], v[68:71]
    v_exp_f32 v164, v164
    v_mfma_f32_16x16x32_bf16 v[100:103], v[228:231], a[120:123], v[100:103]
    v_subrev_u32 v246, s48, v250
    v_accvgpr_write_b32 a199, 0
    v_mfma_f32_16x16x32_bf16 v[132:135], v[232:235], a[120:123], v[132:135]
    v_exp_f32 v165, v165
    v_mfma_f32_16x16x32_bf16 v[40:43], v[236:239], a[116:119], v[40:43]
    v_rcp_f32 v245, v250
    v_mfma_f32_16x16x32_bf16 v[72:75], v[224:227], a[116:119], v[72:75]
    v_exp_f32 v166, v166
    v_mfma_f32_16x16x32_bf16 v[104:107], v[228:231], a[116:119], v[104:107]
    v_max_u32 v253, v253, v246
    ds_bpermute_b32 v245, v242, v245
    v_mfma_f32_16x16x32_bf16 v[136:139], v[232:235], a[116:119], v[136:139]
    v_exp_f32 v167, v167
    v_mfma_f32_16x16x32_bf16 v[44:47], v[236:239], a[112:115], v[44:47]
    v_exp_f32 v172, v172
    v_mfma_f32_16x16x32_bf16 v[76:79], v[224:227], a[112:115], v[76:79]
    v_exp_f32 v173, v173
    v_mfma_f32_16x16x32_bf16 v[108:111], v[228:231], a[112:115], v[108:111]
    v_exp_f32 v174, v174
    v_mfma_f32_16x16x32_bf16 v[140:143], v[232:235], a[112:115], v[140:143]
    v_exp_f32 v175, v175
    v_mfma_f32_16x16x32_bf16 v[48:51], v[236:239], a[108:111], v[48:51]
    v_exp_f32 v180, v180
    v_mfma_f32_16x16x32_bf16 v[80:83], v[224:227], a[108:111], v[80:83]
    v_exp_f32 v181, v181
    v_mfma_f32_16x16x32_bf16 v[112:115], v[228:231], a[108:111], v[112:115]
    s_waitcnt lgkmcnt(0)
    v_mul_f32_dpp v32, v245, v32 row_newbcast:0 row_mask:0xf bank_mask:0xf
    v_mul_f32_dpp v33, v245, v33 row_newbcast:1 row_mask:0xf bank_mask:0xf
    v_mfma_f32_16x16x32_bf16 v[144:147], v[232:235], a[108:111], v[144:147]
    v_exp_f32 v182, v182
    v_mfma_f32_16x16x32_bf16 v[52:55], v[236:239], a[104:107], v[52:55]
    v_mul_f32_dpp v34, v245, v34 row_newbcast:2 row_mask:0xf bank_mask:0xf
    v_mul_f32_dpp v35, v245, v35 row_newbcast:3 row_mask:0xf bank_mask:0xf
    v_mfma_f32_16x16x32_bf16 v[84:87], v[224:227], a[104:107], v[84:87]
    v_exp_f32 v183, v183
    v_mfma_f32_16x16x32_bf16 v[116:119], v[228:231], a[104:107], v[116:119]
    v_mul_f32_dpp v36, v245, v36 row_newbcast:0 row_mask:0xf bank_mask:0xf
    v_mul_f32_dpp v37, v245, v37 row_newbcast:1 row_mask:0xf bank_mask:0xf
    v_mfma_f32_16x16x32_bf16 v[148:151], v[232:235], a[104:107], v[148:151]
    v_exp_f32 v188, v188
    v_mfma_f32_16x16x32_bf16 v[56:59], v[236:239], a[100:103], v[56:59]
    v_mul_f32_dpp v38, v245, v38 row_newbcast:2 row_mask:0xf bank_mask:0xf
    v_mul_f32_dpp v39, v245, v39 row_newbcast:3 row_mask:0xf bank_mask:0xf
    v_mfma_f32_16x16x32_bf16 v[88:91], v[224:227], a[100:103], v[88:91]
    v_exp_f32 v189, v189
    v_mfma_f32_16x16x32_bf16 v[120:123], v[228:231], a[100:103], v[120:123]
    v_mul_f32_dpp v40, v245, v40 row_newbcast:0 row_mask:0xf bank_mask:0xf
    v_mul_f32_dpp v44, v245, v44 row_newbcast:0 row_mask:0xf bank_mask:0xf
    v_mfma_f32_16x16x32_bf16 v[152:155], v[232:235], a[100:103], v[152:155]
    v_exp_f32 v190, v190
    v_mfma_f32_16x16x32_bf16 v[60:63], v[236:239], a[96:99], v[60:63]
    v_cvt_pk_bf16_f32 v236, v184, v185
    v_cvt_pk_bf16_f32 v237, v186, v187
    v_mfma_f32_16x16x32_bf16 v[92:95], v[224:227], a[96:99], v[92:95]
    v_exp_f32 v191, v191
    v_mfma_f32_16x16x32_bf16 v[124:127], v[228:231], a[96:99], v[124:127]
    buffer_store_dwordx4 v[8:11], v248, s[16:19], s62 offen offset:512 sc0 sc1
    v_cvt_pk_bf16_f32 v224, v160, v161
    v_mfma_f32_16x16x32_bf16 v[156:159], v[232:235], a[96:99], v[156:159]
    v_cvt_pk_bf16_f32 v225, v162, v163
    v_cvt_pk_bf16_f32 v228, v168, v169
    v_mfma_f32_16x16x32_bf16 v[192:195], a[144:147], a[0:3], 0
    ds_read_b128 a[140:143], v240 offset:64512
    v_cvt_pk_bf16_f32 v229, v170, v171
    v_mfma_f32_16x16x32_bf16 v[200:203], a[144:147], a[16:19], 0
    v_cvt_pk_bf16_f32 v226, v164, v165
    v_cvt_pk_bf16_f32 v227, v166, v167
    v_mfma_f32_16x16x32_bf16 v[208:211], a[144:147], a[32:35], 0
    v_cvt_pk_bf16_f32 v230, v172, v173
    v_cvt_pk_bf16_f32 v231, v174, v175
    v_mfma_f32_16x16x32_bf16 v[216:219], a[144:147], a[48:51], 0
    v_cvt_pk_bf16_f32 v232, v176, v177
    v_cvt_pk_bf16_f32 v233, v178, v179
    v_mfma_f32_16x16x32_bf16 v[192:195], a[148:151], a[4:7], v[192:195]
    ds_read_b128 a[144:147], v241 offset:49152
    v_cvt_pk_bf16_f32 v234, v180, v181
    v_mfma_f32_16x16x32_bf16 v[200:203], a[148:151], a[20:23], v[200:203]
    v_cvt_pk_bf16_f32 v235, v182, v183
    v_cvt_pk_bf16_f32 v238, v188, v189
    v_mfma_f32_16x16x32_bf16 v[208:211], a[148:151], a[36:39], v[208:211]
    v_cvt_pk_bf16_f32 v239, v190, v191
    v_mul_f32_dpp v48, v245, v48 row_newbcast:0 row_mask:0xf bank_mask:0xf
    v_mfma_f32_16x16x32_bf16 v[216:219], a[148:151], a[52:55], v[216:219]
    v_mul_f32_dpp v52, v245, v52 row_newbcast:0 row_mask:0xf bank_mask:0xf
    v_mul_f32_dpp v56, v245, v56 row_newbcast:0 row_mask:0xf bank_mask:0xf
    v_mfma_f32_16x16x32_bf16 v[192:195], a[152:155], a[8:11], v[192:195]
    ds_read_b128 a[148:151], v241 offset:50176
    v_mul_f32_dpp v60, v245, v60 row_newbcast:0 row_mask:0xf bank_mask:0xf
    v_mfma_f32_16x16x32_bf16 v[200:203], a[152:155], a[24:27], v[200:203]
    v_cvt_pk_bf16_f32 v32, v32, v36
    v_cvt_pk_bf16_f32 v36, v33, v37
    v_mfma_f32_16x16x32_bf16 v[208:211], a[152:155], a[40:43], v[208:211]
    v_cvt_pk_bf16_f32 v33, v40, v44
    v_cvt_pk_bf16_f32 v40, v34, v38
    v_mfma_f32_16x16x32_bf16 v[216:219], a[152:155], a[56:59], v[216:219]
    v_cvt_pk_bf16_f32 v44, v35, v39
    v_mfma_f32_16x16x32_bf16 v[192:195], a[156:159], a[12:15], v[192:195]
    ds_read_b128 a[152:155], v241 offset:51200
    v_cvt_pk_bf16_f32 v34, v48, v52
    v_mfma_f32_16x16x32_bf16 v[200:203], a[156:159], a[28:31], v[200:203]
    v_cvt_pk_bf16_f32 v35, v56, v60
    v_mul_f32_dpp v41, v245, v41 row_newbcast:1 row_mask:0xf bank_mask:0xf
    v_mfma_f32_16x16x32_bf16 v[208:211], a[156:159], a[44:47], v[208:211]
    v_mul_f32_dpp v45, v245, v45 row_newbcast:1 row_mask:0xf bank_mask:0xf
    v_mul_f32_dpp v49, v245, v49 row_newbcast:1 row_mask:0xf bank_mask:0xf
    v_mfma_f32_16x16x32_bf16 v[216:219], a[156:159], a[60:63], v[216:219]
    v_mul_f32_dpp v53, v245, v53 row_newbcast:1 row_mask:0xf bank_mask:0xf
    v_mul_f32_dpp v57, v245, v57 row_newbcast:1 row_mask:0xf bank_mask:0xf
    v_mfma_f32_16x16x32_bf16 v[196:199], a[128:131], a[0:3], 0
    v_exp_f32 v192, v192
    v_mfma_f32_16x16x32_bf16 v[204:207], a[128:131], a[16:19], 0
    ds_read_b128 a[156:159], v241 offset:52224
    v_mul_f32_dpp v61, v245, v61 row_newbcast:1 row_mask:0xf bank_mask:0xf
    v_mfma_f32_16x16x32_bf16 v[212:215], a[128:131], a[32:35], 0
    v_exp_f32 v193, v193
    v_mfma_f32_16x16x32_bf16 v[220:223], a[128:131], a[48:51], 0
    v_cvt_pk_bf16_f32 v37, v41, v45
    v_cvt_pk_bf16_f32 v38, v49, v53
    v_mfma_f32_16x16x32_bf16 v[196:199], a[132:135], a[4:7], v[196:199]
    v_exp_f32 v194, v194
    v_mfma_f32_16x16x32_bf16 v[204:207], a[132:135], a[20:23], v[204:207]
    ds_read_b128 a[128:131], v241 offset:53248
    v_cvt_pk_bf16_f32 v39, v57, v61
    v_mfma_f32_16x16x32_bf16 v[212:215], a[132:135], a[36:39], v[212:215]
    v_exp_f32 v195, v195
    v_mfma_f32_16x16x32_bf16 v[220:223], a[132:135], a[52:55], v[220:223]
    v_mul_f32_dpp v42, v245, v42 row_newbcast:2 row_mask:0xf bank_mask:0xf
    v_mul_f32_dpp v43, v245, v43 row_newbcast:3 row_mask:0xf bank_mask:0xf
    v_mfma_f32_16x16x32_bf16 v[196:199], a[136:139], a[8:11], v[196:199]
    v_exp_f32 v200, v200
    v_mfma_f32_16x16x32_bf16 v[204:207], a[136:139], a[24:27], v[204:207]
    ds_read_b128 a[132:135], v241 offset:54272
    v_mul_f32_dpp v46, v245, v46 row_newbcast:2 row_mask:0xf bank_mask:0xf
    v_mfma_f32_16x16x32_bf16 v[212:215], a[136:139], a[40:43], v[212:215]
    v_exp_f32 v201, v201
    v_mfma_f32_16x16x32_bf16 v[220:223], a[136:139], a[56:59], v[220:223]
    v_mul_f32_dpp v47, v245, v47 row_newbcast:3 row_mask:0xf bank_mask:0xf
    s_waitcnt lgkmcnt(3)
    v_mfma_f32_16x16x32_bf16 v[196:199], a[140:143], a[12:15], v[196:199]
    v_exp_f32 v202, v202
    v_mfma_f32_16x16x32_bf16 v[204:207], a[140:143], a[28:31], v[204:207]
    ds_read_b128 a[136:139], v241 offset:55296
    v_mul_f32_dpp v50, v245, v50 row_newbcast:2 row_mask:0xf bank_mask:0xf
    v_mfma_f32_16x16x32_bf16 v[212:215], a[140:143], a[44:47], v[212:215]
    v_exp_f32 v203, v203
    v_mfma_f32_16x16x32_bf16 v[220:223], a[140:143], a[60:63], v[220:223]
    v_mul_f32_dpp v54, v245, v54 row_newbcast:2 row_mask:0xf bank_mask:0xf
    v_mul_f32_dpp v58, v245, v58 row_newbcast:2 row_mask:0xf bank_mask:0xf
    v_smfmac_f32_16x16x64_bf16 a[192:195], a[212:215], v[224:231], v247
    v_exp_f32 v208, v208
    v_smfmac_f32_16x16x64_bf16 a[196:199], a[212:215], v[232:239], v247
    buffer_store_dwordx4 v[12:15], v248, s[16:19], s62 offen offset:768 sc0 sc1
    v_mul_f32_dpp v62, v245, v62 row_newbcast:2 row_mask:0xf bank_mask:0xf
    v_mfma_f32_16x16x32_bf16 v[64:67], v[224:227], a[144:147], v[64:67]
    v_exp_f32 v209, v209
    v_mfma_f32_16x16x32_bf16 v[96:99], v[228:231], a[144:147], v[96:99]
    ds_read_b128 a[140:143], v241 offset:56320
    v_cvt_pk_bf16_f32 v41, v42, v46
    v_mfma_f32_16x16x32_bf16 v[128:131], v[232:235], a[144:147], v[128:131]
    v_exp_f32 v210, v210
    v_mfma_f32_16x16x32_bf16 v[0:3], v[236:239], a[144:147], 0
    v_cvt_pk_bf16_f32 v42, v50, v54
    v_cvt_pk_bf16_f32 v45, v43, v47
    v_mfma_f32_16x16x32_bf16 v[68:71], v[224:227], a[148:151], v[68:71]
    v_exp_f32 v211, v211
    v_mfma_f32_16x16x32_bf16 v[100:103], v[228:231], a[148:151], v[100:103]
    ds_read_b128 a[144:147], v240 offset:0
    v_cvt_pk_bf16_f32 v43, v58, v62
    v_mfma_f32_16x16x32_bf16 v[132:135], v[232:235], a[148:151], v[132:135]
    v_exp_f32 v216, v216
    v_mfma_f32_16x16x32_bf16 v[4:7], v[236:239], a[148:151], 0
    v_mul_f32_dpp v51, v245, v51 row_newbcast:3 row_mask:0xf bank_mask:0xf
    v_mul_f32_dpp v55, v245, v55 row_newbcast:3 row_mask:0xf bank_mask:0xf
    v_mfma_f32_16x16x32_bf16 v[72:75], v[224:227], a[152:155], v[72:75]
    v_exp_f32 v217, v217
    v_mfma_f32_16x16x32_bf16 v[104:107], v[228:231], a[152:155], v[104:107]
    ds_read_b128 a[148:151], v240 offset:1024
    v_mul_f32_dpp v59, v245, v59 row_newbcast:3 row_mask:0xf bank_mask:0xf
    v_mfma_f32_16x16x32_bf16 v[136:139], v[232:235], a[152:155], v[136:139]
    v_exp_f32 v218, v218
    v_mfma_f32_16x16x32_bf16 v[8:11], v[236:239], a[152:155], 0
    v_mul_f32_dpp v63, v245, v63 row_newbcast:3 row_mask:0xf bank_mask:0xf
    s_waitcnt lgkmcnt(3)
    v_mfma_f32_16x16x32_bf16 v[76:79], v[224:227], a[156:159], v[76:79]
    v_exp_f32 v219, v219
    v_mfma_f32_16x16x32_bf16 v[108:111], v[228:231], a[156:159], v[108:111]
    ds_read_b128 a[152:155], v240 offset:2048
    v_cvt_pk_bf16_f32 v46, v51, v55
    v_mfma_f32_16x16x32_bf16 v[140:143], v[232:235], a[156:159], v[140:143]
    v_exp_f32 v196, v196
    v_mfma_f32_16x16x32_bf16 v[12:15], v[236:239], a[156:159], 0
    v_cvt_pk_bf16_f32 v47, v59, v63
    v_mfma_f32_16x16x32_bf16 v[80:83], v[224:227], a[128:131], v[80:83]
    v_exp_f32 v197, v197
    v_mfma_f32_16x16x32_bf16 v[112:115], v[228:231], a[128:131], v[112:115]
    ds_read_b128 a[156:159], v240 offset:3072
    v_mfma_f32_16x16x32_bf16 v[144:147], v[232:235], a[128:131], v[144:147]
    v_exp_f32 v198, v198
    v_mfma_f32_16x16x32_bf16 v[16:19], v[236:239], a[128:131], 0
    v_exp_f32 v199, v199
    v_mfma_f32_16x16x32_bf16 v[84:87], v[224:227], a[132:135], v[84:87]
    ds_read_b128 a[128:131], v240 offset:4096
    v_mfma_f32_16x16x32_bf16 v[116:119], v[228:231], a[132:135], v[116:119]
    v_exp_f32 v204, v204
    v_mfma_f32_16x16x32_bf16 v[148:151], v[232:235], a[132:135], v[148:151]
    v_exp_f32 v205, v205
    v_mfma_f32_16x16x32_bf16 v[20:23], v[236:239], a[132:135], 0
    v_exp_f32 v206, v206
    v_mfma_f32_16x16x32_bf16 v[88:91], v[224:227], a[136:139], v[88:91]
    ds_read_b128 a[132:135], v240 offset:5120
    v_mfma_f32_16x16x32_bf16 v[120:123], v[228:231], a[136:139], v[120:123]
    v_exp_f32 v207, v207
    v_mfma_f32_16x16x32_bf16 v[152:155], v[232:235], a[136:139], v[152:155]
    buffer_store_dwordx4 v[32:35], v248, s[16:19], s63 offen offset:0 sc0 sc1
    v_mfma_f32_16x16x32_bf16 v[24:27], v[236:239], a[136:139], 0
    s_waitcnt lgkmcnt(3)
    v_mfma_f32_16x16x32_bf16 v[92:95], v[224:227], a[140:143], v[92:95]
    v_exp_f32 v212, v212
    v_mfma_f32_16x16x32_bf16 v[124:127], v[228:231], a[140:143], v[124:127]
    ds_read_b128 a[136:139], v240 offset:6144
    v_cvt_pk_bf16_f32 v224, v192, v193
    v_mfma_f32_16x16x32_bf16 v[156:159], v[232:235], a[140:143], v[156:159]
    v_exp_f32 v213, v213
    v_mfma_f32_16x16x32_bf16 v[28:31], v[236:239], a[140:143], 0
    v_cvt_pk_bf16_f32 v225, v194, v195
    v_cvt_pk_bf16_f32 v228, v200, v201
    v_mfma_f32_16x16x32_bf16 v[168:171], a[144:147], a[16:19], 0
    v_exp_f32 v214, v214
    ds_read_b128 a[140:143], v240 offset:7168
    v_mfma_f32_16x16x32_bf16 v[176:179], a[144:147], a[32:35], 0
    v_cvt_pk_bf16_f32 v229, v202, v203
    v_cvt_pk_bf16_f32 v226, v196, v197
    v_cvt_pk_bf16_f32 v227, v198, v199
    v_mfma_f32_16x16x32_bf16 v[184:187], a[144:147], a[48:51], 0
    v_exp_f32 v215, v215
    v_cvt_pk_bf16_f32 v230, v204, v205
    v_mfma_f32_16x16x32_bf16 v[168:171], a[148:151], a[20:23], v[168:171]
    ds_read_b128 a[144:147], v241 offset:57344
    v_cvt_pk_bf16_f32 v231, v206, v207
    v_cvt_pk_bf16_f32 v232, v208, v209
    v_mfma_f32_16x16x32_bf16 v[176:179], a[148:151], a[36:39], v[176:179]
    v_exp_f32 v220, v220
    v_cvt_pk_bf16_f32 v233, v210, v211
    v_mfma_f32_16x16x32_bf16 v[184:187], a[148:151], a[52:55], v[184:187]
    v_cvt_pk_bf16_f32 v236, v216, v217
    v_cvt_pk_bf16_f32 v237, v218, v219
    v_cvt_pk_bf16_f32 v234, v212, v213
    v_mfma_f32_16x16x32_bf16 v[168:171], a[152:155], a[24:27], v[168:171]
    v_exp_f32 v221, v221
    ds_read_b128 a[148:151], v241 offset:58368
    v_mfma_f32_16x16x32_bf16 v[176:179], a[152:155], a[40:43], v[176:179]
    v_cvt_pk_bf16_f32 v235, v214, v215
    v_cvt_pk_bf16_f32 v238, v220, v221
    v_mfma_f32_16x16x32_bf16 v[184:187], a[152:155], a[56:59], v[184:187]
    v_exp_f32 v222, v222
    s_waitcnt lgkmcnt(3)
    v_mfma_f32_16x16x32_bf16 v[168:171], a[156:159], a[28:31], v[168:171]
    ds_read_b128 a[152:155], v241 offset:59392
    v_mfma_f32_16x16x32_bf16 v[176:179], a[156:159], a[44:47], v[176:179]
    v_exp_f32 v223, v223
    v_mfma_f32_16x16x32_bf16 v[184:187], a[156:159], a[60:63], v[184:187]
    v_cvt_pk_bf16_f32 v239, v222, v223
    v_mfma_f32_16x16x32_bf16 v[172:175], a[128:131], a[16:19], 0
    ds_read_b128 a[156:159], v241 offset:60416
    v_mfma_f32_16x16x32_bf16 v[180:183], a[128:131], a[32:35], 0
    v_exp_f32 v168, v168
    v_mfma_f32_16x16x32_bf16 v[188:191], a[128:131], a[48:51], 0
    v_exp_f32 v169, v169
    v_mfma_f32_16x16x32_bf16 v[172:175], a[132:135], a[20:23], v[172:175]
    ds_read_b128 a[128:131], v241 offset:61440
    v_mfma_f32_16x16x32_bf16 v[180:183], a[132:135], a[36:39], v[180:183]
    v_exp_f32 v170, v170
    v_mfma_f32_16x16x32_bf16 v[188:191], a[132:135], a[52:55], v[188:191]
    v_exp_f32 v171, v171
    v_mfma_f32_16x16x32_bf16 v[172:175], a[136:139], a[24:27], v[172:175]
    ds_read_b128 a[132:135], v241 offset:62464
    v_mfma_f32_16x16x32_bf16 v[180:183], a[136:139], a[40:43], v[180:183]
    v_exp_f32 v176, v176
    v_mfma_f32_16x16x32_bf16 v[188:191], a[136:139], a[56:59], v[188:191]
    v_exp_f32 v177, v177
    s_waitcnt lgkmcnt(3)
    v_mfma_f32_16x16x32_bf16 v[172:175], a[140:143], a[28:31], v[172:175]
    ds_read_b128 a[136:139], v241 offset:63488
    v_mfma_f32_16x16x32_bf16 v[180:183], a[140:143], a[44:47], v[180:183]
    v_exp_f32 v178, v178
    v_mfma_f32_16x16x32_bf16 v[188:191], a[140:143], a[60:63], v[188:191]
    v_exp_f32 v179, v179
    v_smfmac_f32_16x16x64_bf16 a[192:195], a[212:215], v[224:231], v247
    v_exp_f32 v184, v184
    v_smfmac_f32_16x16x64_bf16 a[196:199], a[212:215], v[232:239], v247
    v_exp_f32 v185, v185
    v_mfma_f32_16x16x32_bf16 v[64:67], v[224:227], a[144:147], v[64:67]
    ds_read_b128 a[140:143], v241 offset:64512
    v_mfma_f32_16x16x32_bf16 v[96:99], v[228:231], a[144:147], v[96:99]
    v_exp_f32 v186, v186
    v_mfma_f32_16x16x32_bf16 v[128:131], v[232:235], a[144:147], v[128:131]
    buffer_store_dwordx4 v[36:39], v248, s[16:19], s63 offen offset:256 sc0 sc1
    v_accvgpr_read_b32 v249, a192
    v_accvgpr_read_b32 v251, a193
    v_mfma_f32_16x16x32_bf16 v[0:3], v[236:239], a[144:147], v[0:3]
    v_exp_f32 v187, v187
    v_add_f32 v249, v249, v251
    v_mfma_f32_16x16x32_bf16 v[68:71], v[224:227], a[148:151], v[68:71]
    ds_read_b128 a[144:147], v240 offset:8192
    v_subrev_u32 v246, s48, v249
    v_mfma_f32_16x16x32_bf16 v[100:103], v[228:231], a[148:151], v[100:103]
    v_exp_f32 v172, v172
    v_max_u32 v253, v253, v246
    v_mfma_f32_16x16x32_bf16 v[132:135], v[232:235], a[148:151], v[132:135]
    v_rcp_f32 v244, v249
    v_mfma_f32_16x16x32_bf16 v[4:7], v[236:239], a[148:151], v[4:7]
    v_exp_f32 v173, v173
    ds_bpermute_b32 v244, v242, v244
    v_mfma_f32_16x16x32_bf16 v[72:75], v[224:227], a[152:155], v[72:75]
    ds_read_b128 a[148:151], v240 offset:9216
    v_mfma_f32_16x16x32_bf16 v[104:107], v[228:231], a[152:155], v[104:107]
    v_exp_f32 v174, v174
    v_mfma_f32_16x16x32_bf16 v[136:139], v[232:235], a[152:155], v[136:139]
    v_exp_f32 v175, v175
    v_mfma_f32_16x16x32_bf16 v[8:11], v[236:239], a[152:155], v[8:11]
    v_exp_f32 v180, v180
    s_waitcnt lgkmcnt(4)
    v_mfma_f32_16x16x32_bf16 v[76:79], v[224:227], a[156:159], v[76:79]
    ds_read_b128 a[152:155], v240 offset:10240
    v_mfma_f32_16x16x32_bf16 v[108:111], v[228:231], a[156:159], v[108:111]
    v_exp_f32 v181, v181
    v_mfma_f32_16x16x32_bf16 v[140:143], v[232:235], a[156:159], v[140:143]
    v_exp_f32 v182, v182
    v_mfma_f32_16x16x32_bf16 v[12:15], v[236:239], a[156:159], v[12:15]
    s_waitcnt lgkmcnt(2)
    v_mul_f32_dpp v64, v244, v64 row_newbcast:0 row_mask:0xf bank_mask:0xf
    v_mul_f32_dpp v65, v244, v65 row_newbcast:1 row_mask:0xf bank_mask:0xf
    v_mul_f32_dpp v66, v244, v66 row_newbcast:2 row_mask:0xf bank_mask:0xf
    v_mfma_f32_16x16x32_bf16 v[80:83], v[224:227], a[128:131], v[80:83]
    v_exp_f32 v183, v183
    ds_read_b128 a[156:159], v240 offset:11264
    v_mfma_f32_16x16x32_bf16 v[112:115], v[228:231], a[128:131], v[112:115]
    v_mul_f32_dpp v67, v244, v67 row_newbcast:3 row_mask:0xf bank_mask:0xf
    v_mul_f32_dpp v68, v244, v68 row_newbcast:0 row_mask:0xf bank_mask:0xf
    v_mul_f32_dpp v69, v244, v69 row_newbcast:1 row_mask:0xf bank_mask:0xf
    v_mfma_f32_16x16x32_bf16 v[144:147], v[232:235], a[128:131], v[144:147]
    v_exp_f32 v188, v188
    v_mul_f32_dpp v70, v244, v70 row_newbcast:2 row_mask:0xf bank_mask:0xf
    v_mfma_f32_16x16x32_bf16 v[16:19], v[236:239], a[128:131], v[16:19]
    v_mul_f32_dpp v71, v244, v71 row_newbcast:3 row_mask:0xf bank_mask:0xf
    v_mul_f32_dpp v72, v244, v72 row_newbcast:0 row_mask:0xf bank_mask:0xf
    v_mul_f32_dpp v76, v244, v76 row_newbcast:0 row_mask:0xf bank_mask:0xf
    v_mfma_f32_16x16x32_bf16 v[84:87], v[224:227], a[132:135], v[84:87]
    v_exp_f32 v189, v189
    ds_read_b128 a[128:131], v240 offset:12288
    v_mfma_f32_16x16x32_bf16 v[116:119], v[228:231], a[132:135], v[116:119]
    v_mul_f32_dpp v80, v244, v80 row_newbcast:0 row_mask:0xf bank_mask:0xf
    v_mul_f32_dpp v73, v244, v73 row_newbcast:1 row_mask:0xf bank_mask:0xf
    v_mul_f32_dpp v77, v244, v77 row_newbcast:1 row_mask:0xf bank_mask:0xf
    v_mfma_f32_16x16x32_bf16 v[148:151], v[232:235], a[132:135], v[148:151]
    v_exp_f32 v190, v190
    v_mul_f32_dpp v81, v244, v81 row_newbcast:1 row_mask:0xf bank_mask:0xf
    v_mfma_f32_16x16x32_bf16 v[20:23], v[236:239], a[132:135], v[20:23]
    v_mul_f32_dpp v74, v244, v74 row_newbcast:2 row_mask:0xf bank_mask:0xf
    v_mul_f32_dpp v75, v244, v75 row_newbcast:3 row_mask:0xf bank_mask:0xf
    v_mul_f32_dpp v78, v244, v78 row_newbcast:2 row_mask:0xf bank_mask:0xf
    v_mfma_f32_16x16x32_bf16 v[88:91], v[224:227], a[136:139], v[88:91]
    v_exp_f32 v191, v191
    ds_read_b128 a[132:135], v240 offset:13312
    v_mfma_f32_16x16x32_bf16 v[120:123], v[228:231], a[136:139], v[120:123]
    v_mul_f32_dpp v84, v244, v84 row_newbcast:0 row_mask:0xf bank_mask:0xf
    v_mul_f32_dpp v85, v244, v85 row_newbcast:1 row_mask:0xf bank_mask:0xf
    v_mul_f32_dpp v79, v244, v79 row_newbcast:3 row_mask:0xf bank_mask:0xf
    v_mfma_f32_16x16x32_bf16 v[152:155], v[232:235], a[136:139], v[152:155]
    v_mul_f32_dpp v82, v244, v82 row_newbcast:2 row_mask:0xf bank_mask:0xf
    v_mul_f32_dpp v86, v244, v86 row_newbcast:2 row_mask:0xf bank_mask:0xf
    v_mul_f32_dpp v83, v244, v83 row_newbcast:3 row_mask:0xf bank_mask:0xf
    v_mfma_f32_16x16x32_bf16 v[24:27], v[236:239], a[136:139], v[24:27]
    v_mul_f32_dpp v87, v244, v87 row_newbcast:3 row_mask:0xf bank_mask:0xf
    v_mfma_f32_16x16x32_bf16 v[92:95], v[224:227], a[140:143], v[92:95]
    ds_read_b128 a[136:139], v240 offset:14336
    v_mul_f32_dpp v88, v244, v88 row_newbcast:0 row_mask:0xf bank_mask:0xf
    v_mul_f32_dpp v89, v244, v89 row_newbcast:1 row_mask:0xf bank_mask:0xf
    v_mfma_f32_16x16x32_bf16 v[124:127], v[228:231], a[140:143], v[124:127]
    v_cvt_pk_bf16_f32 v228, v168, v169
    v_cvt_pk_bf16_f32 v229, v170, v171
    v_cvt_pk_bf16_f32 v230, v172, v173
    v_mfma_f32_16x16x32_bf16 v[156:159], v[232:235], a[140:143], v[156:159]
    v_cvt_pk_bf16_f32 v231, v174, v175
    v_cvt_pk_bf16_f32 v232, v176, v177
    v_cvt_pk_bf16_f32 v233, v178, v179
    v_mfma_f32_16x16x32_bf16 v[28:31], v[236:239], a[140:143], v[28:31]
    v_cvt_pk_bf16_f32 v236, v184, v185
    v_cvt_pk_bf16_f32 v237, v186, v187
    v_cvt_pk_bf16_f32 v234, v180, v181
    v_mfma_f32_16x16x32_bf16 v[200:203], a[144:147], a[16:19], 0
    ds_read_b128 a[140:143], v240 offset:15360
    v_mul_f32_dpp v92, v244, v92 row_newbcast:0 row_mask:0xf bank_mask:0xf
    v_cvt_pk_bf16_f32 v235, v182, v183
    v_mfma_f32_16x16x32_bf16 v[208:211], a[144:147], a[32:35], 0
    v_cvt_pk_bf16_f32 v238, v188, v189
    v_cvt_pk_bf16_f32 v239, v190, v191
    v_cvt_pk_bf16_f32 v64, v64, v68
    v_mfma_f32_16x16x32_bf16 v[216:219], a[144:147], a[48:51], 0
    v_cvt_pk_bf16_f32 v68, v65, v69
    v_cvt_pk_bf16_f32 v65, v72, v76
    v_cvt_pk_bf16_f32 v72, v66, v70
    s_waitcnt lgkmcnt(6)
    v_mfma_f32_16x16x32_bf16 v[200:203], a[148:151], a[20:23], v[200:203]
    ds_read_b128 a[144:147], v241 offset:0
    v_cvt_pk_bf16_f32 v76, v67, v71
    v_cvt_pk_bf16_f32 v66, v80, v84
    v_mfma_f32_16x16x32_bf16 v[208:211], a[148:151], a[36:39], v[208:211]
    v_cvt_pk_bf16_f32 v67, v88, v92
    v_mul_f32_dpp v93, v244, v93 row_newbcast:1 row_mask:0xf bank_mask:0xf
    v_cvt_pk_bf16_f32 v69, v73, v77
    v_mfma_f32_16x16x32_bf16 v[216:219], a[148:151], a[52:55], v[216:219]
    v_cvt_pk_bf16_f32 v70, v81, v85
    v_cvt_pk_bf16_f32 v71, v89, v93
    v_mul_f32_dpp v90, v244, v90 row_newbcast:2 row_mask:0xf bank_mask:0xf
    s_waitcnt lgkmcnt(6)
    v_mfma_f32_16x16x32_bf16 v[200:203], a[152:155], a[24:27], v[200:203]
    ds_read_b128 a[148:151], v241 offset:1024
    buffer_store_dwordx4 v[40:43], v248, s[16:19], s63 offen offset:512 sc0 sc1
    v_mul_f32_dpp v94, v244, v94 row_newbcast:2 row_mask:0xf bank_mask:0xf
    v_mfma_f32_16x16x32_bf16 v[208:211], a[152:155], a[40:43], v[208:211]
    v_cvt_pk_bf16_f32 v73, v74, v78
    v_cvt_pk_bf16_f32 v74, v82, v86
    v_cvt_pk_bf16_f32 v77, v75, v79
    v_mfma_f32_16x16x32_bf16 v[216:219], a[152:155], a[56:59], v[216:219]
    v_cvt_pk_bf16_f32 v75, v90, v94
    v_mul_f32_dpp v91, v244, v91 row_newbcast:3 row_mask:0xf bank_mask:0xf
    s_waitcnt lgkmcnt(3)
    v_mfma_f32_16x16x32_bf16 v[200:203], a[156:159], a[28:31], v[200:203]
    ds_read_b128 a[152:155], v241 offset:2048
    v_mul_f32_dpp v95, v244, v95 row_newbcast:3 row_mask:0xf bank_mask:0xf
    v_cvt_pk_bf16_f32 v78, v83, v87
    v_mfma_f32_16x16x32_bf16 v[208:211], a[156:159], a[44:47], v[208:211]
    v_cvt_pk_bf16_f32 v79, v91, v95
    v_mfma_f32_16x16x32_bf16 v[216:219], a[156:159], a[60:63], v[216:219]
    v_mfma_f32_16x16x32_bf16 v[204:207], a[128:131], a[16:19], 0
    ds_read_b128 a[156:159], v241 offset:3072
    v_mfma_f32_16x16x32_bf16 v[212:215], a[128:131], a[32:35], 0
    v_exp_f32 v200, v200
    v_mfma_f32_16x16x32_bf16 v[220:223], a[128:131], a[48:51], 0
    v_exp_f32 v201, v201
    v_mfma_f32_16x16x32_bf16 v[204:207], a[132:135], a[20:23], v[204:207]
    ds_read_b128 a[128:131], v241 offset:4096
    v_mfma_f32_16x16x32_bf16 v[212:215], a[132:135], a[36:39], v[212:215]
    v_exp_f32 v202, v202
    v_mfma_f32_16x16x32_bf16 v[220:223], a[132:135], a[52:55], v[220:223]
    v_exp_f32 v203, v203
    v_mfma_f32_16x16x32_bf16 v[204:207], a[136:139], a[24:27], v[204:207]
    ds_read_b128 a[132:135], v241 offset:5120
    v_mfma_f32_16x16x32_bf16 v[212:215], a[136:139], a[40:43], v[212:215]
    v_exp_f32 v208, v208
    v_mfma_f32_16x16x32_bf16 v[220:223], a[136:139], a[56:59], v[220:223]
    v_exp_f32 v209, v209
    s_waitcnt lgkmcnt(3)
    v_mfma_f32_16x16x32_bf16 v[204:207], a[140:143], a[28:31], v[204:207]
    ds_read_b128 a[136:139], v241 offset:6144
    v_mfma_f32_16x16x32_bf16 v[212:215], a[140:143], a[44:47], v[212:215]
    v_exp_f32 v210, v210
    v_mfma_f32_16x16x32_bf16 v[220:223], a[140:143], a[60:63], v[220:223]
    v_exp_f32 v211, v211
    v_smfmac_f32_16x16x64_bf16 a[192:195], a[212:215], v[224:231], v247
    v_exp_f32 v216, v216
    v_smfmac_f32_16x16x64_bf16 a[196:199], a[212:215], v[232:239], v247
    v_exp_f32 v217, v217
    v_mfma_f32_16x16x32_bf16 v[96:99], v[228:231], a[144:147], v[96:99]
    ds_read_b128 a[140:143], v241 offset:7168
    v_mfma_f32_16x16x32_bf16 v[128:131], v[232:235], a[144:147], v[128:131]
    v_exp_f32 v218, v218
    v_mfma_f32_16x16x32_bf16 v[0:3], v[236:239], a[144:147], v[0:3]
    buffer_store_dwordx4 v[64:67], v248, s[16:19], s64 offen offset:0 sc0 sc1
    v_mfma_f32_16x16x32_bf16 v[100:103], v[228:231], a[148:151], v[100:103]
    v_exp_f32 v219, v219
    ds_read_b128 a[144:147], v240 offset:16384
    v_mfma_f32_16x16x32_bf16 v[132:135], v[232:235], a[148:151], v[132:135]
    v_exp_f32 v204, v204
    v_mfma_f32_16x16x32_bf16 v[4:7], v[236:239], a[148:151], v[4:7]
    v_exp_f32 v205, v205
    v_mfma_f32_16x16x32_bf16 v[104:107], v[228:231], a[152:155], v[104:107]
    ds_read_b128 a[148:151], v240 offset:17408
    v_mfma_f32_16x16x32_bf16 v[136:139], v[232:235], a[152:155], v[136:139]
    v_exp_f32 v206, v206
    v_mfma_f32_16x16x32_bf16 v[8:11], v[236:239], a[152:155], v[8:11]
    v_exp_f32 v207, v207
    s_waitcnt lgkmcnt(3)
    v_mfma_f32_16x16x32_bf16 v[108:111], v[228:231], a[156:159], v[108:111]
    ds_read_b128 a[152:155], v240 offset:18432
    v_mfma_f32_16x16x32_bf16 v[140:143], v[232:235], a[156:159], v[140:143]
    v_exp_f32 v212, v212
    v_mfma_f32_16x16x32_bf16 v[12:15], v[236:239], a[156:159], v[12:15]
    v_exp_f32 v213, v213
    v_mfma_f32_16x16x32_bf16 v[112:115], v[228:231], a[128:131], v[112:115]
    ds_read_b128 a[156:159], v240 offset:19456
    v_mfma_f32_16x16x32_bf16 v[144:147], v[232:235], a[128:131], v[144:147]
    v_exp_f32 v214, v214
    v_mfma_f32_16x16x32_bf16 v[16:19], v[236:239], a[128:131], v[16:19]
    v_exp_f32 v215, v215
    v_mfma_f32_16x16x32_bf16 v[116:119], v[228:231], a[132:135], v[116:119]
    ds_read_b128 a[128:131], v240 offset:20480
    buffer_store_dwordx4 v[44:47], v248, s[16:19], s63 offen offset:768 sc0 sc1
    v_mfma_f32_16x16x32_bf16 v[148:151], v[232:235], a[132:135], v[148:151]
    v_exp_f32 v220, v220
    v_mfma_f32_16x16x32_bf16 v[20:23], v[236:239], a[132:135], v[20:23]
    v_exp_f32 v221, v221
    v_mfma_f32_16x16x32_bf16 v[120:123], v[228:231], a[136:139], v[120:123]
    ds_read_b128 a[132:135], v240 offset:21504
    v_mfma_f32_16x16x32_bf16 v[152:155], v[232:235], a[136:139], v[152:155]
    v_exp_f32 v222, v222
    buffer_store_dwordx4 v[68:71], v248, s[16:19], s64 offen offset:256 sc0 sc1
    v_mfma_f32_16x16x32_bf16 v[24:27], v[236:239], a[136:139], v[24:27]
    v_exp_f32 v223, v223
    s_waitcnt lgkmcnt(3)
    v_mfma_f32_16x16x32_bf16 v[124:127], v[228:231], a[140:143], v[124:127]
    ds_read_b128 a[136:139], v240 offset:22528
    v_cvt_pk_bf16_f32 v228, v200, v201
    v_cvt_pk_bf16_f32 v229, v202, v203
    v_mfma_f32_16x16x32_bf16 v[156:159], v[232:235], a[140:143], v[156:159]
    v_cvt_pk_bf16_f32 v230, v204, v205
    v_cvt_pk_bf16_f32 v231, v206, v207
    v_cvt_pk_bf16_f32 v232, v208, v209
    v_mfma_f32_16x16x32_bf16 v[28:31], v[236:239], a[140:143], v[28:31]
    v_cvt_pk_bf16_f32 v233, v210, v211
    v_cvt_pk_bf16_f32 v236, v216, v217
    v_cvt_pk_bf16_f32 v237, v218, v219
    v_mfma_f32_16x16x32_bf16 v[176:179], a[144:147], a[32:35], 0
    ds_read_b128 a[140:143], v240 offset:23552
    v_cvt_pk_bf16_f32 v234, v212, v213
    v_cvt_pk_bf16_f32 v235, v214, v215
    v_mfma_f32_16x16x32_bf16 v[184:187], a[144:147], a[48:51], 0
    v_cvt_pk_bf16_f32 v238, v220, v221
    v_cvt_pk_bf16_f32 v239, v222, v223
    v_mfma_f32_16x16x32_bf16 v[176:179], a[148:151], a[36:39], v[176:179]
    ds_read_b128 a[144:147], v241 offset:8192
    v_mfma_f32_16x16x32_bf16 v[184:187], a[148:151], a[52:55], v[184:187]
    v_mfma_f32_16x16x32_bf16 v[176:179], a[152:155], a[40:43], v[176:179]
    ds_read_b128 a[148:151], v241 offset:9216
    v_mfma_f32_16x16x32_bf16 v[184:187], a[152:155], a[56:59], v[184:187]
    s_waitcnt lgkmcnt(3)
    v_mfma_f32_16x16x32_bf16 v[176:179], a[156:159], a[44:47], v[176:179]
    ds_read_b128 a[152:155], v241 offset:10240
    v_mfma_f32_16x16x32_bf16 v[184:187], a[156:159], a[60:63], v[184:187]
    v_mfma_f32_16x16x32_bf16 v[180:183], a[128:131], a[32:35], 0
    ds_read_b128 a[156:159], v241 offset:11264
    v_mfma_f32_16x16x32_bf16 v[188:191], a[128:131], a[48:51], 0
    v_mfma_f32_16x16x32_bf16 v[180:183], a[132:135], a[36:39], v[180:183]
    s_nop 1
    v_exp_f32 v176, v176
    ds_read_b128 a[128:131], v241 offset:12288
    v_mfma_f32_16x16x32_bf16 v[188:191], a[132:135], a[52:55], v[188:191]
    v_exp_f32 v177, v177
    v_mfma_f32_16x16x32_bf16 v[180:183], a[136:139], a[40:43], v[180:183]
    ds_read_b128 a[132:135], v241 offset:13312
    v_mfma_f32_16x16x32_bf16 v[188:191], a[136:139], a[56:59], v[188:191]
    v_exp_f32 v178, v178
    s_waitcnt lgkmcnt(3)
    v_mfma_f32_16x16x32_bf16 v[180:183], a[140:143], a[44:47], v[180:183]
    ds_read_b128 a[136:139], v241 offset:14336
    buffer_store_dwordx4 v[72:75], v248, s[16:19], s64 offen offset:512 sc0 sc1
    v_mfma_f32_16x16x32_bf16 v[188:191], a[140:143], a[60:63], v[188:191]
    v_exp_f32 v179, v179
    v_smfmac_f32_16x16x64_bf16 a[192:195], a[212:215], v[224:231], v247
    v_exp_f32 v184, v184
    v_smfmac_f32_16x16x64_bf16 a[196:199], a[212:215], v[232:239], v247
    v_exp_f32 v185, v185
    v_mfma_f32_16x16x32_bf16 v[96:99], v[228:231], a[144:147], v[96:99]
    ds_read_b128 a[140:143], v241 offset:15360
    v_mfma_f32_16x16x32_bf16 v[128:131], v[232:235], a[144:147], v[128:131]
    v_exp_f32 v186, v186
    v_mfma_f32_16x16x32_bf16 v[0:3], v[236:239], a[144:147], v[0:3]
    v_accvgpr_read_b32 v250, a194
    v_accvgpr_read_b32 v251, a195
    v_mfma_f32_16x16x32_bf16 v[100:103], v[228:231], a[148:151], v[100:103]
    v_exp_f32 v187, v187
    ds_read_b128 a[144:147], v240 offset:24576
    v_mfma_f32_16x16x32_bf16 v[132:135], v[232:235], a[148:151], v[132:135]
    v_add_f32 v250, v250, v251
    v_mfma_f32_16x16x32_bf16 v[4:7], v[236:239], a[148:151], v[4:7]
    v_exp_f32 v180, v180
    v_subrev_u32 v246, s48, v250
    v_mfma_f32_16x16x32_bf16 v[104:107], v[228:231], a[152:155], v[104:107]
    ds_read_b128 a[148:151], v240 offset:25600
    v_rcp_f32 v245, v250
    v_mfma_f32_16x16x32_bf16 v[136:139], v[232:235], a[152:155], v[136:139]
    v_exp_f32 v181, v181
    v_max_u32 v253, v253, v246
    v_mfma_f32_16x16x32_bf16 v[8:11], v[236:239], a[152:155], v[8:11]
    ds_bpermute_b32 v245, v242, v245
    s_waitcnt lgkmcnt(4)
    v_mfma_f32_16x16x32_bf16 v[108:111], v[228:231], a[156:159], v[108:111]
    v_exp_f32 v182, v182
    ds_read_b128 a[152:155], v240 offset:26624
    v_mfma_f32_16x16x32_bf16 v[140:143], v[232:235], a[156:159], v[140:143]
    v_exp_f32 v183, v183
    v_mfma_f32_16x16x32_bf16 v[12:15], v[236:239], a[156:159], v[12:15]
    v_exp_f32 v188, v188
    v_mfma_f32_16x16x32_bf16 v[112:115], v[228:231], a[128:131], v[112:115]
    ds_read_b128 a[156:159], v240 offset:27648
    buffer_store_dwordx4 v[76:79], v248, s[16:19], s64 offen offset:768 sc0 sc1
    v_mfma_f32_16x16x32_bf16 v[144:147], v[232:235], a[128:131], v[144:147]
    v_exp_f32 v189, v189
    v_mfma_f32_16x16x32_bf16 v[16:19], v[236:239], a[128:131], v[16:19]
    v_exp_f32 v190, v190
    v_mfma_f32_16x16x32_bf16 v[116:119], v[228:231], a[132:135], v[116:119]
    ds_read_b128 a[128:131], v240 offset:28672
    v_mfma_f32_16x16x32_bf16 v[148:151], v[232:235], a[132:135], v[148:151]
    v_exp_f32 v191, v191
    s_waitcnt lgkmcnt(3)
    v_mul_f32_dpp v96, v245, v96 row_newbcast:0 row_mask:0xf bank_mask:0xf
    v_mfma_f32_16x16x32_bf16 v[20:23], v[236:239], a[132:135], v[20:23]
    v_mul_f32_dpp v97, v245, v97 row_newbcast:1 row_mask:0xf bank_mask:0xf
    v_mul_f32_dpp v98, v245, v98 row_newbcast:2 row_mask:0xf bank_mask:0xf
    v_mul_f32_dpp v99, v245, v99 row_newbcast:3 row_mask:0xf bank_mask:0xf
    v_mfma_f32_16x16x32_bf16 v[120:123], v[228:231], a[136:139], v[120:123]
    ds_read_b128 a[132:135], v240 offset:29696
    v_mul_f32_dpp v100, v245, v100 row_newbcast:0 row_mask:0xf bank_mask:0xf
    v_mul_f32_dpp v101, v245, v101 row_newbcast:1 row_mask:0xf bank_mask:0xf
    v_mfma_f32_16x16x32_bf16 v[152:155], v[232:235], a[136:139], v[152:155]
    v_mul_f32_dpp v102, v245, v102 row_newbcast:2 row_mask:0xf bank_mask:0xf
    v_mul_f32_dpp v103, v245, v103 row_newbcast:3 row_mask:0xf bank_mask:0xf
    v_mul_f32_dpp v104, v245, v104 row_newbcast:0 row_mask:0xf bank_mask:0xf
    v_mfma_f32_16x16x32_bf16 v[24:27], v[236:239], a[136:139], v[24:27]
    v_mul_f32_dpp v108, v245, v108 row_newbcast:0 row_mask:0xf bank_mask:0xf
    v_mul_f32_dpp v112, v245, v112 row_newbcast:0 row_mask:0xf bank_mask:0xf
    v_mfma_f32_16x16x32_bf16 v[124:127], v[228:231], a[140:143], v[124:127]
    ds_read_b128 a[136:139], v240 offset:30720
    v_mul_f32_dpp v116, v245, v116 row_newbcast:0 row_mask:0xf bank_mask:0xf
    v_mul_f32_dpp v105, v245, v105 row_newbcast:1 row_mask:0xf bank_mask:0xf
    v_mfma_f32_16x16x32_bf16 v[156:159], v[232:235], a[140:143], v[156:159]
    v_mul_f32_dpp v120, v245, v120 row_newbcast:0 row_mask:0xf bank_mask:0xf
    v_cvt_pk_bf16_f32 v232, v176, v177
    v_cvt_pk_bf16_f32 v233, v178, v179
    v_mfma_f32_16x16x32_bf16 v[28:31], v[236:239], a[140:143], v[28:31]
    v_cvt_pk_bf16_f32 v236, v184, v185
    v_cvt_pk_bf16_f32 v237, v186, v187
    v_cvt_pk_bf16_f32 v234, v180, v181
    v_mfma_f32_16x16x32_bf16 v[208:211], a[144:147], a[32:35], 0
    ds_read_b128 a[140:143], v240 offset:31744
    v_cvt_pk_bf16_f32 v235, v182, v183
    v_cvt_pk_bf16_f32 v238, v188, v189
    v_mfma_f32_16x16x32_bf16 v[216:219], a[144:147], a[48:51], 0
    v_mul_f32_dpp v124, v245, v124 row_newbcast:0 row_mask:0xf bank_mask:0xf
    v_cvt_pk_bf16_f32 v239, v190, v191
    v_cvt_pk_bf16_f32 v96, v96, v100
    v_mfma_f32_16x16x32_bf16 v[208:211], a[148:151], a[36:39], v[208:211]
    ds_read_b128 a[144:147], v241 offset:16384
    v_cvt_pk_bf16_f32 v100, v97, v101
    v_cvt_pk_bf16_f32 v97, v104, v108
    v_mfma_f32_16x16x32_bf16 v[216:219], a[148:151], a[52:55], v[216:219]
    v_cvt_pk_bf16_f32 v104, v98, v102
    v_cvt_pk_bf16_f32 v108, v99, v103
    v_cvt_pk_bf16_f32 v98, v112, v116
    s_waitcnt lgkmcnt(6)
    v_mfma_f32_16x16x32_bf16 v[208:211], a[152:155], a[40:43], v[208:211]
    ds_read_b128 a[148:151], v241 offset:17408
    v_cvt_pk_bf16_f32 v99, v120, v124
    v_mul_f32_dpp v109, v245, v109 row_newbcast:1 row_mask:0xf bank_mask:0xf
    v_mfma_f32_16x16x32_bf16 v[216:219], a[152:155], a[56:59], v[216:219]
    v_mul_f32_dpp v113, v245, v113 row_newbcast:1 row_mask:0xf bank_mask:0xf
    v_mul_f32_dpp v117, v245, v117 row_newbcast:1 row_mask:0xf bank_mask:0xf
    s_waitcnt lgkmcnt(3)
    v_mfma_f32_16x16x32_bf16 v[208:211], a[156:159], a[44:47], v[208:211]
    ds_read_b128 a[152:155], v241 offset:18432
    v_mul_f32_dpp v121, v245, v121 row_newbcast:1 row_mask:0xf bank_mask:0xf
    v_mul_f32_dpp v125, v245, v125 row_newbcast:1 row_mask:0xf bank_mask:0xf
    v_mfma_f32_16x16x32_bf16 v[216:219], a[156:159], a[60:63], v[216:219]
    v_cvt_pk_bf16_f32 v101, v105, v109
    v_cvt_pk_bf16_f32 v102, v113, v117
    v_cvt_pk_bf16_f32 v103, v121, v125
    v_mfma_f32_16x16x32_bf16 v[212:215], a[128:131], a[32:35], 0
    ds_read_b128 a[156:159], v241 offset:19456
    v_mul_f32_dpp v106, v245, v106 row_newbcast:2 row_mask:0xf bank_mask:0xf
    v_mul_f32_dpp v107, v245, v107 row_newbcast:3 row_mask:0xf bank_mask:0xf
    v_mfma_f32_16x16x32_bf16 v[220:223], a[128:131], a[48:51], 0
    v_mul_f32_dpp v110, v245, v110 row_newbcast:2 row_mask:0xf bank_mask:0xf
    v_mul_f32_dpp v111, v245, v111 row_newbcast:3 row_mask:0xf bank_mask:0xf
    v_mul_f32_dpp v114, v245, v114 row_newbcast:2 row_mask:0xf bank_mask:0xf
    v_mfma_f32_16x16x32_bf16 v[212:215], a[132:135], a[36:39], v[212:215]
    v_exp_f32 v208, v208
    ds_read_b128 a[128:131], v241 offset:20480
    v_mfma_f32_16x16x32_bf16 v[220:223], a[132:135], a[52:55], v[220:223]
    v_mul_f32_dpp v118, v245, v118 row_newbcast:2 row_mask:0xf bank_mask:0xf
    v_mul_f32_dpp v122, v245, v122 row_newbcast:2 row_mask:0xf bank_mask:0xf
    v_mul_f32_dpp v126, v245, v126 row_newbcast:2 row_mask:0xf bank_mask:0xf
    v_mfma_f32_16x16x32_bf16 v[212:215], a[136:139], a[40:43], v[212:215]
    v_exp_f32 v209, v209
    ds_read_b128 a[132:135], v241 offset:21504
    v_mfma_f32_16x16x32_bf16 v[220:223], a[136:139], a[56:59], v[220:223]
    v_cvt_pk_bf16_f32 v105, v106, v110
    v_cvt_pk_bf16_f32 v106, v114, v118
    s_waitcnt lgkmcnt(3)
    v_mfma_f32_16x16x32_bf16 v[212:215], a[140:143], a[44:47], v[212:215]
    v_exp_f32 v210, v210
    ds_read_b128 a[136:139], v241 offset:22528
    v_mfma_f32_16x16x32_bf16 v[220:223], a[140:143], a[60:63], v[220:223]
    v_cvt_pk_bf16_f32 v109, v107, v111
    v_cvt_pk_bf16_f32 v107, v122, v126
    v_mul_f32_dpp v115, v245, v115 row_newbcast:3 row_mask:0xf bank_mask:0xf
    v_smfmac_f32_16x16x64_bf16 a[196:199], a[212:215], v[232:239], v247
    v_exp_f32 v211, v211
    v_mul_f32_dpp v119, v245, v119 row_newbcast:3 row_mask:0xf bank_mask:0xf
    v_mfma_f32_16x16x32_bf16 v[128:131], v[232:235], a[144:147], v[128:131]
    ds_read_b128 a[140:143], v241 offset:23552
    buffer_store_dwordx4 v[96:99], v248, s[16:19], s65 offen offset:0 sc0 sc1
    v_mul_f32_dpp v123, v245, v123 row_newbcast:3 row_mask:0xf bank_mask:0xf
    v_mfma_f32_16x16x32_bf16 v[0:3], v[236:239], a[144:147], v[0:3]
    v_exp_f32 v216, v216
    v_mul_f32_dpp v127, v245, v127 row_newbcast:3 row_mask:0xf bank_mask:0xf
    v_mfma_f32_16x16x32_bf16 v[132:135], v[232:235], a[148:151], v[132:135]
    ds_read_b128 a[144:147], v240 offset:32768
    v_cvt_pk_bf16_f32 v110, v115, v119
    v_cvt_pk_bf16_f32 v111, v123, v127
    v_mfma_f32_16x16x32_bf16 v[4:7], v[236:239], a[148:151], v[4:7]
    v_exp_f32 v217, v217
    v_mfma_f32_16x16x32_bf16 v[136:139], v[232:235], a[152:155], v[136:139]
    ds_read_b128 a[148:151], v240 offset:33792
    v_mfma_f32_16x16x32_bf16 v[8:11], v[236:239], a[152:155], v[8:11]
    v_exp_f32 v218, v218
    s_waitcnt lgkmcnt(3)
    v_mfma_f32_16x16x32_bf16 v[140:143], v[232:235], a[156:159], v[140:143]
    ds_read_b128 a[152:155], v240 offset:34816
    v_mfma_f32_16x16x32_bf16 v[12:15], v[236:239], a[156:159], v[12:15]
    v_exp_f32 v219, v219
    v_mfma_f32_16x16x32_bf16 v[144:147], v[232:235], a[128:131], v[144:147]
    ds_read_b128 a[156:159], v241 offset:24576
    v_mfma_f32_16x16x32_bf16 v[16:19], v[236:239], a[128:131], v[16:19]
    v_exp_f32 v212, v212
    buffer_store_dwordx4 v[100:103], v248, s[16:19], s65 offen offset:256 sc0 sc1
    v_mfma_f32_16x16x32_bf16 v[148:151], v[232:235], a[132:135], v[148:151]
    ds_read_b128 a[128:131], v241 offset:25600
    v_mfma_f32_16x16x32_bf16 v[20:23], v[236:239], a[132:135], v[20:23]
    v_exp_f32 v213, v213
    v_mfma_f32_16x16x32_bf16 v[152:155], v[232:235], a[136:139], v[152:155]
    ds_read_b128 a[132:135], v241 offset:26624
    v_mfma_f32_16x16x32_bf16 v[24:27], v[236:239], a[136:139], v[24:27]
    v_exp_f32 v214, v214
    s_waitcnt lgkmcnt(3)
    v_mfma_f32_16x16x32_bf16 v[156:159], v[232:235], a[140:143], v[156:159]
    ds_read_b128 a[136:139], v241 offset:27648
    v_cvt_pk_bf16_f32 v232, v208, v209
    v_cvt_pk_bf16_f32 v233, v210, v211
    v_mfma_f32_16x16x32_bf16 v[28:31], v[236:239], a[140:143], v[28:31]
    v_exp_f32 v215, v215
    v_cvt_pk_bf16_f32 v236, v216, v217
    v_mfma_f32_16x16x32_bf16 v[184:187], a[144:147], a[48:51], 0
    ds_read_b128 a[140:143], v241 offset:28672
    v_cvt_pk_bf16_f32 v237, v218, v219
    v_cvt_pk_bf16_f32 v234, v212, v213
    v_mfma_f32_16x16x32_bf16 v[184:187], a[148:151], a[52:55], v[184:187]
    v_exp_f32 v220, v220
    ds_read_b128 a[144:147], v241 offset:29696
    v_mfma_f32_16x16x32_bf16 v[184:187], a[152:155], a[56:59], v[184:187]
    ds_read_b128 a[148:151], v241 offset:30720
    v_cvt_pk_bf16_f32 v235, v214, v215
    v_mfma_f32_16x16x32_bf16 v[184:187], a[252:255], a[60:63], v[184:187]
    v_exp_f32 v221, v221
    buffer_store_dwordx4 v[104:107], v248, s[16:19], s65 offen offset:512 sc0 sc1
    v_mfma_f32_16x16x32_bf16 v[188:191], a[248:251], a[48:51], 0
    v_cvt_pk_bf16_f32 v238, v220, v221
    v_mfma_f32_16x16x32_bf16 v[188:191], a[244:247], a[52:55], v[188:191]
    v_exp_f32 v222, v222
    v_exp_f32 v223, v223
    v_mfma_f32_16x16x32_bf16 v[188:191], a[240:243], a[56:59], v[188:191]
    v_cvt_pk_bf16_f32 v239, v222, v223
    v_mfma_f32_16x16x32_bf16 v[188:191], a[236:239], a[60:63], v[188:191]
    v_exp_f32 v184, v184
    v_smfmac_f32_16x16x64_bf16 a[196:199], a[212:215], v[232:239], v247
    v_exp_f32 v185, v185
    s_waitcnt lgkmcnt(3)
    v_mfma_f32_16x16x32_bf16 v[128:131], v[232:235], a[156:159], v[128:131]
    ds_read_b128 a[152:155], v241 offset:31744
    v_mfma_f32_16x16x32_bf16 v[0:3], v[236:239], a[156:159], v[0:3]
    v_exp_f32 v186, v186
    v_mfma_f32_16x16x32_bf16 v[132:135], v[232:235], a[128:131], v[132:135]
    v_exp_f32 v187, v187
    v_mfma_f32_16x16x32_bf16 v[4:7], v[236:239], a[128:131], v[4:7]
    v_accvgpr_read_b32 v249, a196
    v_accvgpr_read_b32 v251, a197
    v_mfma_f32_16x16x32_bf16 v[136:139], v[232:235], a[132:135], v[136:139]
    v_exp_f32 v188, v188
    buffer_store_dwordx4 v[108:111], v248, s[16:19], s65 offen offset:768 sc0 sc1
    v_mfma_f32_16x16x32_bf16 v[8:11], v[236:239], a[132:135], v[8:11]
    v_add_f32 v249, v249, v251
    v_mfma_f32_16x16x32_bf16 v[140:143], v[232:235], a[136:139], v[140:143]
    v_exp_f32 v189, v189
    v_subrev_u32 v246, s48, v249
    v_mfma_f32_16x16x32_bf16 v[12:15], v[236:239], a[136:139], v[12:15]
    v_rcp_f32 v244, v249
    s_waitcnt lgkmcnt(0)
    v_mfma_f32_16x16x32_bf16 v[144:147], v[232:235], a[140:143], v[144:147]
    v_exp_f32 v190, v190
    v_max_u32 v253, v253, v246
    v_mfma_f32_16x16x32_bf16 v[16:19], v[236:239], a[140:143], v[16:19]
    ds_bpermute_b32 v244, v242, v244
    v_mfma_f32_16x16x32_bf16 v[148:151], v[232:235], a[144:147], v[148:151]
    v_exp_f32 v191, v191
    v_mfma_f32_16x16x32_bf16 v[20:23], v[236:239], a[144:147], v[20:23]
    v_mfma_f32_16x16x32_bf16 v[152:155], v[232:235], a[148:151], v[152:155]
    v_mfma_f32_16x16x32_bf16 v[24:27], v[236:239], a[148:151], v[24:27]
    v_mfma_f32_16x16x32_bf16 v[156:159], v[232:235], a[152:155], v[156:159]
    v_mfma_f32_16x16x32_bf16 v[28:31], v[236:239], a[152:155], v[28:31]
    v_cvt_pk_bf16_f32 v236, v184, v185
    v_cvt_pk_bf16_f32 v237, v186, v187
    v_cvt_pk_bf16_f32 v238, v188, v189
    v_mfma_f32_16x16x32_bf16 v[216:219], a[232:235], a[48:51], 0
    v_cvt_pk_bf16_f32 v239, v190, v191
    v_mfma_f32_16x16x32_bf16 v[216:219], a[228:231], a[52:55], v[216:219]
    s_waitcnt lgkmcnt(0)
    v_mul_f32_dpp v128, v244, v128 row_newbcast:0 row_mask:0xf bank_mask:0xf
    v_mul_f32_dpp v129, v244, v129 row_newbcast:1 row_mask:0xf bank_mask:0xf
    v_mul_f32_dpp v130, v244, v130 row_newbcast:2 row_mask:0xf bank_mask:0xf
    v_mul_f32_dpp v131, v244, v131 row_newbcast:3 row_mask:0xf bank_mask:0xf
    v_mul_f32_dpp v132, v244, v132 row_newbcast:0 row_mask:0xf bank_mask:0xf
    v_mul_f32_dpp v133, v244, v133 row_newbcast:1 row_mask:0xf bank_mask:0xf
    v_mul_f32_dpp v134, v244, v134 row_newbcast:2 row_mask:0xf bank_mask:0xf
    v_mul_f32_dpp v135, v244, v135 row_newbcast:3 row_mask:0xf bank_mask:0xf
    v_mul_f32_dpp v136, v244, v136 row_newbcast:0 row_mask:0xf bank_mask:0xf
    v_mul_f32_dpp v140, v244, v140 row_newbcast:0 row_mask:0xf bank_mask:0xf
    v_mul_f32_dpp v144, v244, v144 row_newbcast:0 row_mask:0xf bank_mask:0xf
    v_mul_f32_dpp v148, v244, v148 row_newbcast:0 row_mask:0xf bank_mask:0xf
    v_mul_f32_dpp v152, v244, v152 row_newbcast:0 row_mask:0xf bank_mask:0xf
    v_mfma_f32_16x16x32_bf16 v[216:219], a[224:227], a[56:59], v[216:219]
    v_mul_f32_dpp v156, v244, v156 row_newbcast:0 row_mask:0xf bank_mask:0xf
    v_mul_f32_dpp v137, v244, v137 row_newbcast:1 row_mask:0xf bank_mask:0xf
    v_mul_f32_dpp v141, v244, v141 row_newbcast:1 row_mask:0xf bank_mask:0xf
    v_mfma_f32_16x16x32_bf16 v[216:219], a[220:223], a[60:63], v[216:219]
    v_mul_f32_dpp v145, v244, v145 row_newbcast:1 row_mask:0xf bank_mask:0xf
    v_mul_f32_dpp v149, v244, v149 row_newbcast:1 row_mask:0xf bank_mask:0xf
    v_mul_f32_dpp v153, v244, v153 row_newbcast:1 row_mask:0xf bank_mask:0xf
    v_mfma_f32_16x16x32_bf16 v[220:223], a[216:219], a[48:51], 0
    v_mul_f32_dpp v157, v244, v157 row_newbcast:1 row_mask:0xf bank_mask:0xf
    v_cvt_pk_bf16_f32 v128, v128, v132
    v_cvt_pk_bf16_f32 v132, v129, v133
    v_mfma_f32_16x16x32_bf16 v[220:223], a[208:211], a[52:55], v[220:223]
    v_cvt_pk_bf16_f32 v129, v136, v140
    v_cvt_pk_bf16_f32 v136, v130, v134
    v_cvt_pk_bf16_f32 v140, v131, v135
    v_cvt_pk_bf16_f32 v130, v144, v148
    v_cvt_pk_bf16_f32 v131, v152, v156
    v_mfma_f32_16x16x32_bf16 v[220:223], a[204:207], a[56:59], v[220:223]
    v_mul_f32_dpp v138, v244, v138 row_newbcast:2 row_mask:0xf bank_mask:0xf
    v_mul_f32_dpp v139, v244, v139 row_newbcast:3 row_mask:0xf bank_mask:0xf
    v_mul_f32_dpp v142, v244, v142 row_newbcast:2 row_mask:0xf bank_mask:0xf
    v_mfma_f32_16x16x32_bf16 v[220:223], a[200:203], a[60:63], v[220:223]
    v_exp_f32 v216, v216
    v_mul_f32_dpp v143, v244, v143 row_newbcast:3 row_mask:0xf bank_mask:0xf
    v_smfmac_f32_16x16x64_bf16 a[196:199], a[212:215], v[232:239], v247
    v_mul_f32_dpp v146, v244, v146 row_newbcast:2 row_mask:0xf bank_mask:0xf
    v_mul_f32_dpp v150, v244, v150 row_newbcast:2 row_mask:0xf bank_mask:0xf
    v_mul_f32_dpp v154, v244, v154 row_newbcast:2 row_mask:0xf bank_mask:0xf
    v_mul_f32_dpp v158, v244, v158 row_newbcast:2 row_mask:0xf bank_mask:0xf
    v_mfma_f32_16x16x32_bf16 v[0:3], v[236:239], a[188:191], v[0:3]
    v_exp_f32 v217, v217
    v_cvt_pk_bf16_f32 v133, v137, v141
    v_cvt_pk_bf16_f32 v134, v145, v149
    v_cvt_pk_bf16_f32 v135, v153, v157
    buffer_store_dwordx4 v[128:131], v248, s[16:19], s66 offen offset:0 sc0 sc1
    v_mfma_f32_16x16x32_bf16 v[4:7], v[236:239], a[184:187], v[4:7]
    v_mul_f32_dpp v147, v244, v147 row_newbcast:3 row_mask:0xf bank_mask:0xf
    v_mul_f32_dpp v151, v244, v151 row_newbcast:3 row_mask:0xf bank_mask:0xf
    v_mul_f32_dpp v155, v244, v155 row_newbcast:3 row_mask:0xf bank_mask:0xf
    v_mfma_f32_16x16x32_bf16 v[8:11], v[236:239], a[180:183], v[8:11]
    v_exp_f32 v218, v218
    v_mul_f32_dpp v159, v244, v159 row_newbcast:3 row_mask:0xf bank_mask:0xf
    v_mfma_f32_16x16x32_bf16 v[12:15], v[236:239], a[176:179], v[12:15]
    v_cvt_pk_bf16_f32 v137, v138, v142
    v_cvt_pk_bf16_f32 v138, v146, v150
    v_cvt_pk_bf16_f32 v141, v139, v143
    v_cvt_pk_bf16_f32 v139, v154, v158
    v_mfma_f32_16x16x32_bf16 v[16:19], v[236:239], a[172:175], v[16:19]
    v_exp_f32 v219, v219
    buffer_store_dwordx4 v[132:135], v248, s[16:19], s66 offen offset:256 sc0 sc1
    v_mfma_f32_16x16x32_bf16 v[20:23], v[236:239], a[168:171], v[20:23]
    v_cvt_pk_bf16_f32 v142, v147, v151
    v_cvt_pk_bf16_f32 v143, v155, v159
    buffer_store_dwordx4 v[136:139], v248, s[16:19], s66 offen offset:512 sc0 sc1
    v_mfma_f32_16x16x32_bf16 v[24:27], v[236:239], a[164:167], v[24:27]
    v_exp_f32 v220, v220
    v_exp_f32 v221, v221
    v_exp_f32 v222, v222
    v_exp_f32 v223, v223
    v_mfma_f32_16x16x32_bf16 v[28:31], v[236:239], a[160:163], v[28:31]
    v_cvt_pk_bf16_f32 v236, v216, v217
    v_cvt_pk_bf16_f32 v237, v218, v219
    v_cvt_pk_bf16_f32 v238, v220, v221
    v_cvt_pk_bf16_f32 v239, v222, v223
    s_nop 1
    v_smfmac_f32_16x16x64_bf16 a[196:199], a[212:215], v[232:239], v247
    v_mfma_f32_16x16x32_bf16 v[0:3], v[236:239], a[124:127], v[0:3]
    buffer_store_dwordx4 v[140:143], v248, s[16:19], s66 offen offset:768 sc0 sc1
    v_mfma_f32_16x16x32_bf16 v[4:7], v[236:239], a[120:123], v[4:7]
    v_mfma_f32_16x16x32_bf16 v[8:11], v[236:239], a[116:119], v[8:11]
    v_mfma_f32_16x16x32_bf16 v[12:15], v[236:239], a[112:115], v[12:15]
    s_nop 2
    v_accvgpr_read_b32 v250, a198
    v_accvgpr_read_b32 v251, a199
    v_mfma_f32_16x16x32_bf16 v[16:19], v[236:239], a[108:111], v[16:19]
    v_add_f32 v250, v250, v251
    v_mfma_f32_16x16x32_bf16 v[20:23], v[236:239], a[104:107], v[20:23]
    v_subrev_u32 v246, s48, v250
    v_rcp_f32 v245, v250
    v_mfma_f32_16x16x32_bf16 v[24:27], v[236:239], a[100:103], v[24:27]
    v_max_u32 v253, v253, v246
    ds_bpermute_b32 v245, v242, v245
    v_mfma_f32_16x16x32_bf16 v[28:31], v[236:239], a[96:99], v[28:31]
    s_waitcnt lgkmcnt(0)
    v_mul_f32_dpp v0, v245, v0 row_newbcast:0 row_mask:0xf bank_mask:0xf
    v_mul_f32_dpp v1, v245, v1 row_newbcast:1 row_mask:0xf bank_mask:0xf
    v_mul_f32_dpp v2, v245, v2 row_newbcast:2 row_mask:0xf bank_mask:0xf
    v_mul_f32_dpp v3, v245, v3 row_newbcast:3 row_mask:0xf bank_mask:0xf
    v_mul_f32_dpp v4, v245, v4 row_newbcast:0 row_mask:0xf bank_mask:0xf
    v_mul_f32_dpp v5, v245, v5 row_newbcast:1 row_mask:0xf bank_mask:0xf
    v_mul_f32_dpp v6, v245, v6 row_newbcast:2 row_mask:0xf bank_mask:0xf
    v_mul_f32_dpp v7, v245, v7 row_newbcast:3 row_mask:0xf bank_mask:0xf
    v_mul_f32_dpp v8, v245, v8 row_newbcast:0 row_mask:0xf bank_mask:0xf
    v_mul_f32_dpp v12, v245, v12 row_newbcast:0 row_mask:0xf bank_mask:0xf
    v_mul_f32_dpp v16, v245, v16 row_newbcast:0 row_mask:0xf bank_mask:0xf
    v_mul_f32_dpp v20, v245, v20 row_newbcast:0 row_mask:0xf bank_mask:0xf
    v_mul_f32_dpp v24, v245, v24 row_newbcast:0 row_mask:0xf bank_mask:0xf
    v_mul_f32_dpp v28, v245, v28 row_newbcast:0 row_mask:0xf bank_mask:0xf
    v_mul_f32_dpp v9, v245, v9 row_newbcast:1 row_mask:0xf bank_mask:0xf
    v_mul_f32_dpp v13, v245, v13 row_newbcast:1 row_mask:0xf bank_mask:0xf
    v_mul_f32_dpp v17, v245, v17 row_newbcast:1 row_mask:0xf bank_mask:0xf
    v_mul_f32_dpp v21, v245, v21 row_newbcast:1 row_mask:0xf bank_mask:0xf
    v_mul_f32_dpp v25, v245, v25 row_newbcast:1 row_mask:0xf bank_mask:0xf
    v_mul_f32_dpp v29, v245, v29 row_newbcast:1 row_mask:0xf bank_mask:0xf
    v_mul_f32_dpp v10, v245, v10 row_newbcast:2 row_mask:0xf bank_mask:0xf
    v_mul_f32_dpp v11, v245, v11 row_newbcast:3 row_mask:0xf bank_mask:0xf
    v_mul_f32_dpp v14, v245, v14 row_newbcast:2 row_mask:0xf bank_mask:0xf
    v_mul_f32_dpp v15, v245, v15 row_newbcast:3 row_mask:0xf bank_mask:0xf
    v_mul_f32_dpp v18, v245, v18 row_newbcast:2 row_mask:0xf bank_mask:0xf
    v_mul_f32_dpp v22, v245, v22 row_newbcast:2 row_mask:0xf bank_mask:0xf
    v_mul_f32_dpp v26, v245, v26 row_newbcast:2 row_mask:0xf bank_mask:0xf
    v_mul_f32_dpp v30, v245, v30 row_newbcast:2 row_mask:0xf bank_mask:0xf
    v_mul_f32_dpp v19, v245, v19 row_newbcast:3 row_mask:0xf bank_mask:0xf
    v_mul_f32_dpp v23, v245, v23 row_newbcast:3 row_mask:0xf bank_mask:0xf
    v_mul_f32_dpp v27, v245, v27 row_newbcast:3 row_mask:0xf bank_mask:0xf
    v_mul_f32_dpp v31, v245, v31 row_newbcast:3 row_mask:0xf bank_mask:0xf
    v_cvt_pk_bf16_f32 v0, v0, v4
    v_cvt_pk_bf16_f32 v4, v1, v5
    v_cvt_pk_bf16_f32 v1, v8, v12
    v_cvt_pk_bf16_f32 v8, v2, v6
    v_cvt_pk_bf16_f32 v12, v3, v7
    v_cvt_pk_bf16_f32 v2, v16, v20
    v_cvt_pk_bf16_f32 v3, v24, v28
    v_cvt_pk_bf16_f32 v5, v9, v13
    v_cvt_pk_bf16_f32 v6, v17, v21
    v_cvt_pk_bf16_f32 v7, v25, v29
    v_cvt_pk_bf16_f32 v9, v10, v14
    v_cvt_pk_bf16_f32 v10, v18, v22
    v_cvt_pk_bf16_f32 v13, v11, v15
    v_cvt_pk_bf16_f32 v11, v26, v30
    v_cvt_pk_bf16_f32 v14, v19, v23
    v_cvt_pk_bf16_f32 v15, v27, v31
    buffer_store_dwordx4 v[0:3], v248, s[16:19], s67 offen offset:0 sc0 sc1
    buffer_store_dwordx4 v[4:7], v248, s[16:19], s67 offen offset:256 sc0 sc1
    buffer_store_dwordx4 v[8:11], v248, s[16:19], s67 offen offset:512 sc0 sc1
    buffer_store_dwordx4 v[12:15], v248, s[16:19], s67 offen offset:768 sc0 sc1
    v_cmp_le_u32 vcc, s49, v253
    s_cbranch_vccz L_done
    s_waitcnt vmcnt(0)
    s_mov_b32 s50, 0
L_slow:
    buffer_load_dwordx4 v[128:131], v243, s[12:15], s50 offen offset:0 nt
    buffer_load_dwordx4 v[132:135], v243, s[12:15], s50 offen offset:64 nt
    buffer_load_dwordx4 v[136:139], v243, s[12:15], s50 offen offset:128 nt
    buffer_load_dwordx4 v[140:143], v243, s[12:15], s50 offen offset:192 nt
    s_waitcnt vmcnt(0)
    ds_read_b128 v[144:147], v240 offset:0
    ds_read_b128 v[148:151], v240 offset:1024
    ds_read_b128 v[152:155], v240 offset:2048
    ds_read_b128 v[156:159], v240 offset:3072
    ds_read_b128 v[160:163], v240 offset:4096
    ds_read_b128 v[164:167], v240 offset:5120
    ds_read_b128 v[168:171], v240 offset:6144
    s_waitcnt lgkmcnt(6)
    v_mfma_f32_16x16x32_bf16 v[0:3], v[144:147], v[128:131], 0
    ds_read_b128 v[172:175], v240 offset:7168
    s_waitcnt lgkmcnt(6)
    v_mfma_f32_16x16x32_bf16 v[0:3], v[148:151], v[132:135], v[0:3]
    ds_read_b128 v[144:147], v240 offset:8192
    s_waitcnt lgkmcnt(6)
    v_mfma_f32_16x16x32_bf16 v[0:3], v[152:155], v[136:139], v[0:3]
    ds_read_b128 v[148:151], v240 offset:9216
    s_waitcnt lgkmcnt(6)
    v_mfma_f32_16x16x32_bf16 v[0:3], v[156:159], v[140:143], v[0:3]
    ds_read_b128 v[152:155], v240 offset:10240
    s_waitcnt lgkmcnt(6)
    v_mfma_f32_16x16x32_bf16 v[4:7], v[160:163], v[128:131], 0
    ds_read_b128 v[156:159], v240 offset:11264
    s_waitcnt lgkmcnt(6)
    v_mfma_f32_16x16x32_bf16 v[4:7], v[164:167], v[132:135], v[4:7]
    ds_read_b128 v[160:163], v240 offset:12288
    s_waitcnt lgkmcnt(6)
    v_mfma_f32_16x16x32_bf16 v[4:7], v[168:171], v[136:139], v[4:7]
    ds_read_b128 v[164:167], v240 offset:13312
    s_waitcnt lgkmcnt(6)
    v_mfma_f32_16x16x32_bf16 v[4:7], v[172:175], v[140:143], v[4:7]
    ds_read_b128 v[168:171], v240 offset:14336
    s_waitcnt lgkmcnt(6)
    v_mfma_f32_16x16x32_bf16 v[8:11], v[144:147], v[128:131], 0
    ds_read_b128 v[172:175], v240 offset:15360
    s_waitcnt lgkmcnt(6)
    v_mfma_f32_16x16x32_bf16 v[8:11], v[148:151], v[132:135], v[8:11]
    ds_read_b128 v[144:147], v240 offset:16384
    s_waitcnt lgkmcnt(6)
    v_mfma_f32_16x16x32_bf16 v[8:11], v[152:155], v[136:139], v[8:11]
    ds_read_b128 v[148:151], v240 offset:17408
    s_waitcnt lgkmcnt(6)
    v_mfma_f32_16x16x32_bf16 v[8:11], v[156:159], v[140:143], v[8:11]
    ds_read_b128 v[152:155], v240 offset:18432
    s_waitcnt lgkmcnt(6)
    v_mfma_f32_16x16x32_bf16 v[12:15], v[160:163], v[128:131], 0
    ds_read_b128 v[156:159], v240 offset:19456
    s_waitcnt lgkmcnt(6)
    v_mfma_f32_16x16x32_bf16 v[12:15], v[164:167], v[132:135], v[12:15]
    ds_read_b128 v[160:163], v240 offset:20480
    s_waitcnt lgkmcnt(6)
    v_mfma_f32_16x16x32_bf16 v[12:15], v[168:171], v[136:139], v[12:15]
    ds_read_b128 v[164:167], v240 offset:21504
    s_waitcnt lgkmcnt(6)
    v_mfma_f32_16x16x32_bf16 v[12:15], v[172:175], v[140:143], v[12:15]
    ds_read_b128 v[168:171], v240 offset:22528
    s_waitcnt lgkmcnt(6)
    v_mfma_f32_16x16x32_bf16 v[16:19], v[144:147], v[128:131], 0
    ds_read_b128 v[172:175], v240 offset:23552
    s_waitcnt lgkmcnt(6)
    v_mfma_f32_16x16x32_bf16 v[16:19], v[148:151], v[132:135], v[16:19]
    ds_read_b128 v[144:147], v240 offset:24576
    s_waitcnt lgkmcnt(6)
    v_mfma_f32_16x16x32_bf16 v[16:19], v[152:155], v[136:139], v[16:19]
    ds_read_b128 v[148:151], v240 offset:25600
    s_waitcnt lgkmcnt(6)
    v_mfma_f32_16x16x32_bf16 v[16:19], v[156:159], v[140:143], v[16:19]
    ds_read_b128 v[152:155], v240 offset:26624
    s_waitcnt lgkmcnt(6)
    v_mfma_f32_16x16x32_bf16 v[20:23], v[160:163], v[128:131], 0
    ds_read_b128 v[156:159], v240 offset:27648
    s_waitcnt lgkmcnt(6)
    v_mfma_f32_16x16x32_bf16 v[20:23], v[164:167], v[132:135], v[20:23]
    ds_read_b128 v[160:163], v240 offset:28672
    s_waitcnt lgkmcnt(6)
    v_mfma_f32_16x16x32_bf16 v[20:23], v[168:171], v[136:139], v[20:23]
    ds_read_b128 v[164:167], v240 offset:29696
    s_waitcnt lgkmcnt(6)
    v_mfma_f32_16x16x32_bf16 v[20:23], v[172:175], v[140:143], v[20:23]
    ds_read_b128 v[168:171], v240 offset:30720
    s_waitcnt lgkmcnt(6)
    v_mfma_f32_16x16x32_bf16 v[24:27], v[144:147], v[128:131], 0
    ds_read_b128 v[172:175], v240 offset:31744
    s_waitcnt lgkmcnt(6)
    v_mfma_f32_16x16x32_bf16 v[24:27], v[148:151], v[132:135], v[24:27]
    ds_read_b128 v[144:147], v240 offset:32768
    s_waitcnt lgkmcnt(6)
    v_mfma_f32_16x16x32_bf16 v[24:27], v[152:155], v[136:139], v[24:27]
    ds_read_b128 v[148:151], v240 offset:33792
    s_waitcnt lgkmcnt(6)
    v_mfma_f32_16x16x32_bf16 v[24:27], v[156:159], v[140:143], v[24:27]
    ds_read_b128 v[152:155], v240 offset:34816
    s_waitcnt lgkmcnt(6)
    v_mfma_f32_16x16x32_bf16 v[28:31], v[160:163], v[128:131], 0
    ds_read_b128 v[156:159], v240 offset:35840
    s_waitcnt lgkmcnt(6)
    v_mfma_f32_16x16x32_bf16 v[28:31], v[164:167], v[132:135], v[28:31]
    ds_read_b128 v[160:163], v240 offset:36864
    s_waitcnt lgkmcnt(6)
    v_mfma_f32_16x16x32_bf16 v[28:31], v[168:171], v[136:139], v[28:31]
    ds_read_b128 v[164:167], v240 offset:37888
    s_waitcnt lgkmcnt(6)
    v_mfma_f32_16x16x32_bf16 v[28:31], v[172:175], v[140:143], v[28:31]
    ds_read_b128 v[168:171], v240 offset:38912
    s_waitcnt lgkmcnt(6)
    v_mfma_f32_16x16x32_bf16 v[32:35], v[144:147], v[128:131], 0
    ds_read_b128 v[172:175], v240 offset:39936
    s_waitcnt lgkmcnt(6)
    v_mfma_f32_16x16x32_bf16 v[32:35], v[148:151], v[132:135], v[32:35]
    ds_read_b128 v[144:147], v240 offset:40960
    s_waitcnt lgkmcnt(6)
    v_mfma_f32_16x16x32_bf16 v[32:35], v[152:155], v[136:139], v[32:35]
    ds_read_b128 v[148:151], v240 offset:41984
    s_waitcnt lgkmcnt(6)
    v_mfma_f32_16x16x32_bf16 v[32:35], v[156:159], v[140:143], v[32:35]
    ds_read_b128 v[152:155], v240 offset:43008
    s_waitcnt lgkmcnt(6)
    v_mfma_f32_16x16x32_bf16 v[36:39], v[160:163], v[128:131], 0
    ds_read_b128 v[156:159], v240 offset:44032
    s_waitcnt lgkmcnt(6)
    v_mfma_f32_16x16x32_bf16 v[36:39], v[164:167], v[132:135], v[36:39]
    ds_read_b128 v[160:163], v240 offset:45056
    s_waitcnt lgkmcnt(6)
    v_mfma_f32_16x16x32_bf16 v[36:39], v[168:171], v[136:139], v[36:39]
    ds_read_b128 v[164:167], v240 offset:46080
    s_waitcnt lgkmcnt(6)
    v_mfma_f32_16x16x32_bf16 v[36:39], v[172:175], v[140:143], v[36:39]
    ds_read_b128 v[168:171], v240 offset:47104
    s_waitcnt lgkmcnt(6)
    v_mfma_f32_16x16x32_bf16 v[40:43], v[144:147], v[128:131], 0
    ds_read_b128 v[172:175], v240 offset:48128
    s_waitcnt lgkmcnt(6)
    v_mfma_f32_16x16x32_bf16 v[40:43], v[148:151], v[132:135], v[40:43]
    ds_read_b128 v[144:147], v240 offset:49152
    s_waitcnt lgkmcnt(6)
    v_mfma_f32_16x16x32_bf16 v[40:43], v[152:155], v[136:139], v[40:43]
    ds_read_b128 v[148:151], v240 offset:50176
    s_waitcnt lgkmcnt(6)
    v_mfma_f32_16x16x32_bf16 v[40:43], v[156:159], v[140:143], v[40:43]
    ds_read_b128 v[152:155], v240 offset:51200
    s_waitcnt lgkmcnt(6)
    v_mfma_f32_16x16x32_bf16 v[44:47], v[160:163], v[128:131], 0
    ds_read_b128 v[156:159], v240 offset:52224
    s_waitcnt lgkmcnt(6)
    v_mfma_f32_16x16x32_bf16 v[44:47], v[164:167], v[132:135], v[44:47]
    ds_read_b128 v[160:163], v240 offset:53248
    s_waitcnt lgkmcnt(6)
    v_mfma_f32_16x16x32_bf16 v[44:47], v[168:171], v[136:139], v[44:47]
    ds_read_b128 v[164:167], v240 offset:54272
    s_waitcnt lgkmcnt(6)
    v_mfma_f32_16x16x32_bf16 v[44:47], v[172:175], v[140:143], v[44:47]
    ds_read_b128 v[168:171], v240 offset:55296
    s_waitcnt lgkmcnt(6)
    v_mfma_f32_16x16x32_bf16 v[48:51], v[144:147], v[128:131], 0
    ds_read_b128 v[172:175], v240 offset:56320
    s_waitcnt lgkmcnt(6)
    v_mfma_f32_16x16x32_bf16 v[48:51], v[148:151], v[132:135], v[48:51]
    ds_read_b128 v[144:147], v240 offset:57344
    s_waitcnt lgkmcnt(6)
    v_mfma_f32_16x16x32_bf16 v[48:51], v[152:155], v[136:139], v[48:51]
    ds_read_b128 v[148:151], v240 offset:58368
    s_waitcnt lgkmcnt(6)
    v_mfma_f32_16x16x32_bf16 v[48:51], v[156:159], v[140:143], v[48:51]
    ds_read_b128 v[152:155], v240 offset:59392
    s_waitcnt lgkmcnt(6)
    v_mfma_f32_16x16x32_bf16 v[52:55], v[160:163], v[128:131], 0
    ds_read_b128 v[156:159], v240 offset:60416
    s_waitcnt lgkmcnt(6)
    v_mfma_f32_16x16x32_bf16 v[52:55], v[164:167], v[132:135], v[52:55]
    ds_read_b128 v[160:163], v240 offset:61440
    s_waitcnt lgkmcnt(6)
    v_mfma_f32_16x16x32_bf16 v[52:55], v[168:171], v[136:139], v[52:55]
    ds_read_b128 v[164:167], v240 offset:62464
    s_waitcnt lgkmcnt(6)
    v_mfma_f32_16x16x32_bf16 v[52:55], v[172:175], v[140:143], v[52:55]
    ds_read_b128 v[168:171], v240 offset:63488
    s_waitcnt lgkmcnt(6)
    v_mfma_f32_16x16x32_bf16 v[56:59], v[144:147], v[128:131], 0
    ds_read_b128 v[172:175], v240 offset:64512
    s_waitcnt lgkmcnt(6)
    v_mfma_f32_16x16x32_bf16 v[56:59], v[148:151], v[132:135], v[56:59]
    s_waitcnt lgkmcnt(5)
    v_mfma_f32_16x16x32_bf16 v[56:59], v[152:155], v[136:139], v[56:59]
    s_waitcnt lgkmcnt(4)
    v_mfma_f32_16x16x32_bf16 v[56:59], v[156:159], v[140:143], v[56:59]
    s_waitcnt lgkmcnt(3)
    v_mfma_f32_16x16x32_bf16 v[60:63], v[160:163], v[128:131], 0
    s_waitcnt lgkmcnt(2)
    v_mfma_f32_16x16x32_bf16 v[60:63], v[164:167], v[132:135], v[60:63]
    s_waitcnt lgkmcnt(1)
    v_mfma_f32_16x16x32_bf16 v[60:63], v[168:171], v[136:139], v[60:63]
    s_waitcnt lgkmcnt(0)
    v_mfma_f32_16x16x32_bf16 v[60:63], v[172:175], v[140:143], v[60:63]
    s_nop 15
    v_max3_f32 v200, v0, v1, v2
    v_max3_f32 v200, v200, v3, v4
    v_max3_f32 v200, v200, v5, v6
    v_max3_f32 v200, v200, v7, v8
    v_max3_f32 v200, v200, v9, v10
    v_max3_f32 v200, v200, v11, v12
    v_max3_f32 v200, v200, v13, v14
    v_max3_f32 v200, v200, v15, v16
    v_max3_f32 v200, v200, v17, v18
    v_max3_f32 v200, v200, v19, v20
    v_max3_f32 v200, v200, v21, v22
    v_max3_f32 v200, v200, v23, v24
    v_max3_f32 v200, v200, v25, v26
    v_max3_f32 v200, v200, v27, v28
    v_max3_f32 v200, v200, v29, v30
    v_max3_f32 v200, v200, v31, v32
    v_max3_f32 v200, v200, v33, v34
    v_max3_f32 v200, v200, v35, v36
    v_max3_f32 v200, v200, v37, v38
    v_max3_f32 v200, v200, v39, v40
    v_max3_f32 v200, v200, v41, v42
    v_max3_f32 v200, v200, v43, v44
    v_max3_f32 v200, v200, v45, v46
    v_max3_f32 v200, v200, v47, v48
    v_max3_f32 v200, v200, v49, v50
    v_max3_f32 v200, v200, v51, v52
    v_max3_f32 v200, v200, v53, v54
    v_max3_f32 v200, v200, v55, v56
    v_max3_f32 v200, v200, v57, v58
    v_max3_f32 v200, v200, v59, v60
    v_max3_f32 v200, v200, v61, v62
    v_max_f32 v200, v200, v63
    v_mov_b32 v201, v200
    s_nop 1
    v_permlane16_swap_b32 v200, v201
    s_nop 1
    v_max_f32 v200, v200, v201
    v_mov_b32 v201, v200
    s_nop 1
    v_permlane32_swap_b32 v200, v201
    s_nop 1
    v_max_f32 v200, v200, v201
    v_mov_b32 v202, 0
    v_sub_f32 v0, v0, v200
    v_sub_f32 v1, v1, v200
    v_sub_f32 v2, v2, v200
    v_sub_f32 v3, v3, v200
    v_sub_f32 v4, v4, v200
    v_sub_f32 v5, v5, v200
    v_sub_f32 v6, v6, v200
    v_sub_f32 v7, v7, v200
    v_sub_f32 v8, v8, v200
    v_sub_f32 v9, v9, v200
    v_sub_f32 v10, v10, v200
    v_sub_f32 v11, v11, v200
    v_sub_f32 v12, v12, v200
    v_sub_f32 v13, v13, v200
    v_sub_f32 v14, v14, v200
    v_sub_f32 v15, v15, v200
    v_sub_f32 v16, v16, v200
    v_sub_f32 v17, v17, v200
    v_sub_f32 v18, v18, v200
    v_sub_f32 v19, v19, v200
    v_sub_f32 v20, v20, v200
    v_sub_f32 v21, v21, v200
    v_sub_f32 v22, v22, v200
    v_sub_f32 v23, v23, v200
    v_sub_f32 v24, v24, v200
    v_sub_f32 v25, v25, v200
    v_sub_f32 v26, v26, v200
    v_sub_f32 v27, v27, v200
    v_sub_f32 v28, v28, v200
    v_sub_f32 v29, v29, v200
    v_sub_f32 v30, v30, v200
    v_sub_f32 v31, v31, v200
    v_sub_f32 v32, v32, v200
    v_sub_f32 v33, v33, v200
    v_sub_f32 v34, v34, v200
    v_sub_f32 v35, v35, v200
    v_sub_f32 v36, v36, v200
    v_sub_f32 v37, v37, v200
    v_sub_f32 v38, v38, v200
    v_sub_f32 v39, v39, v200
    v_sub_f32 v40, v40, v200
    v_sub_f32 v41, v41, v200
    v_sub_f32 v42, v42, v200
    v_sub_f32 v43, v43, v200
    v_sub_f32 v44, v44, v200
    v_sub_f32 v45, v45, v200
    v_sub_f32 v46, v46, v200
    v_sub_f32 v47, v47, v200
    v_sub_f32 v48, v48, v200
    v_sub_f32 v49, v49, v200
    v_sub_f32 v50, v50, v200
    v_sub_f32 v51, v51, v200
    v_sub_f32 v52, v52, v200
    v_sub_f32 v53, v53, v200
    v_sub_f32 v54, v54, v200
    v_sub_f32 v55, v55, v200
    v_sub_f32 v56, v56, v200
    v_sub_f32 v57, v57, v200
    v_sub_f32 v58, v58, v200
    v_sub_f32 v59, v59, v200
    v_sub_f32 v60, v60, v200
    v_sub_f32 v61, v61, v200
    v_sub_f32 v62, v62, v200
    v_sub_f32 v63, v63, v200
    v_exp_f32 v0, v0
    v_exp_f32 v1, v1
    v_exp_f32 v2, v2
    v_exp_f32 v3, v3
    v_exp_f32 v4, v4
    v_exp_f32 v5, v5
    v_exp_f32 v6, v6
    v_exp_f32 v7, v7
    v_exp_f32 v8, v8
    v_exp_f32 v9, v9
    v_exp_f32 v10, v10
    v_exp_f32 v11, v11
    v_exp_f32 v12, v12
    v_exp_f32 v13, v13
    v_exp_f32 v14, v14
    v_exp_f32 v15, v15
    v_exp_f32 v16, v16
    v_exp_f32 v17, v17
    v_exp_f32 v18, v18
    v_exp_f32 v19, v19
    v_exp_f32 v20, v20
    v_exp_f32 v21, v21
    v_exp_f32 v22, v22
    v_exp_f32 v23, v23
    v_exp_f32 v24, v24
    v_exp_f32 v25, v25
    v_exp_f32 v26, v26
    v_exp_f32 v27, v27
    v_exp_f32 v28, v28
    v_exp_f32 v29, v29
    v_exp_f32 v30, v30
    v_exp_f32 v31, v31
    v_exp_f32 v32, v32
    v_exp_f32 v33, v33
    v_exp_f32 v34, v34
    v_exp_f32 v35, v35
    v_exp_f32 v36, v36
    v_exp_f32 v37, v37
    v_exp_f32 v38, v38
    v_exp_f32 v39, v39
    v_exp_f32 v40, v40
    v_exp_f32 v41, v41
    v_exp_f32 v42, v42
    v_exp_f32 v43, v43
    v_exp_f32 v44, v44
    v_exp_f32 v45, v45
    v_exp_f32 v46, v46
    v_exp_f32 v47, v47
    v_exp_f32 v48, v48
    v_exp_f32 v49, v49
    v_exp_f32 v50, v50
    v_exp_f32 v51, v51
    v_exp_f32 v52, v52
    v_exp_f32 v53, v53
    v_exp_f32 v54, v54
    v_exp_f32 v55, v55
    v_exp_f32 v56, v56
    v_exp_f32 v57, v57
    v_exp_f32 v58, v58
    v_exp_f32 v59, v59
    v_exp_f32 v60, v60
    v_exp_f32 v61, v61
    v_exp_f32 v62, v62
    v_exp_f32 v63, v63
    s_nop 1
    v_add_f32 v202, v202, v0
    v_add_f32 v202, v202, v1
    v_add_f32 v202, v202, v2
    v_add_f32 v202, v202, v3
    v_add_f32 v202, v202, v4
    v_add_f32 v202, v202, v5
    v_add_f32 v202, v202, v6
    v_add_f32 v202, v202, v7
    v_add_f32 v202, v202, v8
    v_add_f32 v202, v202, v9
    v_add_f32 v202, v202, v10
    v_add_f32 v202, v202, v11
    v_add_f32 v202, v202, v12
    v_add_f32 v202, v202, v13
    v_add_f32 v202, v202, v14
    v_add_f32 v202, v202, v15
    v_add_f32 v202, v202, v16
    v_add_f32 v202, v202, v17
    v_add_f32 v202, v202, v18
    v_add_f32 v202, v202, v19
    v_add_f32 v202, v202, v20
    v_add_f32 v202, v202, v21
    v_add_f32 v202, v202, v22
    v_add_f32 v202, v202, v23
    v_add_f32 v202, v202, v24
    v_add_f32 v202, v202, v25
    v_add_f32 v202, v202, v26
    v_add_f32 v202, v202, v27
    v_add_f32 v202, v202, v28
    v_add_f32 v202, v202, v29
    v_add_f32 v202, v202, v30
    v_add_f32 v202, v202, v31
    v_add_f32 v202, v202, v32
    v_add_f32 v202, v202, v33
    v_add_f32 v202, v202, v34
    v_add_f32 v202, v202, v35
    v_add_f32 v202, v202, v36
    v_add_f32 v202, v202, v37
    v_add_f32 v202, v202, v38
    v_add_f32 v202, v202, v39
    v_add_f32 v202, v202, v40
    v_add_f32 v202, v202, v41
    v_add_f32 v202, v202, v42
    v_add_f32 v202, v202, v43
    v_add_f32 v202, v202, v44
    v_add_f32 v202, v202, v45
    v_add_f32 v202, v202, v46
    v_add_f32 v202, v202, v47
    v_add_f32 v202, v202, v48
    v_add_f32 v202, v202, v49
    v_add_f32 v202, v202, v50
    v_add_f32 v202, v202, v51
    v_add_f32 v202, v202, v52
    v_add_f32 v202, v202, v53
    v_add_f32 v202, v202, v54
    v_add_f32 v202, v202, v55
    v_add_f32 v202, v202, v56
    v_add_f32 v202, v202, v57
    v_add_f32 v202, v202, v58
    v_add_f32 v202, v202, v59
    v_add_f32 v202, v202, v60
    v_add_f32 v202, v202, v61
    v_add_f32 v202, v202, v62
    v_add_f32 v202, v202, v63
    v_mov_b32 v201, v202
    s_nop 1
    v_permlane16_swap_b32 v202, v201
    s_nop 1
    v_add_f32 v202, v202, v201
    v_mov_b32 v201, v202
    s_nop 1
    v_permlane32_swap_b32 v202, v201
    s_nop 1
    v_add_f32 v202, v202, v201
    v_rcp_f32 v202, v202
    s_nop 1
    v_mul_f32 v0, v0, v202
    v_mul_f32 v1, v1, v202
    v_mul_f32 v2, v2, v202
    v_mul_f32 v3, v3, v202
    v_mul_f32 v4, v4, v202
    v_mul_f32 v5, v5, v202
    v_mul_f32 v6, v6, v202
    v_mul_f32 v7, v7, v202
    v_mul_f32 v8, v8, v202
    v_mul_f32 v9, v9, v202
    v_mul_f32 v10, v10, v202
    v_mul_f32 v11, v11, v202
    v_mul_f32 v12, v12, v202
    v_mul_f32 v13, v13, v202
    v_mul_f32 v14, v14, v202
    v_mul_f32 v15, v15, v202
    v_mul_f32 v16, v16, v202
    v_mul_f32 v17, v17, v202
    v_mul_f32 v18, v18, v202
    v_mul_f32 v19, v19, v202
    v_mul_f32 v20, v20, v202
    v_mul_f32 v21, v21, v202
    v_mul_f32 v22, v22, v202
    v_mul_f32 v23, v23, v202
    v_mul_f32 v24, v24, v202
    v_mul_f32 v25, v25, v202
    v_mul_f32 v26, v26, v202
    v_mul_f32 v27, v27, v202
    v_mul_f32 v28, v28, v202
    v_mul_f32 v29, v29, v202
    v_mul_f32 v30, v30, v202
    v_mul_f32 v31, v31, v202
    v_mul_f32 v32, v32, v202
    v_mul_f32 v33, v33, v202
    v_mul_f32 v34, v34, v202
    v_mul_f32 v35, v35, v202
    v_mul_f32 v36, v36, v202
    v_mul_f32 v37, v37, v202
    v_mul_f32 v38, v38, v202
    v_mul_f32 v39, v39, v202
    v_mul_f32 v40, v40, v202
    v_mul_f32 v41, v41, v202
    v_mul_f32 v42, v42, v202
    v_mul_f32 v43, v43, v202
    v_mul_f32 v44, v44, v202
    v_mul_f32 v45, v45, v202
    v_mul_f32 v46, v46, v202
    v_mul_f32 v47, v47, v202
    v_mul_f32 v48, v48, v202
    v_mul_f32 v49, v49, v202
    v_mul_f32 v50, v50, v202
    v_mul_f32 v51, v51, v202
    v_mul_f32 v52, v52, v202
    v_mul_f32 v53, v53, v202
    v_mul_f32 v54, v54, v202
    v_mul_f32 v55, v55, v202
    v_mul_f32 v56, v56, v202
    v_mul_f32 v57, v57, v202
    v_mul_f32 v58, v58, v202
    v_mul_f32 v59, v59, v202
    v_mul_f32 v60, v60, v202
    v_mul_f32 v61, v61, v202
    v_mul_f32 v62, v62, v202
    v_mul_f32 v63, v63, v202
    v_cvt_pk_bf16_f32 v64, v0, v1
    v_cvt_pk_bf16_f32 v65, v2, v3
    v_cvt_pk_bf16_f32 v66, v4, v5
    v_cvt_pk_bf16_f32 v67, v6, v7
    v_cvt_pk_bf16_f32 v68, v8, v9
    v_cvt_pk_bf16_f32 v69, v10, v11
    v_cvt_pk_bf16_f32 v70, v12, v13
    v_cvt_pk_bf16_f32 v71, v14, v15
    v_cvt_pk_bf16_f32 v72, v16, v17
    v_cvt_pk_bf16_f32 v73, v18, v19
    v_cvt_pk_bf16_f32 v74, v20, v21
    v_cvt_pk_bf16_f32 v75, v22, v23
    v_cvt_pk_bf16_f32 v76, v24, v25
    v_cvt_pk_bf16_f32 v77, v26, v27
    v_cvt_pk_bf16_f32 v78, v28, v29
    v_cvt_pk_bf16_f32 v79, v30, v31
    v_cvt_pk_bf16_f32 v80, v32, v33
    v_cvt_pk_bf16_f32 v81, v34, v35
    v_cvt_pk_bf16_f32 v82, v36, v37
    v_cvt_pk_bf16_f32 v83, v38, v39
    v_cvt_pk_bf16_f32 v84, v40, v41
    v_cvt_pk_bf16_f32 v85, v42, v43
    v_cvt_pk_bf16_f32 v86, v44, v45
    v_cvt_pk_bf16_f32 v87, v46, v47
    v_cvt_pk_bf16_f32 v88, v48, v49
    v_cvt_pk_bf16_f32 v89, v50, v51
    v_cvt_pk_bf16_f32 v90, v52, v53
    v_cvt_pk_bf16_f32 v91, v54, v55
    v_cvt_pk_bf16_f32 v92, v56, v57
    v_cvt_pk_bf16_f32 v93, v58, v59
    v_cvt_pk_bf16_f32 v94, v60, v61
    v_cvt_pk_bf16_f32 v95, v62, v63
    ds_read_b128 v[144:147], v241 offset:0
    ds_read_b128 v[148:151], v241 offset:1024
    ds_read_b128 v[152:155], v241 offset:2048
    ds_read_b128 v[156:159], v241 offset:3072
    ds_read_b128 v[160:163], v241 offset:4096
    ds_read_b128 v[164:167], v241 offset:5120
    ds_read_b128 v[168:171], v241 offset:6144
    s_waitcnt lgkmcnt(6)
    v_mfma_f32_16x16x32_bf16 v[96:99], v[64:67], v[144:147], 0
    ds_read_b128 v[172:175], v241 offset:7168
    s_waitcnt lgkmcnt(6)
    v_mfma_f32_16x16x32_bf16 v[100:103], v[64:67], v[148:151], 0
    ds_read_b128 v[144:147], v241 offset:8192
    s_waitcnt lgkmcnt(6)
    v_mfma_f32_16x16x32_bf16 v[104:107], v[64:67], v[152:155], 0
    ds_read_b128 v[148:151], v241 offset:9216
    s_waitcnt lgkmcnt(6)
    v_mfma_f32_16x16x32_bf16 v[108:111], v[64:67], v[156:159], 0
    ds_read_b128 v[152:155], v241 offset:10240
    s_waitcnt lgkmcnt(6)
    v_mfma_f32_16x16x32_bf16 v[112:115], v[64:67], v[160:163], 0
    ds_read_b128 v[156:159], v241 offset:11264
    s_waitcnt lgkmcnt(6)
    v_mfma_f32_16x16x32_bf16 v[116:119], v[64:67], v[164:167], 0
    ds_read_b128 v[160:163], v241 offset:12288
    s_waitcnt lgkmcnt(6)
    v_mfma_f32_16x16x32_bf16 v[120:123], v[64:67], v[168:171], 0
    ds_read_b128 v[164:167], v241 offset:13312
    s_waitcnt lgkmcnt(6)
    v_mfma_f32_16x16x32_bf16 v[124:127], v[64:67], v[172:175], 0
    ds_read_b128 v[168:171], v241 offset:14336
    s_waitcnt lgkmcnt(6)
    v_mfma_f32_16x16x32_bf16 v[96:99], v[68:71], v[144:147], v[96:99]
    ds_read_b128 v[172:175], v241 offset:15360
    s_waitcnt lgkmcnt(6)
    v_mfma_f32_16x16x32_bf16 v[100:103], v[68:71], v[148:151], v[100:103]
    ds_read_b128 v[144:147], v241 offset:16384
    s_waitcnt lgkmcnt(6)
    v_mfma_f32_16x16x32_bf16 v[104:107], v[68:71], v[152:155], v[104:107]
    ds_read_b128 v[148:151], v241 offset:17408
    s_waitcnt lgkmcnt(6)
    v_mfma_f32_16x16x32_bf16 v[108:111], v[68:71], v[156:159], v[108:111]
    ds_read_b128 v[152:155], v241 offset:18432
    s_waitcnt lgkmcnt(6)
    v_mfma_f32_16x16x32_bf16 v[112:115], v[68:71], v[160:163], v[112:115]
    ds_read_b128 v[156:159], v241 offset:19456
    s_waitcnt lgkmcnt(6)
    v_mfma_f32_16x16x32_bf16 v[116:119], v[68:71], v[164:167], v[116:119]
    ds_read_b128 v[160:163], v241 offset:20480
    s_waitcnt lgkmcnt(6)
    v_mfma_f32_16x16x32_bf16 v[120:123], v[68:71], v[168:171], v[120:123]
    ds_read_b128 v[164:167], v241 offset:21504
    s_waitcnt lgkmcnt(6)
    v_mfma_f32_16x16x32_bf16 v[124:127], v[68:71], v[172:175], v[124:127]
    ds_read_b128 v[168:171], v241 offset:22528
    s_waitcnt lgkmcnt(6)
    v_mfma_f32_16x16x32_bf16 v[96:99], v[72:75], v[144:147], v[96:99]
    ds_read_b128 v[172:175], v241 offset:23552
    s_waitcnt lgkmcnt(6)
    v_mfma_f32_16x16x32_bf16 v[100:103], v[72:75], v[148:151], v[100:103]
    ds_read_b128 v[144:147], v241 offset:24576
    s_waitcnt lgkmcnt(6)
    v_mfma_f32_16x16x32_bf16 v[104:107], v[72:75], v[152:155], v[104:107]
    ds_read_b128 v[148:151], v241 offset:25600
    s_waitcnt lgkmcnt(6)
    v_mfma_f32_16x16x32_bf16 v[108:111], v[72:75], v[156:159], v[108:111]
    ds_read_b128 v[152:155], v241 offset:26624
    s_waitcnt lgkmcnt(6)
    v_mfma_f32_16x16x32_bf16 v[112:115], v[72:75], v[160:163], v[112:115]
    ds_read_b128 v[156:159], v241 offset:27648
    s_waitcnt lgkmcnt(6)
    v_mfma_f32_16x16x32_bf16 v[116:119], v[72:75], v[164:167], v[116:119]
    ds_read_b128 v[160:163], v241 offset:28672
    s_waitcnt lgkmcnt(6)
    v_mfma_f32_16x16x32_bf16 v[120:123], v[72:75], v[168:171], v[120:123]
    ds_read_b128 v[164:167], v241 offset:29696
    s_waitcnt lgkmcnt(6)
    v_mfma_f32_16x16x32_bf16 v[124:127], v[72:75], v[172:175], v[124:127]
    ds_read_b128 v[168:171], v241 offset:30720
    s_waitcnt lgkmcnt(6)
    v_mfma_f32_16x16x32_bf16 v[96:99], v[76:79], v[144:147], v[96:99]
    ds_read_b128 v[172:175], v241 offset:31744
    s_waitcnt lgkmcnt(6)
    v_mfma_f32_16x16x32_bf16 v[100:103], v[76:79], v[148:151], v[100:103]
    ds_read_b128 v[144:147], v241 offset:32768
    s_waitcnt lgkmcnt(6)
    v_mfma_f32_16x16x32_bf16 v[104:107], v[76:79], v[152:155], v[104:107]
    ds_read_b128 v[148:151], v241 offset:33792
    s_waitcnt lgkmcnt(6)
    v_mfma_f32_16x16x32_bf16 v[108:111], v[76:79], v[156:159], v[108:111]
    ds_read_b128 v[152:155], v241 offset:34816
    s_waitcnt lgkmcnt(6)
    v_mfma_f32_16x16x32_bf16 v[112:115], v[76:79], v[160:163], v[112:115]
    ds_read_b128 v[156:159], v241 offset:35840
    s_waitcnt lgkmcnt(6)
    v_mfma_f32_16x16x32_bf16 v[116:119], v[76:79], v[164:167], v[116:119]
    ds_read_b128 v[160:163], v241 offset:36864
    s_waitcnt lgkmcnt(6)
    v_mfma_f32_16x16x32_bf16 v[120:123], v[76:79], v[168:171], v[120:123]
    ds_read_b128 v[164:167], v241 offset:37888
    s_waitcnt lgkmcnt(6)
    v_mfma_f32_16x16x32_bf16 v[124:127], v[76:79], v[172:175], v[124:127]
    ds_read_b128 v[168:171], v241 offset:38912
    s_waitcnt lgkmcnt(6)
    v_mfma_f32_16x16x32_bf16 v[96:99], v[80:83], v[144:147], v[96:99]
    ds_read_b128 v[172:175], v241 offset:39936
    s_waitcnt lgkmcnt(6)
    v_mfma_f32_16x16x32_bf16 v[100:103], v[80:83], v[148:151], v[100:103]
    ds_read_b128 v[144:147], v241 offset:40960
    s_waitcnt lgkmcnt(6)
    v_mfma_f32_16x16x32_bf16 v[104:107], v[80:83], v[152:155], v[104:107]
    ds_read_b128 v[148:151], v241 offset:41984
    s_waitcnt lgkmcnt(6)
    v_mfma_f32_16x16x32_bf16 v[108:111], v[80:83], v[156:159], v[108:111]
    ds_read_b128 v[152:155], v241 offset:43008
    s_waitcnt lgkmcnt(6)
    v_mfma_f32_16x16x32_bf16 v[112:115], v[80:83], v[160:163], v[112:115]
    ds_read_b128 v[156:159], v241 offset:44032
    s_waitcnt lgkmcnt(6)
    v_mfma_f32_16x16x32_bf16 v[116:119], v[80:83], v[164:167], v[116:119]
    ds_read_b128 v[160:163], v241 offset:45056
    s_waitcnt lgkmcnt(6)
    v_mfma_f32_16x16x32_bf16 v[120:123], v[80:83], v[168:171], v[120:123]
    ds_read_b128 v[164:167], v241 offset:46080
    s_waitcnt lgkmcnt(6)
    v_mfma_f32_16x16x32_bf16 v[124:127], v[80:83], v[172:175], v[124:127]
    ds_read_b128 v[168:171], v241 offset:47104
    s_waitcnt lgkmcnt(6)
    v_mfma_f32_16x16x32_bf16 v[96:99], v[84:87], v[144:147], v[96:99]
    ds_read_b128 v[172:175], v241 offset:48128
    s_waitcnt lgkmcnt(6)
    v_mfma_f32_16x16x32_bf16 v[100:103], v[84:87], v[148:151], v[100:103]
    ds_read_b128 v[144:147], v241 offset:49152
    s_waitcnt lgkmcnt(6)
    v_mfma_f32_16x16x32_bf16 v[104:107], v[84:87], v[152:155], v[104:107]
    ds_read_b128 v[148:151], v241 offset:50176
    s_waitcnt lgkmcnt(6)
    v_mfma_f32_16x16x32_bf16 v[108:111], v[84:87], v[156:159], v[108:111]
    ds_read_b128 v[152:155], v241 offset:51200
    s_waitcnt lgkmcnt(6)
    v_mfma_f32_16x16x32_bf16 v[112:115], v[84:87], v[160:163], v[112:115]
    ds_read_b128 v[156:159], v241 offset:52224
    s_waitcnt lgkmcnt(6)
    v_mfma_f32_16x16x32_bf16 v[116:119], v[84:87], v[164:167], v[116:119]
    ds_read_b128 v[160:163], v241 offset:53248
    s_waitcnt lgkmcnt(6)
    v_mfma_f32_16x16x32_bf16 v[120:123], v[84:87], v[168:171], v[120:123]
    ds_read_b128 v[164:167], v241 offset:54272
    s_waitcnt lgkmcnt(6)
    v_mfma_f32_16x16x32_bf16 v[124:127], v[84:87], v[172:175], v[124:127]
    ds_read_b128 v[168:171], v241 offset:55296
    s_waitcnt lgkmcnt(6)
    v_mfma_f32_16x16x32_bf16 v[96:99], v[88:91], v[144:147], v[96:99]
    ds_read_b128 v[172:175], v241 offset:56320
    s_waitcnt lgkmcnt(6)
    v_mfma_f32_16x16x32_bf16 v[100:103], v[88:91], v[148:151], v[100:103]
    ds_read_b128 v[144:147], v241 offset:57344
    s_waitcnt lgkmcnt(6)
    v_mfma_f32_16x16x32_bf16 v[104:107], v[88:91], v[152:155], v[104:107]
    ds_read_b128 v[148:151], v241 offset:58368
    s_waitcnt lgkmcnt(6)
    v_mfma_f32_16x16x32_bf16 v[108:111], v[88:91], v[156:159], v[108:111]
    ds_read_b128 v[152:155], v241 offset:59392
    s_waitcnt lgkmcnt(6)
    v_mfma_f32_16x16x32_bf16 v[112:115], v[88:91], v[160:163], v[112:115]
    ds_read_b128 v[156:159], v241 offset:60416
    s_waitcnt lgkmcnt(6)
    v_mfma_f32_16x16x32_bf16 v[116:119], v[88:91], v[164:167], v[116:119]
    ds_read_b128 v[160:163], v241 offset:61440
    s_waitcnt lgkmcnt(6)
    v_mfma_f32_16x16x32_bf16 v[120:123], v[88:91], v[168:171], v[120:123]
    ds_read_b128 v[164:167], v241 offset:62464
    s_waitcnt lgkmcnt(6)
    v_mfma_f32_16x16x32_bf16 v[124:127], v[88:91], v[172:175], v[124:127]
    ds_read_b128 v[168:171], v241 offset:63488
    s_waitcnt lgkmcnt(6)
    v_mfma_f32_16x16x32_bf16 v[96:99], v[92:95], v[144:147], v[96:99]
    ds_read_b128 v[172:175], v241 offset:64512
    s_waitcnt lgkmcnt(6)
    v_mfma_f32_16x16x32_bf16 v[100:103], v[92:95], v[148:151], v[100:103]
    s_waitcnt lgkmcnt(5)
    v_mfma_f32_16x16x32_bf16 v[104:107], v[92:95], v[152:155], v[104:107]
    s_waitcnt lgkmcnt(4)
    v_mfma_f32_16x16x32_bf16 v[108:111], v[92:95], v[156:159], v[108:111]
    s_waitcnt lgkmcnt(3)
    v_mfma_f32_16x16x32_bf16 v[112:115], v[92:95], v[160:163], v[112:115]
    s_waitcnt lgkmcnt(2)
    v_mfma_f32_16x16x32_bf16 v[116:119], v[92:95], v[164:167], v[116:119]
    s_waitcnt lgkmcnt(1)
    v_mfma_f32_16x16x32_bf16 v[120:123], v[92:95], v[168:171], v[120:123]
    s_waitcnt lgkmcnt(0)
    v_mfma_f32_16x16x32_bf16 v[124:127], v[92:95], v[172:175], v[124:127]
    s_nop 15
    v_cvt_pk_bf16_f32 v96, v96, v100
    v_cvt_pk_bf16_f32 v100, v97, v101
    v_cvt_pk_bf16_f32 v97, v104, v108
    v_cvt_pk_bf16_f32 v101, v105, v109
    v_cvt_pk_bf16_f32 v104, v98, v102
    v_cvt_pk_bf16_f32 v108, v99, v103
    v_cvt_pk_bf16_f32 v105, v106, v110
    v_cvt_pk_bf16_f32 v109, v107, v111
    v_cvt_pk_bf16_f32 v98, v112, v116
    v_cvt_pk_bf16_f32 v102, v113, v117
    v_cvt_pk_bf16_f32 v106, v114, v118
    v_cvt_pk_bf16_f32 v110, v115, v119
    v_cvt_pk_bf16_f32 v99, v120, v124
    v_cvt_pk_bf16_f32 v103, v121, v125
    v_cvt_pk_bf16_f32 v107, v122, v126
    v_cvt_pk_bf16_f32 v111, v123, v127
    s_nop 1
    buffer_store_dwordx4 v[96:99], v248, s[16:19], s50 offen offset:0
    buffer_store_dwordx4 v[100:103], v248, s[16:19], s50 offen offset:256
    buffer_store_dwordx4 v[104:107], v248, s[16:19], s50 offen offset:512
    buffer_store_dwordx4 v[108:111], v248, s[16:19], s50 offen offset:768
    s_waitcnt vmcnt(0)
    s_add_u32 s50, s50, 4096
    s_cmp_lt_u32 s50, 0x10000
    s_cbranch_scc1 L_slow
L_done:
L_end:
    s_endpgm
.section .rodata,"a"
.p2align 6
.amdhsa_kernel standalone__gqa_softmax__near_ridge_kernel
  .amdhsa_next_free_vgpr 512
  .amdhsa_next_free_sgpr 102
  .amdhsa_accum_offset 256
  .amdhsa_group_segment_fixed_size 0
  .amdhsa_kernarg_size 48
  .amdhsa_user_sgpr_count 2
  .amdhsa_user_sgpr_kernarg_segment_ptr 1
  .amdhsa_system_sgpr_workgroup_id_x 1
.end_amdhsa_kernel
```
